```python
import torch

def _softmax(x, axis=-1):
    return torch.softmax(x, dim=axis)
def _gelu(x):
    return torch.nn.functional.gelu(x, approximate="tanh")
def _silu(x):
    return torch.nn.functional.silu(x)
def _sigmoid(x):
    return torch.sigmoid(x)
def _layernorm(x, axis=-1, eps=1e-5):
    m = x.mean(dim=axis, keepdim=True)
    v = x.var(dim=axis, keepdim=True, unbiased=False)
    return (x - m) / torch.sqrt(v + eps)
def _scatter_add(tgt, idx, src, axis=0):
    return tgt.clone().index_add_(axis, idx, src)
def _segment_sum(src, seg, n):
    out = torch.zeros((n,) + src.shape[1:], dtype=src.dtype)
    return out.index_add_(0, seg, src)
def _pad(x, pw):
    flat = tuple(v for pair in reversed(pw) for v in pair)
    return torch.nn.functional.pad(x, flat)

kernel_name = 'concat_heads__gqa_block_cached__mha_block_cached__near_ridge'

def setup_inputs():

    _w = (lambda a: (lambda t: t.to(torch.bfloat16) if t.is_floating_point() else t)(torch.as_tensor(a)))
    def _A_setup():
        B, Sq, D = 16, 144, 640
        Hq, Hkv, Sk, Dh = 32, 32, 512, 192
        assert Hq % Hkv == 0, (Hq, Hkv)
        return {
            "x": _w((lambda *s: torch.randn(*s, dtype=torch.bfloat16) * 0.8)(B, Sq, D)),
            "k_cache": _w((lambda *s: torch.randn(*s, dtype=torch.bfloat16) * 0.8)(B, Hkv, Sk, Dh)),
            "v_cache": _w((lambda *s: torch.randn(*s, dtype=torch.bfloat16) * 0.05)(B, Hkv, Sk, Dh)),
            "wq": _w((lambda *s: torch.randn(*s, dtype=torch.bfloat16) * 0.8)(D, Hq * Dh) * (D ** -0.5)),
            "wo": _w((lambda *s: torch.randn(*s, dtype=torch.bfloat16) * 0.05)(Hq * Dh, D) * ((Hq * Dh) ** -0.5)),
        }
    _A_in = _A_setup()

    def _B_setup():
        B, Sq, D = 16, 144, 640
        H, Sk, Dh = 32, 512, 192
        return {
            "x": _w((lambda *s: torch.randn(*s, dtype=torch.bfloat16) * 0.8)(B, Sq, D)),
            "k_cache": _w((lambda *s: torch.randn(*s, dtype=torch.bfloat16) * 0.8)(B, H, Sk, Dh)),
            "v_cache": _w((lambda *s: torch.randn(*s, dtype=torch.bfloat16) * 0.05)(B, H, Sk, Dh)),
            "wq": _w((lambda *s: torch.randn(*s, dtype=torch.bfloat16) * 0.8)(D, H * Dh) * (D ** -0.5)),
            "wo": _w((lambda *s: torch.randn(*s, dtype=torch.bfloat16) * 0.05)(H * Dh, D) * ((H * Dh) ** -0.5)),
        }
    _B_in = _B_setup()

    return {
        "A_x": _A_in["x"],
        "A_k_cache": _A_in["k_cache"],
        "A_v_cache": _A_in["v_cache"],
        "A_wq": _A_in["wq"],
        "A_wo": _A_in["wo"],
        "B_x": _B_in["x"],
        "B_k_cache": _B_in["k_cache"],
        "B_v_cache": _B_in["v_cache"],
        "B_wq": _B_in["wq"],
        "B_wo": _B_in["wo"],
    }

def reference(A_x, A_k_cache, A_v_cache, A_wq, A_wo, B_x, B_k_cache, B_v_cache, B_wq, B_wo):
    def _A_ref(x, k_cache, v_cache, wq, wo):
        B, Sq, D = x.shape
        Hq, Dh = 32, 192
        Hkv = k_cache.shape[1]
        rep = Hq // Hkv
        q = (lambda x, *d: x.permute(*d))((x @ wq).reshape(B, Sq, Hq, Dh), 0, 2, 1, 3)
        k = (lambda x, n, axis: torch.repeat_interleave(x, n, dim=axis))(k_cache, rep, axis=1)
        v = (lambda x, n, axis: torch.repeat_interleave(x, n, dim=axis))(v_cache, rep, axis=1)
        scores = torch.einsum("bhqd,bhkd->bhqk", q, k) * (Dh ** -0.5)
        p = _softmax(scores, axis=-1)
        o = torch.einsum("bhqk,bhkd->bhqd", p, v)
        return (lambda x, *d: x.permute(*d))(o, 0, 2, 1, 3).reshape(B, Sq, Hq * Dh) @ wo

    def _B_ref(x, k_cache, v_cache, wq, wo):
        B, Sq, D = x.shape
        H, Dh = 32, 192
        q = (lambda x, *d: x.permute(*d))((x @ wq).reshape(B, Sq, H, Dh), 0, 2, 1, 3)
        scores = torch.einsum("bhqd,bhkd->bhqk", q, k_cache) * (Dh ** -0.5)
        p = _softmax(scores, axis=-1)
        o = torch.einsum("bhqk,bhkd->bhqd", p, v_cache)
        return (lambda x, *d: x.permute(*d))(o, 0, 2, 1, 3).reshape(B, Sq, H * Dh) @ wo

    a = _A_ref(A_x, A_k_cache, A_v_cache, A_wq, A_wo)
    b = _B_ref(B_x, B_k_cache, B_v_cache, B_wq, B_wo)
    return torch.concatenate([a, b], axis=-1)
```

```asm
; @launch kernel=attn_kernel grid=(256,1,1) block=(512,1,1) lds=163840
; @launch kernel=oproj_kernel grid=(240,1,1) block=(256,1,1) lds=131072
.amdgcn_target "amdgcn-amd-amdhsa--gfx950"
.text
.globl attn_kernel
.type attn_kernel,@function
.globl oproj_kernel
.type oproj_kernel,@function
.p2align 8
attn_kernel:
    s_cmp_ge_u32 s2, 256
    s_cbranch_scc1 L_k1_exit
    s_load_dwordx8 s[48:55], s[0:1], 0
    s_load_dwordx8 s[56:63], s[0:1], 40
    s_load_dwordx2 s[64:65], s[0:1], 96
    s_load_dwordx2 s[94:95], s[0:1], 32
    s_load_dwordx2 s[96:97], s[0:1], 72
    s_and_b32 s3, s2, 7
    s_lshr_b32 s4, s2, 3
    s_lshr_b32 s5, s3, 2
    s_and_b32 s6, s3, 3
    s_lshr_b32 s7, s6, 1
    s_lshl_b32 s7, s7, 3
    s_lshr_b32 s66, s4, 2
    s_add_u32 s7, s7, s66
    s_and_b32 s66, s6, 1
    s_lshl_b32 s66, s66, 2
    s_and_b32 s67, s4, 3
    s_add_u32 s66, s66, s67
    s_lshl_b32 s66, s66, 2
    s_waitcnt lgkmcnt(0)
    s_cmp_eq_u32 s5, 0
    s_cselect_b32 s48, s48, s56
    s_cselect_b32 s49, s49, s57
    s_cselect_b32 s50, s50, s58
    s_cselect_b32 s51, s51, s59
    s_cselect_b32 s52, s52, s60
    s_cselect_b32 s53, s53, s61
    s_cselect_b32 s54, s54, s62
    s_cselect_b32 s55, s55, s63
    s_cselect_b32 s94, s94, s96
    s_cselect_b32 s95, s95, s97
    s_mov_b32 s88, s94
    s_and_b32 s89, s95, 0xffff
    s_mov_b32 s90, 7864320
    s_mov_b32 s91, 0x00020000
    s_mov_b32 s20, s48
    s_and_b32 s21, s49, 0xffff
    s_mov_b32 s22, 2949120
    s_mov_b32 s23, 0x00020000
    s_mov_b32 s8, s50
    s_and_b32 s9, s51, 0xffff
    s_mov_b32 s10, 100663296
    s_mov_b32 s11, 0x00020000
    s_mov_b32 s12, s52
    s_and_b32 s13, s53, 0xffff
    s_mov_b32 s14, 100663296
    s_mov_b32 s15, 0x00020000
    s_mov_b32 s16, s54
    s_and_b32 s17, s55, 0xffff
    s_mov_b32 s18, 7864320
    s_mov_b32 s19, 0x00020000
    s_mov_b32 s24, s64
    s_and_b32 s25, s65, 0xffff
    s_mov_b32 s26, 56623104
    s_mov_b32 s27, 0x00020000
    v_lshrrev_b32 v1, 6, v0
    s_nop 0
    v_readfirstlane_b32 s28, v1
    s_nop 0
    s_and_b32 s29, s28, 3
    s_mul_i32 s30, s28, 3072
    s_mul_i32 s31, s28, 2304
    s_lshl_b32 s67, s7, 5
    s_add_u32 s67, s67, s66
    s_mul_i32 s32, s67, 196608
    s_add_u32 s41, s32, 196608
    s_mul_i32 s33, s66, 384
    s_add_u32 s42, s33, 384
    s_mul_i32 s34, s7, 184320
    s_mul_i32 s67, s5, 192
    s_mul_i32 s68, s66, 6
    s_add_u32 s67, s67, s68
    s_mul_i32 s67, s67, 144
    s_mul_i32 s68, s7, 9
    s_add_u32 s67, s67, s68
    s_lshl_b32 s35, s67, 10
    s_mov_b32 s36, 0
    s_mov_b32 s37, 0x3dd53b95
    s_lshr_b32 s67, s4, 2
    s_mul_i32 s67, s67, 80
    s_mul_i32 s68, s28, 10
    s_add_u32 s67, s67, s68
    s_mul_i32 s74, s67, 12288
    s_and_b32 s67, s4, 3
    s_mul_i32 s67, s67, 360
    s_mul_i32 s68, s28, 45
    s_add_u32 s67, s67, s68
    s_lshl_b32 s67, s67, 7
    s_add_u32 s75, s67, s34
    s_lshl_b32 s67, s7, 3
    s_lshr_b32 s68, s66, 2
    s_add_u32 s67, s67, s68
    s_mul_i32 s67, s67, 61440
    s_mul_i32 s68, s28, 7680
    s_add_u32 s92, s67, s68
    s_mul_i32 s67, s29, 3
    s_and_b32 s68, s29, 1
    s_add_u32 s38, s67, s68
    s_add_u32 s39, s38, 1
    s_add_u32 s40, s67, 2
    s_cmp_eq_u32 s68, 1
    s_cselect_b32 s40, s67, s40
    s_lshr_b32 s67, s38, 1
    s_mul_i32 s43, s67, 147456
    s_lshr_b32 s67, s40, 1
    s_mul_i32 s44, s67, 147456
    s_and_b32 s67, s40, 1
    s_lshl_b32 s67, s67, 3
    s_add_u32 s44, s44, s67
    s_cmp_ge_u32 s28, 4
    s_cbranch_scc1 L_grp1
    s_nop 9
    v_and_b32 v240, 63, v0
    v_lshrrev_b32 v252, 3, v240
    v_lshrrev_b32 v253, 4, v240
    v_lshlrev_b32 v253, 1, v253
    v_and_b32 v254, 7, v240
    v_xor_b32 v253, v253, v254
    v_lshlrev_b32 v253, 4, v253
    v_mul_u32_u24 v241, 384, v252
    v_add3_u32 v241, v241, v253, s30
    s_and_b32 s45, s28, 1
    s_lshl_b32 s45, s45, 2
    v_bfe_u32 v253, v240, 4, 1
    v_lshlrev_b32 v253, 1, v253
    v_or_b32 v253, s45, v253
    v_xor_b32 v253, v253, v254
    v_lshlrev_b32 v253, 4, v253
    v_mul_u32_u24 v242, 12288, v252
    s_mul_i32 s45, s28, 98304
    v_add3_u32 v242, v242, v253, s45
    s_mul_i32 s45, s28, 9
    v_lshrrev_b32 v253, 4, v240
    v_add_u32 v253, s45, v253
    v_and_b32 v253, 3, v253
    v_lshlrev_b32 v253, 1, v253
    v_xor_b32 v253, v253, v254
    v_lshlrev_b32 v253, 4, v253
    v_mul_u32_u24 v243, 1280, v252
    s_mul_i32 s45, s28, 23040
    v_add3_u32 v243, v243, v253, s45
    v_lshlrev_b32 v252, 4, v240
    v_add_u32 v249, 122880, v252
    s_and_b32 s45, s29, 1
    s_lshl_b32 s45, s45, 3
    s_lshr_b32 s46, s29, 1
    s_lshl_b32 s46, s46, 10
    s_add_u32 s45, s45, s46
    v_add_u32 v250, s45, v249
    v_and_b32 v252, 15, v240
    v_mul_u32_u24 v252, 48, v252
    v_add_u32 v251, 162048, v252
    s_add_u32 s45, s33, 0
    s_add_u32 m0, s30, 0
    s_nop 0
    buffer_load_dwordx4 v242, s[16:19], s45 offen lds
    s_add_u32 m0, s30, 896
    s_nop 0
    buffer_load_dwordx4 v242, s[16:19], s45 offen offset:128 lds
    s_add_u32 m0, s30, 1792
    s_nop 0
    buffer_load_dwordx4 v242, s[16:19], s45 offen offset:256 lds
    s_add_u32 s45, s33, 786432
    s_add_u32 m0, s30, 24576
    s_nop 0
    buffer_load_dwordx4 v242, s[16:19], s45 offen lds
    s_add_u32 m0, s30, 25472
    s_nop 0
    buffer_load_dwordx4 v242, s[16:19], s45 offen offset:128 lds
    s_add_u32 m0, s30, 26368
    s_nop 0
    buffer_load_dwordx4 v242, s[16:19], s45 offen offset:256 lds
    s_add_u32 s46, s34, 0
    s_add_u32 m0, s31, 122880
    s_nop 0
    buffer_load_dwordx4 v243, s[20:23], s46 offen lds
    s_add_u32 s46, s34, 9216
    buffer_load_dwordx4 v243, s[20:23], s46 offen offset:1024 lds
    s_add_u32 s46, s34, 18432
    s_mov_b64 exec, 0xffff
    buffer_load_dwordx4 v243, s[20:23], s46 offen offset:2048 lds
    s_mov_b64 exec, -1
    s_add_u32 s46, s34, 256
    s_add_u32 m0, s31, 98304
    s_nop 0
    buffer_load_dwordx4 v243, s[20:23], s46 offen lds
    s_add_u32 s46, s34, 9472
    buffer_load_dwordx4 v243, s[20:23], s46 offen offset:1024 lds
    s_add_u32 s46, s34, 18688
    s_mov_b64 exec, 0xffff
    buffer_load_dwordx4 v243, s[20:23], s46 offen offset:2048 lds
    s_mov_b64 exec, -1
    s_add_u32 s45, s32, 0
    s_add_u32 m0, s30, 73728
    s_nop 0
    buffer_load_dwordx4 v241, s[8:11], s45 offen nt lds
    s_add_u32 m0, s30, 74624
    s_nop 0
    buffer_load_dwordx4 v241, s[8:11], s45 offen offset:128 nt lds
    s_add_u32 m0, s30, 75520
    s_nop 0
    buffer_load_dwordx4 v241, s[8:11], s45 offen offset:256 nt lds
    v_min_u32 v254, 59, v240
    v_lshlrev_b32 v254, 7, v254
    buffer_load_dword v255, v254, s[88:91], s92 offen
    s_waitcnt vmcnt(0)
    s_barrier
    s_waitcnt vmcnt(0)
    s_nop 9
L_head_0:
    v_and_b32 v188, 15, v240
    v_lshrrev_b32 v189, 4, v240
    v_bfe_u32 v190, v240, 2, 2
    v_and_b32 v191, 3, v240
    v_lshrrev_b32 v192, 1, v190
    v_and_b32 v193, 1, v189
    v_lshl_add_u32 v192, v193, 1, v192
    v_lshlrev_b32 v192, 1, v192
    v_mul_u32_u24 v195, 3072, v189
    v_lshl_add_u32 v195, v190, 7, v195
    v_and_b32 v193, 1, v191
    v_lshl_add_u32 v195, v193, 3, v195
    v_lshrrev_b32 v191, 1, v191
    s_lshl_b32 s45, s38, 1
    v_add_u32 v193, s45, v191
    v_lshrrev_b32 v194, 3, v193
    v_and_b32 v193, 7, v193
    v_xor_b32 v193, v193, v192
    v_lshl_add_u32 v193, v193, 4, v195
    v_lshl_add_u32 v246, v194, 10, v193
    s_lshl_b32 s45, s39, 1
    v_add_u32 v193, s45, v191
    v_lshrrev_b32 v194, 3, v193
    v_and_b32 v193, 7, v193
    v_xor_b32 v193, v193, v192
    v_lshl_add_u32 v193, v193, 4, v195
    v_lshl_add_u32 v247, v194, 10, v193
    s_lshl_b32 s45, s40, 1
    v_add_u32 v193, s45, v191
    v_lshrrev_b32 v194, 3, v193
    v_and_b32 v193, 7, v193
    v_xor_b32 v193, v193, v192
    v_lshl_add_u32 v193, v193, 4, v195
    v_lshl_add_u32 v248, v194, 10, v193
    v_and_b32 v188, 15, v240
    v_lshrrev_b32 v189, 4, v240
    v_and_b32 v190, 6, v188
    v_xor_b32 v191, v189, v190
    v_lshlrev_b32 v191, 4, v191
    v_lshl_add_u32 v191, v188, 7, v191
    v_add_u32 v244, 98304, v191
    v_xor_b32 v245, 64, v244
    v_mov_b32 v188, 0xff800000
    v_mov_b32 v189, 0xff800000
    v_lshlrev_b32 v190, 3, v240
    v_add_u32 v190, 162048, v190
    ds_write_b64 v190, v[188:189]
    ds_write_b64 v190, v[188:189] offset:512
    ds_write_b64 v190, v[188:189] offset:1024
    ds_read_b64_tr_b16 v[120:121], v246
    ds_read_b64_tr_b16 v[122:123], v246 offset:512
    ds_read_b64_tr_b16 v[124:125], v247
    ds_read_b64_tr_b16 v[126:127], v247 offset:512
    ds_read_b64_tr_b16 v[128:129], v248
    ds_read_b64_tr_b16 v[130:131], v248 offset:512
    ds_read_b128 v[144:147], v244 offset:24576
    ds_read_b128 v[148:151], v244 offset:26624
    ds_read_b128 v[152:155], v244 offset:28672
    ds_read_b64_tr_b16 v[132:133], v246 offset:12288
    ds_read_b64_tr_b16 v[134:135], v246 offset:12800
    ds_read_b64_tr_b16 v[136:137], v247 offset:12288
    ds_read_b64_tr_b16 v[138:139], v247 offset:12800
    ds_read_b64_tr_b16 v[140:141], v248 offset:12288
    ds_read_b64_tr_b16 v[142:143], v248 offset:12800
    s_waitcnt lgkmcnt(8)
    v_mfma_f32_16x16x32_bf16 v[12:15], v[120:123], v[144:147], 0
    s_add_u32 s45, s33, 1572864
    s_add_u32 m0, s30, 49152
    s_nop 0
    buffer_load_dwordx4 v242, s[16:19], s45 offen lds
    v_mfma_f32_16x16x32_bf16 v[16:19], v[124:127], v[144:147], 0
    s_add_u32 m0, s30, 50048
    s_nop 0
    buffer_load_dwordx4 v242, s[16:19], s45 offen offset:128 lds
    v_mfma_f32_16x16x32_bf16 v[20:23], v[128:131], v[144:147], 0
    s_add_u32 m0, s30, 50944
    s_nop 0
    buffer_load_dwordx4 v242, s[16:19], s45 offen offset:256 lds
    ds_read_b128 v[144:147], v244 offset:30720
    s_waitcnt lgkmcnt(8)
    v_mfma_f32_16x16x32_bf16 v[36:39], v[120:123], v[148:151], 0
    s_add_u32 s46, s34, 128
    s_add_u32 m0, s31, 141312
    s_nop 0
    buffer_load_dwordx4 v243, s[20:23], s46 offen lds
    s_add_u32 s46, s34, 9344
    buffer_load_dwordx4 v243, s[20:23], s46 offen offset:1024 lds
    s_add_u32 s46, s34, 18560
    s_mov_b64 exec, 0xffff
    buffer_load_dwordx4 v243, s[20:23], s46 offen offset:2048 lds
    s_mov_b64 exec, -1
    v_mfma_f32_16x16x32_bf16 v[40:43], v[124:127], v[148:151], 0
    v_mfma_f32_16x16x32_bf16 v[44:47], v[128:131], v[148:151], 0
    ds_read_b128 v[148:151], v244 offset:32768
    s_waitcnt lgkmcnt(8)
    v_mfma_f32_16x16x32_bf16 v[60:63], v[120:123], v[152:155], 0
    v_mfma_f32_16x16x32_bf16 v[64:67], v[124:127], v[152:155], 0
    v_mfma_f32_16x16x32_bf16 v[68:71], v[128:131], v[152:155], 0
    ds_read_b128 v[152:155], v245 offset:24576
    s_waitcnt lgkmcnt(2)
    v_mfma_f32_16x16x32_bf16 v[84:87], v[120:123], v[144:147], 0
    v_mfma_f32_16x16x32_bf16 v[88:91], v[124:127], v[144:147], 0
    v_mfma_f32_16x16x32_bf16 v[92:95], v[128:131], v[144:147], 0
    ds_read_b128 v[144:147], v245 offset:26624
    s_waitcnt lgkmcnt(2)
    v_mfma_f32_16x16x32_bf16 v[108:111], v[120:123], v[148:151], 0
    v_mfma_f32_16x16x32_bf16 v[112:115], v[124:127], v[148:151], 0
    v_mfma_f32_16x16x32_bf16 v[116:119], v[128:131], v[148:151], 0
    ds_read_b128 v[148:151], v245 offset:28672
    s_waitcnt lgkmcnt(2)
    v_mfma_f32_16x16x32_bf16 v[12:15], v[132:135], v[152:155], v[12:15]
    v_mfma_f32_16x16x32_bf16 v[16:19], v[136:139], v[152:155], v[16:19]
    v_mfma_f32_16x16x32_bf16 v[20:23], v[140:143], v[152:155], v[20:23]
    ds_read_b128 v[152:155], v245 offset:30720
    s_waitcnt lgkmcnt(2)
    v_mfma_f32_16x16x32_bf16 v[36:39], v[132:135], v[144:147], v[36:39]
    v_mfma_f32_16x16x32_bf16 v[40:43], v[136:139], v[144:147], v[40:43]
    v_mfma_f32_16x16x32_bf16 v[44:47], v[140:143], v[144:147], v[44:47]
    ds_read_b128 v[144:147], v245 offset:32768
    s_waitcnt lgkmcnt(2)
    v_mfma_f32_16x16x32_bf16 v[60:63], v[132:135], v[148:151], v[60:63]
    v_mfma_f32_16x16x32_bf16 v[64:67], v[136:139], v[148:151], v[64:67]
    v_mfma_f32_16x16x32_bf16 v[68:71], v[140:143], v[148:151], v[68:71]
    s_waitcnt lgkmcnt(1)
    v_mfma_f32_16x16x32_bf16 v[84:87], v[132:135], v[152:155], v[84:87]
    v_mfma_f32_16x16x32_bf16 v[88:91], v[136:139], v[152:155], v[88:91]
    v_mfma_f32_16x16x32_bf16 v[92:95], v[140:143], v[152:155], v[92:95]
    s_waitcnt lgkmcnt(0)
    v_mfma_f32_16x16x32_bf16 v[108:111], v[132:135], v[144:147], v[108:111]
    v_mfma_f32_16x16x32_bf16 v[112:115], v[136:139], v[144:147], v[112:115]
    v_mfma_f32_16x16x32_bf16 v[116:119], v[140:143], v[144:147], v[116:119]
    s_waitcnt vmcnt(0)
    s_barrier
    ds_read_b64_tr_b16 v[120:121], v246 offset:24576
    ds_read_b64_tr_b16 v[122:123], v246 offset:25088
    ds_read_b64_tr_b16 v[124:125], v247 offset:24576
    ds_read_b64_tr_b16 v[126:127], v247 offset:25088
    ds_read_b64_tr_b16 v[128:129], v248 offset:24576
    ds_read_b64_tr_b16 v[130:131], v248 offset:25088
    ds_read_b128 v[144:147], v244 offset:43008
    ds_read_b128 v[148:151], v244 offset:45056
    ds_read_b128 v[152:155], v244 offset:47104
    ds_read_b64_tr_b16 v[132:133], v246 offset:36864
    ds_read_b64_tr_b16 v[134:135], v246 offset:37376
    ds_read_b64_tr_b16 v[136:137], v247 offset:36864
    ds_read_b64_tr_b16 v[138:139], v247 offset:37376
    ds_read_b64_tr_b16 v[140:141], v248 offset:36864
    ds_read_b64_tr_b16 v[142:143], v248 offset:37376
    s_waitcnt lgkmcnt(8)
    v_mfma_f32_16x16x32_bf16 v[12:15], v[120:123], v[144:147], v[12:15]
    s_add_u32 s45, s33, 2359296
    s_add_u32 m0, s30, 0
    s_nop 0
    buffer_load_dwordx4 v242, s[16:19], s45 offen lds
    v_mfma_f32_16x16x32_bf16 v[16:19], v[124:127], v[144:147], v[16:19]
    s_add_u32 m0, s30, 896
    s_nop 0
    buffer_load_dwordx4 v242, s[16:19], s45 offen offset:128 lds
    v_mfma_f32_16x16x32_bf16 v[20:23], v[128:131], v[144:147], v[20:23]
    s_add_u32 m0, s30, 1792
    s_nop 0
    buffer_load_dwordx4 v242, s[16:19], s45 offen offset:256 lds
    ds_read_b128 v[144:147], v244 offset:49152
    s_waitcnt lgkmcnt(8)
    v_mfma_f32_16x16x32_bf16 v[36:39], v[120:123], v[148:151], v[36:39]
    s_add_u32 s46, s34, 384
    s_add_u32 m0, s31, 122880
    s_nop 0
    buffer_load_dwordx4 v243, s[20:23], s46 offen lds
    s_add_u32 s46, s34, 9600
    buffer_load_dwordx4 v243, s[20:23], s46 offen offset:1024 lds
    s_add_u32 s46, s34, 18816
    s_mov_b64 exec, 0xffff
    buffer_load_dwordx4 v243, s[20:23], s46 offen offset:2048 lds
    s_mov_b64 exec, -1
    v_mfma_f32_16x16x32_bf16 v[40:43], v[124:127], v[148:151], v[40:43]
    v_mfma_f32_16x16x32_bf16 v[44:47], v[128:131], v[148:151], v[44:47]
    ds_read_b128 v[148:151], v244 offset:51200
    s_waitcnt lgkmcnt(8)
    v_mfma_f32_16x16x32_bf16 v[60:63], v[120:123], v[152:155], v[60:63]
    v_mfma_f32_16x16x32_bf16 v[64:67], v[124:127], v[152:155], v[64:67]
    v_mfma_f32_16x16x32_bf16 v[68:71], v[128:131], v[152:155], v[68:71]
    ds_read_b128 v[152:155], v245 offset:43008
    s_waitcnt lgkmcnt(2)
    v_mfma_f32_16x16x32_bf16 v[84:87], v[120:123], v[144:147], v[84:87]
    v_mfma_f32_16x16x32_bf16 v[88:91], v[124:127], v[144:147], v[88:91]
    v_mfma_f32_16x16x32_bf16 v[92:95], v[128:131], v[144:147], v[92:95]
    ds_read_b128 v[144:147], v245 offset:45056
    s_waitcnt lgkmcnt(2)
    v_mfma_f32_16x16x32_bf16 v[108:111], v[120:123], v[148:151], v[108:111]
    v_mfma_f32_16x16x32_bf16 v[112:115], v[124:127], v[148:151], v[112:115]
    v_mfma_f32_16x16x32_bf16 v[116:119], v[128:131], v[148:151], v[116:119]
    ds_read_b128 v[148:151], v245 offset:47104
    s_waitcnt lgkmcnt(2)
    v_mfma_f32_16x16x32_bf16 v[12:15], v[132:135], v[152:155], v[12:15]
    v_mfma_f32_16x16x32_bf16 v[16:19], v[136:139], v[152:155], v[16:19]
    v_mfma_f32_16x16x32_bf16 v[20:23], v[140:143], v[152:155], v[20:23]
    ds_read_b128 v[152:155], v245 offset:49152
    s_waitcnt lgkmcnt(2)
    v_mfma_f32_16x16x32_bf16 v[36:39], v[132:135], v[144:147], v[36:39]
    v_mfma_f32_16x16x32_bf16 v[40:43], v[136:139], v[144:147], v[40:43]
    v_mfma_f32_16x16x32_bf16 v[44:47], v[140:143], v[144:147], v[44:47]
    ds_read_b128 v[144:147], v245 offset:51200
    s_waitcnt lgkmcnt(2)
    v_mfma_f32_16x16x32_bf16 v[60:63], v[132:135], v[148:151], v[60:63]
    v_mfma_f32_16x16x32_bf16 v[64:67], v[136:139], v[148:151], v[64:67]
    v_mfma_f32_16x16x32_bf16 v[68:71], v[140:143], v[148:151], v[68:71]
    s_waitcnt lgkmcnt(1)
    v_mfma_f32_16x16x32_bf16 v[84:87], v[132:135], v[152:155], v[84:87]
    v_mfma_f32_16x16x32_bf16 v[88:91], v[136:139], v[152:155], v[88:91]
    v_mfma_f32_16x16x32_bf16 v[92:95], v[140:143], v[152:155], v[92:95]
    s_waitcnt lgkmcnt(0)
    v_mfma_f32_16x16x32_bf16 v[108:111], v[132:135], v[144:147], v[108:111]
    v_mfma_f32_16x16x32_bf16 v[112:115], v[136:139], v[144:147], v[112:115]
    v_mfma_f32_16x16x32_bf16 v[116:119], v[140:143], v[144:147], v[116:119]
    s_barrier
    ds_read_b64_tr_b16 v[120:121], v246 offset:49152
    ds_read_b64_tr_b16 v[122:123], v246 offset:49664
    ds_read_b64_tr_b16 v[124:125], v247 offset:49152
    ds_read_b64_tr_b16 v[126:127], v247 offset:49664
    ds_read_b64_tr_b16 v[128:129], v248 offset:49152
    ds_read_b64_tr_b16 v[130:131], v248 offset:49664
    ds_read_b128 v[144:147], v244
    ds_read_b128 v[148:151], v244 offset:2048
    ds_read_b128 v[152:155], v244 offset:4096
    ds_read_b64_tr_b16 v[132:133], v246 offset:61440
    ds_read_b64_tr_b16 v[134:135], v246 offset:61952
    ds_read_b64_tr_b16 v[136:137], v247 offset:61440
    ds_read_b64_tr_b16 v[138:139], v247 offset:61952
    ds_read_b64_tr_b16 v[140:141], v248 offset:61440
    ds_read_b64_tr_b16 v[142:143], v248 offset:61952
    s_waitcnt lgkmcnt(8)
    v_mfma_f32_16x16x32_bf16 v[12:15], v[120:123], v[144:147], v[12:15]
    s_add_u32 s45, s33, 3145728
    s_add_u32 m0, s30, 24576
    s_nop 0
    buffer_load_dwordx4 v242, s[16:19], s45 offen lds
    v_mfma_f32_16x16x32_bf16 v[16:19], v[124:127], v[144:147], v[16:19]
    s_add_u32 m0, s30, 25472
    s_nop 0
    buffer_load_dwordx4 v242, s[16:19], s45 offen offset:128 lds
    v_mfma_f32_16x16x32_bf16 v[20:23], v[128:131], v[144:147], v[20:23]
    s_add_u32 m0, s30, 26368
    s_nop 0
    buffer_load_dwordx4 v242, s[16:19], s45 offen offset:256 lds
    ds_read_b128 v[144:147], v244 offset:6144
    s_waitcnt lgkmcnt(8)
    v_mfma_f32_16x16x32_bf16 v[36:39], v[120:123], v[148:151], v[36:39]
    s_add_u32 s46, s34, 512
    s_add_u32 m0, s31, 141312
    s_nop 0
    buffer_load_dwordx4 v243, s[20:23], s46 offen lds
    s_add_u32 s46, s34, 9728
    buffer_load_dwordx4 v243, s[20:23], s46 offen offset:1024 lds
    s_add_u32 s46, s34, 18944
    s_mov_b64 exec, 0xffff
    buffer_load_dwordx4 v243, s[20:23], s46 offen offset:2048 lds
    s_mov_b64 exec, -1
    v_mfma_f32_16x16x32_bf16 v[40:43], v[124:127], v[148:151], v[40:43]
    v_mfma_f32_16x16x32_bf16 v[44:47], v[128:131], v[148:151], v[44:47]
    ds_read_b128 v[148:151], v244 offset:8192
    s_waitcnt lgkmcnt(8)
    v_mfma_f32_16x16x32_bf16 v[60:63], v[120:123], v[152:155], v[60:63]
    v_mfma_f32_16x16x32_bf16 v[64:67], v[124:127], v[152:155], v[64:67]
    v_mfma_f32_16x16x32_bf16 v[68:71], v[128:131], v[152:155], v[68:71]
    ds_read_b128 v[152:155], v245
    s_waitcnt lgkmcnt(2)
    v_mfma_f32_16x16x32_bf16 v[84:87], v[120:123], v[144:147], v[84:87]
    v_mfma_f32_16x16x32_bf16 v[88:91], v[124:127], v[144:147], v[88:91]
    v_mfma_f32_16x16x32_bf16 v[92:95], v[128:131], v[144:147], v[92:95]
    ds_read_b128 v[144:147], v245 offset:2048
    s_waitcnt lgkmcnt(2)
    v_mfma_f32_16x16x32_bf16 v[108:111], v[120:123], v[148:151], v[108:111]
    v_mfma_f32_16x16x32_bf16 v[112:115], v[124:127], v[148:151], v[112:115]
    v_mfma_f32_16x16x32_bf16 v[116:119], v[128:131], v[148:151], v[116:119]
    ds_read_b128 v[148:151], v245 offset:4096
    s_waitcnt lgkmcnt(2)
    v_mfma_f32_16x16x32_bf16 v[12:15], v[132:135], v[152:155], v[12:15]
    v_mfma_f32_16x16x32_bf16 v[16:19], v[136:139], v[152:155], v[16:19]
    v_mfma_f32_16x16x32_bf16 v[20:23], v[140:143], v[152:155], v[20:23]
    ds_read_b128 v[152:155], v245 offset:6144
    s_waitcnt lgkmcnt(2)
    v_mfma_f32_16x16x32_bf16 v[36:39], v[132:135], v[144:147], v[36:39]
    v_mfma_f32_16x16x32_bf16 v[40:43], v[136:139], v[144:147], v[40:43]
    v_mfma_f32_16x16x32_bf16 v[44:47], v[140:143], v[144:147], v[44:47]
    ds_read_b128 v[144:147], v245 offset:8192
    s_waitcnt lgkmcnt(2)
    v_mfma_f32_16x16x32_bf16 v[60:63], v[132:135], v[148:151], v[60:63]
    v_mfma_f32_16x16x32_bf16 v[64:67], v[136:139], v[148:151], v[64:67]
    v_mfma_f32_16x16x32_bf16 v[68:71], v[140:143], v[148:151], v[68:71]
    s_waitcnt lgkmcnt(1)
    v_mfma_f32_16x16x32_bf16 v[84:87], v[132:135], v[152:155], v[84:87]
    v_mfma_f32_16x16x32_bf16 v[88:91], v[136:139], v[152:155], v[88:91]
    v_mfma_f32_16x16x32_bf16 v[92:95], v[140:143], v[152:155], v[92:95]
    s_waitcnt lgkmcnt(0)
    v_mfma_f32_16x16x32_bf16 v[108:111], v[132:135], v[144:147], v[108:111]
    v_mfma_f32_16x16x32_bf16 v[112:115], v[136:139], v[144:147], v[112:115]
    v_mfma_f32_16x16x32_bf16 v[116:119], v[140:143], v[144:147], v[116:119]
    s_waitcnt vmcnt(6)
    s_barrier
    ds_read_b64_tr_b16 v[120:121], v246
    ds_read_b64_tr_b16 v[122:123], v246 offset:512
    ds_read_b64_tr_b16 v[124:125], v247
    ds_read_b64_tr_b16 v[126:127], v247 offset:512
    ds_read_b64_tr_b16 v[128:129], v248
    ds_read_b64_tr_b16 v[130:131], v248 offset:512
    ds_read_b128 v[144:147], v244 offset:24576
    ds_read_b128 v[148:151], v244 offset:26624
    ds_read_b128 v[152:155], v244 offset:28672
    ds_read_b64_tr_b16 v[132:133], v246 offset:12288
    ds_read_b64_tr_b16 v[134:135], v246 offset:12800
    ds_read_b64_tr_b16 v[136:137], v247 offset:12288
    ds_read_b64_tr_b16 v[138:139], v247 offset:12800
    ds_read_b64_tr_b16 v[140:141], v248 offset:12288
    ds_read_b64_tr_b16 v[142:143], v248 offset:12800
    s_waitcnt lgkmcnt(8)
    v_mfma_f32_16x16x32_bf16 v[12:15], v[120:123], v[144:147], v[12:15]
    s_add_u32 s45, s33, 3932160
    s_add_u32 m0, s30, 49152
    s_nop 0
    buffer_load_dwordx4 v242, s[16:19], s45 offen lds
    v_mfma_f32_16x16x32_bf16 v[16:19], v[124:127], v[144:147], v[16:19]
    s_add_u32 m0, s30, 50048
    s_nop 0
    buffer_load_dwordx4 v242, s[16:19], s45 offen offset:128 lds
    v_mfma_f32_16x16x32_bf16 v[20:23], v[128:131], v[144:147], v[20:23]
    s_add_u32 m0, s30, 50944
    s_nop 0
    buffer_load_dwordx4 v242, s[16:19], s45 offen offset:256 lds
    ds_read_b128 v[144:147], v244 offset:30720
    s_waitcnt lgkmcnt(8)
    v_mfma_f32_16x16x32_bf16 v[36:39], v[120:123], v[148:151], v[36:39]
    s_add_u32 s46, s34, 640
    s_add_u32 m0, s31, 98304
    s_nop 0
    buffer_load_dwordx4 v243, s[20:23], s46 offen lds
    s_add_u32 s46, s34, 9856
    buffer_load_dwordx4 v243, s[20:23], s46 offen offset:1024 lds
    s_add_u32 s46, s34, 19072
    s_mov_b64 exec, 0xffff
    buffer_load_dwordx4 v243, s[20:23], s46 offen offset:2048 lds
    s_mov_b64 exec, -1
    v_mfma_f32_16x16x32_bf16 v[40:43], v[124:127], v[148:151], v[40:43]
    v_mfma_f32_16x16x32_bf16 v[44:47], v[128:131], v[148:151], v[44:47]
    ds_read_b128 v[148:151], v244 offset:32768
    s_waitcnt lgkmcnt(8)
    v_mfma_f32_16x16x32_bf16 v[60:63], v[120:123], v[152:155], v[60:63]
    v_mfma_f32_16x16x32_bf16 v[64:67], v[124:127], v[152:155], v[64:67]
    v_mfma_f32_16x16x32_bf16 v[68:71], v[128:131], v[152:155], v[68:71]
    ds_read_b128 v[152:155], v245 offset:24576
    s_waitcnt lgkmcnt(2)
    v_mfma_f32_16x16x32_bf16 v[84:87], v[120:123], v[144:147], v[84:87]
    v_mfma_f32_16x16x32_bf16 v[88:91], v[124:127], v[144:147], v[88:91]
    v_mfma_f32_16x16x32_bf16 v[92:95], v[128:131], v[144:147], v[92:95]
    ds_read_b128 v[144:147], v245 offset:26624
    s_waitcnt lgkmcnt(2)
    v_mfma_f32_16x16x32_bf16 v[108:111], v[120:123], v[148:151], v[108:111]
    v_mfma_f32_16x16x32_bf16 v[112:115], v[124:127], v[148:151], v[112:115]
    v_mfma_f32_16x16x32_bf16 v[116:119], v[128:131], v[148:151], v[116:119]
    ds_read_b128 v[148:151], v245 offset:28672
    s_waitcnt lgkmcnt(2)
    v_mfma_f32_16x16x32_bf16 v[12:15], v[132:135], v[152:155], v[12:15]
    v_mfma_f32_16x16x32_bf16 v[16:19], v[136:139], v[152:155], v[16:19]
    v_mfma_f32_16x16x32_bf16 v[20:23], v[140:143], v[152:155], v[20:23]
    ds_read_b128 v[152:155], v245 offset:30720
    s_waitcnt lgkmcnt(2)
    v_mfma_f32_16x16x32_bf16 v[36:39], v[132:135], v[144:147], v[36:39]
    v_mfma_f32_16x16x32_bf16 v[40:43], v[136:139], v[144:147], v[40:43]
    v_mfma_f32_16x16x32_bf16 v[44:47], v[140:143], v[144:147], v[44:47]
    ds_read_b128 v[144:147], v245 offset:32768
    s_waitcnt lgkmcnt(2)
    v_mfma_f32_16x16x32_bf16 v[60:63], v[132:135], v[148:151], v[60:63]
    v_mfma_f32_16x16x32_bf16 v[64:67], v[136:139], v[148:151], v[64:67]
    v_mfma_f32_16x16x32_bf16 v[68:71], v[140:143], v[148:151], v[68:71]
    s_waitcnt lgkmcnt(1)
    v_mfma_f32_16x16x32_bf16 v[84:87], v[132:135], v[152:155], v[84:87]
    v_mfma_f32_16x16x32_bf16 v[88:91], v[136:139], v[152:155], v[88:91]
    v_mfma_f32_16x16x32_bf16 v[92:95], v[140:143], v[152:155], v[92:95]
    s_waitcnt lgkmcnt(0)
    v_mfma_f32_16x16x32_bf16 v[108:111], v[132:135], v[144:147], v[108:111]
    v_mfma_f32_16x16x32_bf16 v[112:115], v[136:139], v[144:147], v[112:115]
    v_mfma_f32_16x16x32_bf16 v[116:119], v[140:143], v[144:147], v[116:119]
    s_waitcnt vmcnt(6)
    s_barrier
    ds_read_b64_tr_b16 v[120:121], v246 offset:24576
    ds_read_b64_tr_b16 v[122:123], v246 offset:25088
    ds_read_b64_tr_b16 v[124:125], v247 offset:24576
    ds_read_b64_tr_b16 v[126:127], v247 offset:25088
    ds_read_b64_tr_b16 v[128:129], v248 offset:24576
    ds_read_b64_tr_b16 v[130:131], v248 offset:25088
    ds_read_b128 v[144:147], v244 offset:43008
    ds_read_b128 v[148:151], v244 offset:45056
    ds_read_b128 v[152:155], v244 offset:47104
    ds_read_b64_tr_b16 v[132:133], v246 offset:36864
    ds_read_b64_tr_b16 v[134:135], v246 offset:37376
    ds_read_b64_tr_b16 v[136:137], v247 offset:36864
    ds_read_b64_tr_b16 v[138:139], v247 offset:37376
    ds_read_b64_tr_b16 v[140:141], v248 offset:36864
    ds_read_b64_tr_b16 v[142:143], v248 offset:37376
    s_waitcnt lgkmcnt(8)
    v_mfma_f32_16x16x32_bf16 v[12:15], v[120:123], v[144:147], v[12:15]
    s_add_u32 s45, s33, 4718592
    s_add_u32 m0, s30, 0
    s_nop 0
    buffer_load_dwordx4 v242, s[16:19], s45 offen lds
    v_mfma_f32_16x16x32_bf16 v[16:19], v[124:127], v[144:147], v[16:19]
    s_add_u32 m0, s30, 896
    s_nop 0
    buffer_load_dwordx4 v242, s[16:19], s45 offen offset:128 lds
    v_mfma_f32_16x16x32_bf16 v[20:23], v[128:131], v[144:147], v[20:23]
    s_add_u32 m0, s30, 1792
    s_nop 0
    buffer_load_dwordx4 v242, s[16:19], s45 offen offset:256 lds
    ds_read_b128 v[144:147], v244 offset:49152
    s_waitcnt lgkmcnt(8)
    v_mfma_f32_16x16x32_bf16 v[36:39], v[120:123], v[148:151], v[36:39]
    s_add_u32 s46, s34, 768
    s_add_u32 m0, s31, 122880
    s_nop 0
    buffer_load_dwordx4 v243, s[20:23], s46 offen lds
    s_add_u32 s46, s34, 9984
    buffer_load_dwordx4 v243, s[20:23], s46 offen offset:1024 lds
    s_add_u32 s46, s34, 19200
    s_mov_b64 exec, 0xffff
    buffer_load_dwordx4 v243, s[20:23], s46 offen offset:2048 lds
    s_mov_b64 exec, -1
    v_mfma_f32_16x16x32_bf16 v[40:43], v[124:127], v[148:151], v[40:43]
    v_mfma_f32_16x16x32_bf16 v[44:47], v[128:131], v[148:151], v[44:47]
    ds_read_b128 v[148:151], v244 offset:51200
    s_waitcnt lgkmcnt(8)
    v_mfma_f32_16x16x32_bf16 v[60:63], v[120:123], v[152:155], v[60:63]
    v_mfma_f32_16x16x32_bf16 v[64:67], v[124:127], v[152:155], v[64:67]
    v_mfma_f32_16x16x32_bf16 v[68:71], v[128:131], v[152:155], v[68:71]
    ds_read_b128 v[152:155], v245 offset:43008
    s_waitcnt lgkmcnt(2)
    v_mfma_f32_16x16x32_bf16 v[84:87], v[120:123], v[144:147], v[84:87]
    v_mfma_f32_16x16x32_bf16 v[88:91], v[124:127], v[144:147], v[88:91]
    v_mfma_f32_16x16x32_bf16 v[92:95], v[128:131], v[144:147], v[92:95]
    ds_read_b128 v[144:147], v245 offset:45056
    s_waitcnt lgkmcnt(2)
    v_mfma_f32_16x16x32_bf16 v[108:111], v[120:123], v[148:151], v[108:111]
    v_mfma_f32_16x16x32_bf16 v[112:115], v[124:127], v[148:151], v[112:115]
    v_mfma_f32_16x16x32_bf16 v[116:119], v[128:131], v[148:151], v[116:119]
    ds_read_b128 v[148:151], v245 offset:47104
    s_waitcnt lgkmcnt(2)
    v_mfma_f32_16x16x32_bf16 v[12:15], v[132:135], v[152:155], v[12:15]
    v_mfma_f32_16x16x32_bf16 v[16:19], v[136:139], v[152:155], v[16:19]
    v_mfma_f32_16x16x32_bf16 v[20:23], v[140:143], v[152:155], v[20:23]
    ds_read_b128 v[152:155], v245 offset:49152
    s_waitcnt lgkmcnt(2)
    v_mfma_f32_16x16x32_bf16 v[36:39], v[132:135], v[144:147], v[36:39]
    v_mfma_f32_16x16x32_bf16 v[40:43], v[136:139], v[144:147], v[40:43]
    v_mfma_f32_16x16x32_bf16 v[44:47], v[140:143], v[144:147], v[44:47]
    ds_read_b128 v[144:147], v245 offset:51200
    s_waitcnt lgkmcnt(2)
    v_mfma_f32_16x16x32_bf16 v[60:63], v[132:135], v[148:151], v[60:63]
    v_mfma_f32_16x16x32_bf16 v[64:67], v[136:139], v[148:151], v[64:67]
    v_mfma_f32_16x16x32_bf16 v[68:71], v[140:143], v[148:151], v[68:71]
    s_waitcnt lgkmcnt(1)
    v_mfma_f32_16x16x32_bf16 v[84:87], v[132:135], v[152:155], v[84:87]
    v_mfma_f32_16x16x32_bf16 v[88:91], v[136:139], v[152:155], v[88:91]
    v_mfma_f32_16x16x32_bf16 v[92:95], v[140:143], v[152:155], v[92:95]
    s_waitcnt lgkmcnt(0)
    v_mfma_f32_16x16x32_bf16 v[108:111], v[132:135], v[144:147], v[108:111]
    v_mfma_f32_16x16x32_bf16 v[112:115], v[136:139], v[144:147], v[112:115]
    v_mfma_f32_16x16x32_bf16 v[116:119], v[140:143], v[144:147], v[116:119]
    s_waitcnt vmcnt(6)
    s_barrier
    ds_read_b64_tr_b16 v[120:121], v246 offset:49152
    ds_read_b64_tr_b16 v[122:123], v246 offset:49664
    ds_read_b64_tr_b16 v[124:125], v247 offset:49152
    ds_read_b64_tr_b16 v[126:127], v247 offset:49664
    ds_read_b64_tr_b16 v[128:129], v248 offset:49152
    ds_read_b64_tr_b16 v[130:131], v248 offset:49664
    ds_read_b128 v[144:147], v244
    ds_read_b128 v[148:151], v244 offset:2048
    ds_read_b128 v[152:155], v244 offset:4096
    ds_read_b64_tr_b16 v[132:133], v246 offset:61440
    ds_read_b64_tr_b16 v[134:135], v246 offset:61952
    ds_read_b64_tr_b16 v[136:137], v247 offset:61440
    ds_read_b64_tr_b16 v[138:139], v247 offset:61952
    ds_read_b64_tr_b16 v[140:141], v248 offset:61440
    ds_read_b64_tr_b16 v[142:143], v248 offset:61952
    s_waitcnt lgkmcnt(8)
    v_mfma_f32_16x16x32_bf16 v[12:15], v[120:123], v[144:147], v[12:15]
    s_add_u32 s45, s33, 5505024
    s_add_u32 m0, s30, 24576
    s_nop 0
    buffer_load_dwordx4 v242, s[16:19], s45 offen lds
    v_mfma_f32_16x16x32_bf16 v[16:19], v[124:127], v[144:147], v[16:19]
    s_add_u32 m0, s30, 25472
    s_nop 0
    buffer_load_dwordx4 v242, s[16:19], s45 offen offset:128 lds
    v_mfma_f32_16x16x32_bf16 v[20:23], v[128:131], v[144:147], v[20:23]
    s_add_u32 m0, s30, 26368
    s_nop 0
    buffer_load_dwordx4 v242, s[16:19], s45 offen offset:256 lds
    ds_read_b128 v[144:147], v244 offset:6144
    s_waitcnt lgkmcnt(8)
    v_mfma_f32_16x16x32_bf16 v[36:39], v[120:123], v[148:151], v[36:39]
    s_add_u32 s46, s34, 896
    s_add_u32 m0, s31, 141312
    s_nop 0
    buffer_load_dwordx4 v243, s[20:23], s46 offen lds
    s_add_u32 s46, s34, 10112
    buffer_load_dwordx4 v243, s[20:23], s46 offen offset:1024 lds
    s_add_u32 s46, s34, 19328
    s_mov_b64 exec, 0xffff
    buffer_load_dwordx4 v243, s[20:23], s46 offen offset:2048 lds
    s_mov_b64 exec, -1
    v_mfma_f32_16x16x32_bf16 v[40:43], v[124:127], v[148:151], v[40:43]
    v_mfma_f32_16x16x32_bf16 v[44:47], v[128:131], v[148:151], v[44:47]
    ds_read_b128 v[148:151], v244 offset:8192
    s_waitcnt lgkmcnt(8)
    v_mfma_f32_16x16x32_bf16 v[60:63], v[120:123], v[152:155], v[60:63]
    v_mfma_f32_16x16x32_bf16 v[64:67], v[124:127], v[152:155], v[64:67]
    v_mfma_f32_16x16x32_bf16 v[68:71], v[128:131], v[152:155], v[68:71]
    ds_read_b128 v[152:155], v245
    s_waitcnt lgkmcnt(2)
    v_mfma_f32_16x16x32_bf16 v[84:87], v[120:123], v[144:147], v[84:87]
    v_mfma_f32_16x16x32_bf16 v[88:91], v[124:127], v[144:147], v[88:91]
    v_mfma_f32_16x16x32_bf16 v[92:95], v[128:131], v[144:147], v[92:95]
    ds_read_b128 v[144:147], v245 offset:2048
    s_waitcnt lgkmcnt(2)
    v_mfma_f32_16x16x32_bf16 v[108:111], v[120:123], v[148:151], v[108:111]
    v_mfma_f32_16x16x32_bf16 v[112:115], v[124:127], v[148:151], v[112:115]
    v_mfma_f32_16x16x32_bf16 v[116:119], v[128:131], v[148:151], v[116:119]
    ds_read_b128 v[148:151], v245 offset:4096
    s_waitcnt lgkmcnt(2)
    v_mfma_f32_16x16x32_bf16 v[12:15], v[132:135], v[152:155], v[12:15]
    v_mfma_f32_16x16x32_bf16 v[16:19], v[136:139], v[152:155], v[16:19]
    v_mfma_f32_16x16x32_bf16 v[20:23], v[140:143], v[152:155], v[20:23]
    ds_read_b128 v[152:155], v245 offset:6144
    s_waitcnt lgkmcnt(2)
    v_mfma_f32_16x16x32_bf16 v[36:39], v[132:135], v[144:147], v[36:39]
    v_mfma_f32_16x16x32_bf16 v[40:43], v[136:139], v[144:147], v[40:43]
    v_mfma_f32_16x16x32_bf16 v[44:47], v[140:143], v[144:147], v[44:47]
    ds_read_b128 v[144:147], v245 offset:8192
    s_waitcnt lgkmcnt(2)
    v_mfma_f32_16x16x32_bf16 v[60:63], v[132:135], v[148:151], v[60:63]
    v_mfma_f32_16x16x32_bf16 v[64:67], v[136:139], v[148:151], v[64:67]
    v_mfma_f32_16x16x32_bf16 v[68:71], v[140:143], v[148:151], v[68:71]
    s_waitcnt lgkmcnt(1)
    v_mfma_f32_16x16x32_bf16 v[84:87], v[132:135], v[152:155], v[84:87]
    v_mfma_f32_16x16x32_bf16 v[88:91], v[136:139], v[152:155], v[88:91]
    v_mfma_f32_16x16x32_bf16 v[92:95], v[140:143], v[152:155], v[92:95]
    s_waitcnt lgkmcnt(0)
    v_mfma_f32_16x16x32_bf16 v[108:111], v[132:135], v[144:147], v[108:111]
    v_mfma_f32_16x16x32_bf16 v[112:115], v[136:139], v[144:147], v[112:115]
    v_mfma_f32_16x16x32_bf16 v[116:119], v[140:143], v[144:147], v[116:119]
    s_waitcnt vmcnt(6)
    s_barrier
    ds_read_b64_tr_b16 v[120:121], v246
    ds_read_b64_tr_b16 v[122:123], v246 offset:512
    ds_read_b64_tr_b16 v[124:125], v247
    ds_read_b64_tr_b16 v[126:127], v247 offset:512
    ds_read_b64_tr_b16 v[128:129], v248
    ds_read_b64_tr_b16 v[130:131], v248 offset:512
    ds_read_b128 v[144:147], v244 offset:24576
    ds_read_b128 v[148:151], v244 offset:26624
    ds_read_b128 v[152:155], v244 offset:28672
    ds_read_b64_tr_b16 v[132:133], v246 offset:12288
    ds_read_b64_tr_b16 v[134:135], v246 offset:12800
    ds_read_b64_tr_b16 v[136:137], v247 offset:12288
    ds_read_b64_tr_b16 v[138:139], v247 offset:12800
    ds_read_b64_tr_b16 v[140:141], v248 offset:12288
    ds_read_b64_tr_b16 v[142:143], v248 offset:12800
    s_waitcnt lgkmcnt(8)
    v_mfma_f32_16x16x32_bf16 v[12:15], v[120:123], v[144:147], v[12:15]
    s_add_u32 s45, s33, 6291456
    s_add_u32 m0, s30, 49152
    s_nop 0
    buffer_load_dwordx4 v242, s[16:19], s45 offen lds
    v_mfma_f32_16x16x32_bf16 v[16:19], v[124:127], v[144:147], v[16:19]
    s_add_u32 m0, s30, 50048
    s_nop 0
    buffer_load_dwordx4 v242, s[16:19], s45 offen offset:128 lds
    v_mfma_f32_16x16x32_bf16 v[20:23], v[128:131], v[144:147], v[20:23]
    s_add_u32 m0, s30, 50944
    s_nop 0
    buffer_load_dwordx4 v242, s[16:19], s45 offen offset:256 lds
    ds_read_b128 v[144:147], v244 offset:30720
    s_waitcnt lgkmcnt(8)
    v_mfma_f32_16x16x32_bf16 v[36:39], v[120:123], v[148:151], v[36:39]
    v_mfma_f32_16x16x32_bf16 v[40:43], v[124:127], v[148:151], v[40:43]
    v_mfma_f32_16x16x32_bf16 v[44:47], v[128:131], v[148:151], v[44:47]
    ds_read_b128 v[148:151], v244 offset:32768
    s_waitcnt lgkmcnt(8)
    v_mfma_f32_16x16x32_bf16 v[60:63], v[120:123], v[152:155], v[60:63]
    v_mfma_f32_16x16x32_bf16 v[64:67], v[124:127], v[152:155], v[64:67]
    v_mfma_f32_16x16x32_bf16 v[68:71], v[128:131], v[152:155], v[68:71]
    ds_read_b128 v[152:155], v245 offset:24576
    s_waitcnt lgkmcnt(2)
    v_mfma_f32_16x16x32_bf16 v[84:87], v[120:123], v[144:147], v[84:87]
    v_mfma_f32_16x16x32_bf16 v[88:91], v[124:127], v[144:147], v[88:91]
    v_mfma_f32_16x16x32_bf16 v[92:95], v[128:131], v[144:147], v[92:95]
    ds_read_b128 v[144:147], v245 offset:26624
    s_waitcnt lgkmcnt(2)
    v_mfma_f32_16x16x32_bf16 v[108:111], v[120:123], v[148:151], v[108:111]
    v_mfma_f32_16x16x32_bf16 v[112:115], v[124:127], v[148:151], v[112:115]
    v_mfma_f32_16x16x32_bf16 v[116:119], v[128:131], v[148:151], v[116:119]
    ds_read_b128 v[148:151], v245 offset:28672
    s_waitcnt lgkmcnt(2)
    v_mfma_f32_16x16x32_bf16 v[12:15], v[132:135], v[152:155], v[12:15]
    v_mfma_f32_16x16x32_bf16 v[16:19], v[136:139], v[152:155], v[16:19]
    v_mfma_f32_16x16x32_bf16 v[20:23], v[140:143], v[152:155], v[20:23]
    ds_read_b128 v[152:155], v245 offset:30720
    s_waitcnt lgkmcnt(2)
    v_mfma_f32_16x16x32_bf16 v[36:39], v[132:135], v[144:147], v[36:39]
    v_mfma_f32_16x16x32_bf16 v[40:43], v[136:139], v[144:147], v[40:43]
    v_mfma_f32_16x16x32_bf16 v[44:47], v[140:143], v[144:147], v[44:47]
    ds_read_b128 v[144:147], v245 offset:32768
    s_waitcnt lgkmcnt(2)
    v_mfma_f32_16x16x32_bf16 v[60:63], v[132:135], v[148:151], v[60:63]
    v_mfma_f32_16x16x32_bf16 v[64:67], v[136:139], v[148:151], v[64:67]
    v_mfma_f32_16x16x32_bf16 v[68:71], v[140:143], v[148:151], v[68:71]
    s_waitcnt lgkmcnt(1)
    v_mfma_f32_16x16x32_bf16 v[84:87], v[132:135], v[152:155], v[84:87]
    v_mfma_f32_16x16x32_bf16 v[88:91], v[136:139], v[152:155], v[88:91]
    v_mfma_f32_16x16x32_bf16 v[92:95], v[140:143], v[152:155], v[92:95]
    s_waitcnt lgkmcnt(0)
    v_mfma_f32_16x16x32_bf16 v[108:111], v[132:135], v[144:147], v[108:111]
    v_mfma_f32_16x16x32_bf16 v[112:115], v[136:139], v[144:147], v[112:115]
    v_mfma_f32_16x16x32_bf16 v[116:119], v[140:143], v[144:147], v[116:119]
    s_waitcnt vmcnt(3)
    s_barrier
    ds_read_b64_tr_b16 v[120:121], v246 offset:24576
    ds_read_b64_tr_b16 v[122:123], v246 offset:25088
    ds_read_b64_tr_b16 v[124:125], v247 offset:24576
    ds_read_b64_tr_b16 v[126:127], v247 offset:25088
    ds_read_b64_tr_b16 v[128:129], v248 offset:24576
    ds_read_b64_tr_b16 v[130:131], v248 offset:25088
    ds_read_b128 v[144:147], v244 offset:43008
    ds_read_b128 v[148:151], v244 offset:45056
    ds_read_b128 v[152:155], v244 offset:47104
    ds_read_b64_tr_b16 v[132:133], v246 offset:36864
    ds_read_b64_tr_b16 v[134:135], v246 offset:37376
    ds_read_b64_tr_b16 v[136:137], v247 offset:36864
    ds_read_b64_tr_b16 v[138:139], v247 offset:37376
    ds_read_b64_tr_b16 v[140:141], v248 offset:36864
    ds_read_b64_tr_b16 v[142:143], v248 offset:37376
    s_waitcnt lgkmcnt(8)
    v_mfma_f32_16x16x32_bf16 v[12:15], v[120:123], v[144:147], v[12:15]
    s_add_u32 s45, s33, 7077888
    s_add_u32 m0, s30, 0
    s_nop 0
    buffer_load_dwordx4 v242, s[16:19], s45 offen lds
    v_mfma_f32_16x16x32_bf16 v[16:19], v[124:127], v[144:147], v[16:19]
    s_add_u32 m0, s30, 896
    s_nop 0
    buffer_load_dwordx4 v242, s[16:19], s45 offen offset:128 lds
    v_mfma_f32_16x16x32_bf16 v[20:23], v[128:131], v[144:147], v[20:23]
    s_add_u32 m0, s30, 1792
    s_nop 0
    buffer_load_dwordx4 v242, s[16:19], s45 offen offset:256 lds
    ds_read_b128 v[144:147], v244 offset:49152
    s_waitcnt lgkmcnt(8)
    v_mfma_f32_16x16x32_bf16 v[36:39], v[120:123], v[148:151], v[36:39]
    s_add_u32 s46, s34, 1024
    s_add_u32 m0, s31, 122880
    s_nop 0
    buffer_load_dwordx4 v243, s[20:23], s46 offen lds
    s_add_u32 s46, s34, 10240
    buffer_load_dwordx4 v243, s[20:23], s46 offen offset:1024 lds
    s_add_u32 s46, s34, 19456
    s_mov_b64 exec, 0xffff
    buffer_load_dwordx4 v243, s[20:23], s46 offen offset:2048 lds
    s_mov_b64 exec, -1
    v_mfma_f32_16x16x32_bf16 v[40:43], v[124:127], v[148:151], v[40:43]
    v_mfma_f32_16x16x32_bf16 v[44:47], v[128:131], v[148:151], v[44:47]
    ds_read_b128 v[148:151], v244 offset:51200
    s_waitcnt lgkmcnt(8)
    v_mfma_f32_16x16x32_bf16 v[60:63], v[120:123], v[152:155], v[60:63]
    v_mfma_f32_16x16x32_bf16 v[64:67], v[124:127], v[152:155], v[64:67]
    v_mfma_f32_16x16x32_bf16 v[68:71], v[128:131], v[152:155], v[68:71]
    ds_read_b128 v[152:155], v245 offset:43008
    s_waitcnt lgkmcnt(2)
    v_mfma_f32_16x16x32_bf16 v[84:87], v[120:123], v[144:147], v[84:87]
    v_mfma_f32_16x16x32_bf16 v[88:91], v[124:127], v[144:147], v[88:91]
    v_mfma_f32_16x16x32_bf16 v[92:95], v[128:131], v[144:147], v[92:95]
    ds_read_b128 v[144:147], v245 offset:45056
    s_waitcnt lgkmcnt(2)
    v_mfma_f32_16x16x32_bf16 v[108:111], v[120:123], v[148:151], v[108:111]
    v_mfma_f32_16x16x32_bf16 v[112:115], v[124:127], v[148:151], v[112:115]
    v_mfma_f32_16x16x32_bf16 v[116:119], v[128:131], v[148:151], v[116:119]
    ds_read_b128 v[148:151], v245 offset:47104
    s_waitcnt lgkmcnt(2)
    v_mfma_f32_16x16x32_bf16 v[12:15], v[132:135], v[152:155], v[12:15]
    v_mfma_f32_16x16x32_bf16 v[16:19], v[136:139], v[152:155], v[16:19]
    v_mfma_f32_16x16x32_bf16 v[20:23], v[140:143], v[152:155], v[20:23]
    ds_read_b128 v[152:155], v245 offset:49152
    s_waitcnt lgkmcnt(2)
    v_mfma_f32_16x16x32_bf16 v[36:39], v[132:135], v[144:147], v[36:39]
    v_mfma_f32_16x16x32_bf16 v[40:43], v[136:139], v[144:147], v[40:43]
    v_mfma_f32_16x16x32_bf16 v[44:47], v[140:143], v[144:147], v[44:47]
    ds_read_b128 v[144:147], v245 offset:51200
    s_waitcnt lgkmcnt(2)
    v_mfma_f32_16x16x32_bf16 v[60:63], v[132:135], v[148:151], v[60:63]
    v_mfma_f32_16x16x32_bf16 v[64:67], v[136:139], v[148:151], v[64:67]
    v_mfma_f32_16x16x32_bf16 v[68:71], v[140:143], v[148:151], v[68:71]
    s_waitcnt lgkmcnt(1)
    v_mfma_f32_16x16x32_bf16 v[84:87], v[132:135], v[152:155], v[84:87]
    v_mfma_f32_16x16x32_bf16 v[88:91], v[136:139], v[152:155], v[88:91]
    v_mfma_f32_16x16x32_bf16 v[92:95], v[140:143], v[152:155], v[92:95]
    s_waitcnt lgkmcnt(0)
    v_mfma_f32_16x16x32_bf16 v[108:111], v[132:135], v[144:147], v[108:111]
    v_mfma_f32_16x16x32_bf16 v[112:115], v[136:139], v[144:147], v[112:115]
    v_mfma_f32_16x16x32_bf16 v[116:119], v[140:143], v[144:147], v[116:119]
    s_waitcnt vmcnt(0)
    s_barrier
    ds_read_b64_tr_b16 v[120:121], v246 offset:49152
    ds_read_b64_tr_b16 v[122:123], v246 offset:49664
    ds_read_b64_tr_b16 v[124:125], v247 offset:49152
    ds_read_b64_tr_b16 v[126:127], v247 offset:49664
    ds_read_b64_tr_b16 v[128:129], v248 offset:49152
    ds_read_b64_tr_b16 v[130:131], v248 offset:49664
    ds_read_b128 v[144:147], v244 offset:24576
    ds_read_b128 v[148:151], v244 offset:26624
    ds_read_b128 v[152:155], v244 offset:28672
    ds_read_b64_tr_b16 v[132:133], v246 offset:61440
    ds_read_b64_tr_b16 v[134:135], v246 offset:61952
    ds_read_b64_tr_b16 v[136:137], v247 offset:61440
    ds_read_b64_tr_b16 v[138:139], v247 offset:61952
    ds_read_b64_tr_b16 v[140:141], v248 offset:61440
    ds_read_b64_tr_b16 v[142:143], v248 offset:61952
    s_waitcnt lgkmcnt(8)
    v_mfma_f32_16x16x32_bf16 v[12:15], v[120:123], v[144:147], v[12:15]
    s_add_u32 s46, s34, 1152
    s_add_u32 m0, s31, 141312
    s_nop 0
    buffer_load_dwordx4 v243, s[20:23], s46 offen lds
    s_add_u32 s46, s34, 10368
    buffer_load_dwordx4 v243, s[20:23], s46 offen offset:1024 lds
    s_add_u32 s46, s34, 19584
    s_mov_b64 exec, 0xffff
    buffer_load_dwordx4 v243, s[20:23], s46 offen offset:2048 lds
    s_mov_b64 exec, -1
    v_mfma_f32_16x16x32_bf16 v[16:19], v[124:127], v[144:147], v[16:19]
    s_add_u32 s45, s32, 24576
    s_add_u32 m0, s30, 98304
    s_nop 0
    buffer_load_dwordx4 v241, s[8:11], s45 offen nt lds
    v_mfma_f32_16x16x32_bf16 v[20:23], v[128:131], v[144:147], v[20:23]
    s_add_u32 m0, s30, 99200
    s_nop 0
    buffer_load_dwordx4 v241, s[8:11], s45 offen offset:128 nt lds
    ds_read_b128 v[144:147], v244 offset:30720
    s_waitcnt lgkmcnt(8)
    v_mfma_f32_16x16x32_bf16 v[36:39], v[120:123], v[148:151], v[36:39]
    s_add_u32 m0, s30, 100096
    s_nop 0
    buffer_load_dwordx4 v241, s[8:11], s45 offen offset:256 nt lds
    v_mfma_f32_16x16x32_bf16 v[40:43], v[124:127], v[148:151], v[40:43]
    s_add_u32 s45, s32, 0
    s_add_u32 m0, s30, 24576
    s_nop 0
    buffer_load_dwordx4 v241, s[12:15], s45 offen nt lds
    v_mfma_f32_16x16x32_bf16 v[44:47], v[128:131], v[148:151], v[44:47]
    s_add_u32 m0, s30, 25472
    s_nop 0
    buffer_load_dwordx4 v241, s[12:15], s45 offen offset:128 nt lds
    ds_read_b128 v[148:151], v244 offset:32768
    s_waitcnt lgkmcnt(8)
    v_mfma_f32_16x16x32_bf16 v[60:63], v[120:123], v[152:155], v[60:63]
    s_add_u32 m0, s30, 26368
    s_nop 0
    buffer_load_dwordx4 v241, s[12:15], s45 offen offset:256 nt lds
    v_mfma_f32_16x16x32_bf16 v[64:67], v[124:127], v[152:155], v[64:67]
    v_mfma_f32_16x16x32_bf16 v[68:71], v[128:131], v[152:155], v[68:71]
    ds_read_b128 v[152:155], v245 offset:24576
    s_waitcnt lgkmcnt(2)
    v_mfma_f32_16x16x32_bf16 v[84:87], v[120:123], v[144:147], v[84:87]
    v_mfma_f32_16x16x32_bf16 v[88:91], v[124:127], v[144:147], v[88:91]
    v_mfma_f32_16x16x32_bf16 v[92:95], v[128:131], v[144:147], v[92:95]
    ds_read_b128 v[144:147], v245 offset:26624
    s_waitcnt lgkmcnt(2)
    v_mfma_f32_16x16x32_bf16 v[108:111], v[120:123], v[148:151], v[108:111]
    v_mfma_f32_16x16x32_bf16 v[112:115], v[124:127], v[148:151], v[112:115]
    v_mfma_f32_16x16x32_bf16 v[116:119], v[128:131], v[148:151], v[116:119]
    ds_read_b128 v[148:151], v245 offset:28672
    s_waitcnt lgkmcnt(2)
    v_mfma_f32_16x16x32_bf16 v[12:15], v[132:135], v[152:155], v[12:15]
    v_mfma_f32_16x16x32_bf16 v[16:19], v[136:139], v[152:155], v[16:19]
    v_mfma_f32_16x16x32_bf16 v[20:23], v[140:143], v[152:155], v[20:23]
    ds_read_b128 v[152:155], v245 offset:30720
    s_waitcnt lgkmcnt(2)
    v_mfma_f32_16x16x32_bf16 v[36:39], v[132:135], v[144:147], v[36:39]
    v_mfma_f32_16x16x32_bf16 v[40:43], v[136:139], v[144:147], v[40:43]
    v_mfma_f32_16x16x32_bf16 v[44:47], v[140:143], v[144:147], v[44:47]
    ds_read_b128 v[144:147], v245 offset:32768
    s_waitcnt lgkmcnt(2)
    v_mfma_f32_16x16x32_bf16 v[60:63], v[132:135], v[148:151], v[60:63]
    v_mfma_f32_16x16x32_bf16 v[64:67], v[136:139], v[148:151], v[64:67]
    v_mfma_f32_16x16x32_bf16 v[68:71], v[140:143], v[148:151], v[68:71]
    s_waitcnt lgkmcnt(1)
    v_mfma_f32_16x16x32_bf16 v[84:87], v[132:135], v[152:155], v[84:87]
    v_mfma_f32_16x16x32_bf16 v[88:91], v[136:139], v[152:155], v[88:91]
    v_mfma_f32_16x16x32_bf16 v[92:95], v[140:143], v[152:155], v[92:95]
    s_waitcnt lgkmcnt(0)
    v_mfma_f32_16x16x32_bf16 v[108:111], v[132:135], v[144:147], v[108:111]
    v_mfma_f32_16x16x32_bf16 v[112:115], v[136:139], v[144:147], v[112:115]
    v_mfma_f32_16x16x32_bf16 v[116:119], v[140:143], v[144:147], v[116:119]
    s_waitcnt vmcnt(6)
    s_barrier
    ds_read_b64_tr_b16 v[120:121], v246
    ds_read_b64_tr_b16 v[122:123], v246 offset:512
    ds_read_b64_tr_b16 v[124:125], v247
    ds_read_b64_tr_b16 v[126:127], v247 offset:512
    ds_read_b64_tr_b16 v[128:129], v248
    ds_read_b64_tr_b16 v[130:131], v248 offset:512
    ds_read_b128 v[144:147], v244 offset:43008
    ds_read_b128 v[148:151], v244 offset:45056
    ds_read_b128 v[152:155], v244 offset:47104
    ds_read_b64_tr_b16 v[132:133], v246 offset:12288
    ds_read_b64_tr_b16 v[134:135], v246 offset:12800
    ds_read_b64_tr_b16 v[136:137], v247 offset:12288
    ds_read_b64_tr_b16 v[138:139], v247 offset:12800
    ds_read_b64_tr_b16 v[140:141], v248 offset:12288
    ds_read_b64_tr_b16 v[142:143], v248 offset:12800
    s_waitcnt lgkmcnt(8)
    v_mfma_f32_16x16x32_bf16 v[12:15], v[120:123], v[144:147], v[12:15]
    s_add_u32 s45, s32, 24576
    s_add_u32 m0, s30, 49152
    s_nop 0
    buffer_load_dwordx4 v241, s[12:15], s45 offen nt lds
    v_mfma_f32_16x16x32_bf16 v[16:19], v[124:127], v[144:147], v[16:19]
    s_add_u32 m0, s30, 50048
    s_nop 0
    buffer_load_dwordx4 v241, s[12:15], s45 offen offset:128 nt lds
    v_mfma_f32_16x16x32_bf16 v[20:23], v[128:131], v[144:147], v[20:23]
    s_add_u32 m0, s30, 50944
    s_nop 0
    buffer_load_dwordx4 v241, s[12:15], s45 offen offset:256 nt lds
    ds_read_b128 v[144:147], v244 offset:49152
    s_waitcnt lgkmcnt(8)
    v_mfma_f32_16x16x32_bf16 v[36:39], v[120:123], v[148:151], v[36:39]
    v_mfma_f32_16x16x32_bf16 v[40:43], v[124:127], v[148:151], v[40:43]
    v_mfma_f32_16x16x32_bf16 v[44:47], v[128:131], v[148:151], v[44:47]
    ds_read_b128 v[148:151], v244 offset:51200
    s_waitcnt lgkmcnt(8)
    v_mfma_f32_16x16x32_bf16 v[60:63], v[120:123], v[152:155], v[60:63]
    v_mfma_f32_16x16x32_bf16 v[64:67], v[124:127], v[152:155], v[64:67]
    v_mfma_f32_16x16x32_bf16 v[68:71], v[128:131], v[152:155], v[68:71]
    ds_read_b128 v[152:155], v245 offset:43008
    s_waitcnt lgkmcnt(2)
    v_mfma_f32_16x16x32_bf16 v[84:87], v[120:123], v[144:147], v[84:87]
    v_mfma_f32_16x16x32_bf16 v[88:91], v[124:127], v[144:147], v[88:91]
    v_mfma_f32_16x16x32_bf16 v[92:95], v[128:131], v[144:147], v[92:95]
    ds_read_b128 v[144:147], v245 offset:45056
    s_waitcnt lgkmcnt(2)
    v_mfma_f32_16x16x32_bf16 v[108:111], v[120:123], v[148:151], v[108:111]
    v_mfma_f32_16x16x32_bf16 v[112:115], v[124:127], v[148:151], v[112:115]
    v_mfma_f32_16x16x32_bf16 v[116:119], v[128:131], v[148:151], v[116:119]
    ds_read_b128 v[148:151], v245 offset:47104
    s_waitcnt lgkmcnt(2)
    v_mfma_f32_16x16x32_bf16 v[12:15], v[132:135], v[152:155], v[12:15]
    v_mfma_f32_16x16x32_bf16 v[16:19], v[136:139], v[152:155], v[16:19]
    v_mfma_f32_16x16x32_bf16 v[20:23], v[140:143], v[152:155], v[20:23]
    ds_read_b128 v[152:155], v245 offset:49152
    s_waitcnt lgkmcnt(2)
    v_mfma_f32_16x16x32_bf16 v[36:39], v[132:135], v[144:147], v[36:39]
    v_mfma_f32_16x16x32_bf16 v[40:43], v[136:139], v[144:147], v[40:43]
    v_mfma_f32_16x16x32_bf16 v[44:47], v[140:143], v[144:147], v[44:47]
    ds_read_b128 v[144:147], v245 offset:51200
    s_waitcnt lgkmcnt(2)
    v_mfma_f32_16x16x32_bf16 v[60:63], v[132:135], v[148:151], v[60:63]
    v_mfma_f32_16x16x32_bf16 v[64:67], v[136:139], v[148:151], v[64:67]
    v_mfma_f32_16x16x32_bf16 v[68:71], v[140:143], v[148:151], v[68:71]
    s_waitcnt lgkmcnt(1)
    v_mfma_f32_16x16x32_bf16 v[84:87], v[132:135], v[152:155], v[84:87]
    v_mfma_f32_16x16x32_bf16 v[88:91], v[136:139], v[152:155], v[88:91]
    v_mfma_f32_16x16x32_bf16 v[92:95], v[140:143], v[152:155], v[92:95]
    s_waitcnt lgkmcnt(0)
    v_mfma_f32_16x16x32_bf16 v[108:111], v[132:135], v[144:147], v[108:111]
    v_mfma_f32_16x16x32_bf16 v[112:115], v[136:139], v[144:147], v[112:115]
    v_mfma_f32_16x16x32_bf16 v[116:119], v[140:143], v[144:147], v[116:119]
    v_cvt_pk_bf16_f32 v12, v12, v13
    v_cvt_pk_bf16_f32 v13, v14, v15
    v_cvt_pk_bf16_f32 v16, v16, v17
    v_cvt_pk_bf16_f32 v17, v18, v19
    v_cvt_pk_bf16_f32 v20, v20, v21
    v_cvt_pk_bf16_f32 v21, v22, v23
    v_cvt_pk_bf16_f32 v36, v36, v37
    v_cvt_pk_bf16_f32 v37, v38, v39
    v_cvt_pk_bf16_f32 v40, v40, v41
    v_cvt_pk_bf16_f32 v41, v42, v43
    v_cvt_pk_bf16_f32 v44, v44, v45
    v_cvt_pk_bf16_f32 v45, v46, v47
    v_cvt_pk_bf16_f32 v60, v60, v61
    v_cvt_pk_bf16_f32 v61, v62, v63
    v_cvt_pk_bf16_f32 v64, v64, v65
    v_cvt_pk_bf16_f32 v65, v66, v67
    v_cvt_pk_bf16_f32 v68, v68, v69
    v_cvt_pk_bf16_f32 v69, v70, v71
    v_cvt_pk_bf16_f32 v84, v84, v85
    v_cvt_pk_bf16_f32 v85, v86, v87
    v_cvt_pk_bf16_f32 v88, v88, v89
    v_cvt_pk_bf16_f32 v89, v90, v91
    v_cvt_pk_bf16_f32 v92, v92, v93
    v_cvt_pk_bf16_f32 v93, v94, v95
    v_cvt_pk_bf16_f32 v108, v108, v109
    v_cvt_pk_bf16_f32 v109, v110, v111
    v_cvt_pk_bf16_f32 v112, v112, v113
    v_cvt_pk_bf16_f32 v113, v114, v115
    v_cvt_pk_bf16_f32 v116, v116, v117
    v_cvt_pk_bf16_f32 v117, v118, v119
    v_and_b32 v188, 15, v240
    v_lshrrev_b32 v189, 4, v240
    v_mul_u32_u24 v190, 208, v188
    v_add_u32 v190, 122880, v190
    v_lshl_add_u32 v194, v189, 4, v190
    v_lshl_add_u32 v190, v189, 3, v190
    s_sub_u32 s45, s38, 6
    s_cmp_ge_u32 s38, 6
    s_cselect_b32 s45, s45, s38
    s_lshl_b32 s45, s45, 5
    v_add_u32 v191, s45, v190
    s_sub_u32 s45, s39, 6
    s_cmp_ge_u32 s39, 6
    s_cselect_b32 s45, s45, s39
    s_lshl_b32 s45, s45, 5
    v_add_u32 v192, s45, v190
    s_sub_u32 s45, s40, 6
    s_cmp_ge_u32 s40, 6
    s_cselect_b32 s45, s45, s40
    s_lshl_b32 s45, s45, 5
    v_add_u32 v193, s45, v190
    s_barrier
    s_add_u32 s45, s32, 49152
    s_add_u32 m0, s30, 0
    s_nop 0
    buffer_load_dwordx4 v241, s[12:15], s45 offen nt lds
    s_add_u32 m0, s30, 896
    s_nop 0
    buffer_load_dwordx4 v241, s[12:15], s45 offen offset:128 nt lds
    s_add_u32 m0, s30, 1792
    s_nop 0
    buffer_load_dwordx4 v241, s[12:15], s45 offen offset:256 nt lds
    s_cmp_ge_u32 s29, 2
    s_cbranch_scc1 L_exA_0
    ds_write_b64 v191, v[12:13]
    ds_write_b64 v192, v[16:17]
    ds_write_b64 v193, v[20:21]
    ds_write_b64 v191, v[36:37] offset:3328
    ds_write_b64 v192, v[40:41] offset:3328
    ds_write_b64 v193, v[44:45] offset:3328
    ds_write_b64 v191, v[60:61] offset:6656
    ds_write_b64 v192, v[64:65] offset:6656
    ds_write_b64 v193, v[68:69] offset:6656
    ds_write_b64 v191, v[84:85] offset:9984
    ds_write_b64 v192, v[88:89] offset:9984
    ds_write_b64 v193, v[92:93] offset:9984
    ds_write_b64 v191, v[108:109] offset:13312
    ds_write_b64 v192, v[112:113] offset:13312
    ds_write_b64 v193, v[116:117] offset:13312
    s_waitcnt lgkmcnt(0)
L_exA_0:
    s_nop 9
    s_barrier
    ds_read_b128 v[0:3], v194
    ds_read_b128 v[4:7], v194 offset:64
    ds_read_b128 v[8:11], v194 offset:128
    ds_read_b128 v[24:27], v194 offset:3328
    ds_read_b128 v[28:31], v194 offset:3392
    ds_read_b128 v[32:35], v194 offset:3456
    ds_read_b128 v[48:51], v194 offset:6656
    ds_read_b128 v[52:55], v194 offset:6720
    ds_read_b128 v[56:59], v194 offset:6784
    ds_read_b128 v[72:75], v194 offset:9984
    ds_read_b128 v[76:79], v194 offset:10048
    ds_read_b128 v[80:83], v194 offset:10112
    ds_read_b128 v[96:99], v194 offset:13312
    ds_read_b128 v[100:103], v194 offset:13376
    ds_read_b128 v[104:107], v194 offset:13440
    s_waitcnt lgkmcnt(0)
    s_barrier
    s_cmp_ge_u32 s29, 2
    s_cbranch_scc0 L_exB_0
    ds_write_b64 v191, v[12:13]
    ds_write_b64 v192, v[16:17]
    ds_write_b64 v193, v[20:21]
    ds_write_b64 v191, v[36:37] offset:3328
    ds_write_b64 v192, v[40:41] offset:3328
    ds_write_b64 v193, v[44:45] offset:3328
    ds_write_b64 v191, v[60:61] offset:6656
    ds_write_b64 v192, v[64:65] offset:6656
    ds_write_b64 v193, v[68:69] offset:6656
    ds_write_b64 v191, v[84:85] offset:9984
    ds_write_b64 v192, v[88:89] offset:9984
    ds_write_b64 v193, v[92:93] offset:9984
    ds_write_b64 v191, v[108:109] offset:13312
    ds_write_b64 v192, v[112:113] offset:13312
    ds_write_b64 v193, v[116:117] offset:13312
    s_waitcnt lgkmcnt(0)
L_exB_0:
    s_nop 9
    s_barrier
    ds_read_b128 v[12:15], v194
    ds_read_b128 v[16:19], v194 offset:64
    ds_read_b128 v[20:23], v194 offset:128
    ds_read_b128 v[36:39], v194 offset:3328
    ds_read_b128 v[40:43], v194 offset:3392
    ds_read_b128 v[44:47], v194 offset:3456
    ds_read_b128 v[60:63], v194 offset:6656
    ds_read_b128 v[64:67], v194 offset:6720
    ds_read_b128 v[68:71], v194 offset:6784
    ds_read_b128 v[84:87], v194 offset:9984
    ds_read_b128 v[88:91], v194 offset:10048
    ds_read_b128 v[92:95], v194 offset:10112
    ds_read_b128 v[108:111], v194 offset:13312
    ds_read_b128 v[112:115], v194 offset:13376
    ds_read_b128 v[116:119], v194 offset:13440
    v_and_b32 v188, 15, v240
    v_lshrrev_b32 v189, 4, v240
    v_bfe_u32 v190, v240, 2, 2
    v_and_b32 v191, 3, v240
    v_lshrrev_b32 v192, 1, v190
    v_lshl_add_u32 v192, v189, 1, v192
    v_and_b32 v192, 3, v192
    v_lshlrev_b32 v192, 1, v192
    v_lshrrev_b32 v193, 1, v189
    v_mul_u32_u24 v195, 3072, v193
    v_and_b32 v193, 1, v189
    v_lshl_add_u32 v193, v193, 2, v190
    v_lshl_add_u32 v195, v193, 7, v195
    v_and_b32 v193, 1, v191
    v_lshl_add_u32 v195, v193, 3, v195
    v_lshrrev_b32 v191, 1, v191
    s_lshl_b32 s45, s38, 1
    v_add_u32 v193, s45, v191
    v_lshrrev_b32 v194, 3, v193
    v_and_b32 v193, 7, v193
    v_xor_b32 v193, v193, v192
    v_lshl_add_u32 v193, v193, 4, v195
    v_lshl_add_u32 v246, v194, 10, v193
    s_lshl_b32 s45, s39, 1
    v_add_u32 v193, s45, v191
    v_lshrrev_b32 v194, 3, v193
    v_and_b32 v193, 7, v193
    v_xor_b32 v193, v193, v192
    v_lshl_add_u32 v193, v193, 4, v195
    v_lshl_add_u32 v247, v194, 10, v193
    s_lshl_b32 s45, s40, 1
    v_add_u32 v193, s45, v191
    v_lshrrev_b32 v194, 3, v193
    v_and_b32 v193, 7, v193
    v_xor_b32 v193, v193, v192
    v_lshl_add_u32 v193, v193, 4, v195
    v_lshl_add_u32 v248, v194, 10, v193
    v_and_b32 v188, 15, v240
    v_lshrrev_b32 v189, 4, v240
    v_and_b32 v190, 6, v188
    v_xor_b32 v191, v189, v190
    v_lshlrev_b32 v191, 4, v191
    v_and_b32 v192, 7, v188
    v_lshl_add_u32 v191, v192, 7, v191
    v_lshrrev_b32 v192, 3, v188
    v_mul_u32_u24 v192, 3072, v192
    s_mul_i32 s45, s29, 6144
    s_add_u32 s45, s45, 73728
    v_add3_u32 v244, v191, v192, s45
    v_xor_b32 v245, 64, v244
    v_mov_b32 v229, 0xff800000
    v_mov_b32 v230, 0
    v_mov_b32 v224, 0xff800000
    v_mov_b32 v231, 0
    v_mov_b32 v225, 0xff800000
    v_mov_b32 v232, 0
    v_mov_b32 v226, 0xff800000
    v_mov_b32 v233, 0
    v_mov_b32 v227, 0xff800000
    v_mov_b32 v234, 0
    ds_read_b128 v[188:191], v244
    ds_read_b128 v[192:195], v245
    ds_read_b128 v[208:211], v244 offset:1024
    ds_read_b128 v[212:215], v245 offset:1024
    ds_read_b128 v[216:219], v244 offset:2048
    s_waitcnt lgkmcnt(4)
    v_mfma_f32_16x16x32_bf16 v[168:171], v[188:191], v[0:3], 0
    v_mfma_f32_16x16x32_bf16 v[172:175], v[188:191], v[24:27], 0
    v_mfma_f32_16x16x32_bf16 v[176:179], v[188:191], v[48:51], 0
    v_mfma_f32_16x16x32_bf16 v[180:183], v[188:191], v[72:75], 0
    v_mfma_f32_16x16x32_bf16 v[184:187], v[188:191], v[96:99], 0
    ds_read_b128 v[188:191], v245 offset:2048
    s_waitcnt lgkmcnt(4)
    v_mfma_f32_16x16x32_bf16 v[168:171], v[192:195], v[4:7], v[168:171]
    v_mfma_f32_16x16x32_bf16 v[172:175], v[192:195], v[28:31], v[172:175]
    v_mfma_f32_16x16x32_bf16 v[176:179], v[192:195], v[52:55], v[176:179]
    v_mfma_f32_16x16x32_bf16 v[180:183], v[192:195], v[76:79], v[180:183]
    v_mfma_f32_16x16x32_bf16 v[184:187], v[192:195], v[100:103], v[184:187]
    s_waitcnt lgkmcnt(3)
    v_mfma_f32_16x16x32_bf16 v[168:171], v[208:211], v[8:11], v[168:171]
    v_mfma_f32_16x16x32_bf16 v[172:175], v[208:211], v[32:35], v[172:175]
    v_mfma_f32_16x16x32_bf16 v[176:179], v[208:211], v[56:59], v[176:179]
    v_mfma_f32_16x16x32_bf16 v[180:183], v[208:211], v[80:83], v[180:183]
    v_mfma_f32_16x16x32_bf16 v[184:187], v[208:211], v[104:107], v[184:187]
    s_waitcnt lgkmcnt(2)
    v_mfma_f32_16x16x32_bf16 v[168:171], v[212:215], v[12:15], v[168:171]
    v_mfma_f32_16x16x32_bf16 v[172:175], v[212:215], v[36:39], v[172:175]
    v_mfma_f32_16x16x32_bf16 v[176:179], v[212:215], v[60:63], v[176:179]
    v_mfma_f32_16x16x32_bf16 v[180:183], v[212:215], v[84:87], v[180:183]
    v_mfma_f32_16x16x32_bf16 v[184:187], v[212:215], v[108:111], v[184:187]
    s_waitcnt lgkmcnt(1)
    v_mfma_f32_16x16x32_bf16 v[168:171], v[216:219], v[16:19], v[168:171]
    v_mfma_f32_16x16x32_bf16 v[172:175], v[216:219], v[40:43], v[172:175]
    v_mfma_f32_16x16x32_bf16 v[176:179], v[216:219], v[64:67], v[176:179]
    v_mfma_f32_16x16x32_bf16 v[180:183], v[216:219], v[88:91], v[180:183]
    v_mfma_f32_16x16x32_bf16 v[184:187], v[216:219], v[112:115], v[184:187]
    s_waitcnt lgkmcnt(0)
    v_mfma_f32_16x16x32_bf16 v[168:171], v[188:191], v[20:23], v[168:171]
    v_mfma_f32_16x16x32_bf16 v[172:175], v[188:191], v[44:47], v[172:175]
    v_mfma_f32_16x16x32_bf16 v[176:179], v[188:191], v[68:71], v[176:179]
    v_mfma_f32_16x16x32_bf16 v[180:183], v[188:191], v[92:95], v[180:183]
    v_mfma_f32_16x16x32_bf16 v[184:187], v[188:191], v[116:119], v[184:187]
    s_nop 3
    v_max3_f32 v253, v168, v169, v170
    v_max_f32 v253, v253, v171
    ds_max_f32 v251, v253 offset:12
    v_max3_f32 v254, v172, v173, v174
    v_max_f32 v254, v254, v175
    ds_max_f32 v251, v254 offset:16
    v_max3_f32 v253, v176, v177, v178
    v_max_f32 v253, v253, v179
    ds_max_f32 v251, v253 offset:20
    v_max3_f32 v254, v180, v181, v182
    v_max_f32 v254, v254, v183
    ds_max_f32 v251, v254 offset:24
    v_max3_f32 v253, v184, v185, v186
    v_max_f32 v253, v253, v187
    ds_max_f32 v251, v253 offset:28
    s_waitcnt vmcnt(9)
    s_waitcnt lgkmcnt(0)
    s_barrier
    ds_read_b32 v228, v251 offset:12
    ds_read_b128 v[220:223], v251 offset:16
    ds_read_b128 v[188:191], v244 offset:24576
    ds_read_b128 v[192:195], v245 offset:24576
    s_waitcnt lgkmcnt(3)
    v_mul_f32 v228, s37, v228
    s_waitcnt lgkmcnt(2)
    v_mul_f32 v220, s37, v220
    v_mul_f32 v221, s37, v221
    v_mul_f32 v222, s37, v222
    v_mul_f32 v223, s37, v223
    v_sub_f32 v235, v228, v229
    v_sub_f32 v236, v220, v224
    v_sub_f32 v237, v221, v225
    v_sub_f32 v238, v222, v226
    v_sub_f32 v239, v223, v227
    v_cmp_lt_f32 s[78:79], 4.0, v235
    v_cmp_lt_f32 s[80:81], 4.0, v236
    v_cmp_lt_f32 s[82:83], 4.0, v237
    v_cmp_lt_f32 s[84:85], 4.0, v238
    v_cmp_lt_f32 s[86:87], 4.0, v239
    v_cndmask_b32 v228, v229, v228, s[78:79]
    v_cndmask_b32 v220, v224, v220, s[80:81]
    v_cndmask_b32 v221, v225, v221, s[82:83]
    v_cndmask_b32 v222, v226, v222, s[84:85]
    v_cndmask_b32 v223, v227, v223, s[86:87]
    s_or_b64 s[76:77], s[78:79], s[80:81]
    s_or_b64 s[82:83], s[82:83], s[84:85]
    s_or_b64 s[76:77], s[76:77], s[86:87]
    s_or_b64 s[76:77], s[76:77], s[82:83]
    s_cbranch_scc0 L_nl_0_0
    v_sub_f32 v235, v229, v228
    v_sub_f32 v236, v224, v220
    v_sub_f32 v237, v225, v221
    v_sub_f32 v238, v226, v222
    v_sub_f32 v239, v227, v223
    v_exp_f32 v235, v235
    v_exp_f32 v236, v236
    v_exp_f32 v237, v237
    v_exp_f32 v238, v238
    v_exp_f32 v239, v239
    v_mul_f32 v230, v235, v230
    v_mul_f32 v231, v236, v231
    v_mul_f32 v232, v237, v232
    v_mul_f32 v233, v238, v233
    v_mul_f32 v234, v239, v234
L_nl_0_0:
    v_fma_f32 v168, v168, s37, -v228
    v_fma_f32 v169, v169, s37, -v228
    v_fma_f32 v170, v170, s37, -v228
    v_fma_f32 v171, v171, s37, -v228
    v_fma_f32 v172, v172, s37, -v220
    v_fma_f32 v173, v173, s37, -v220
    v_fma_f32 v174, v174, s37, -v220
    v_fma_f32 v175, v175, s37, -v220
    v_fma_f32 v176, v176, s37, -v221
    v_fma_f32 v177, v177, s37, -v221
    v_fma_f32 v178, v178, s37, -v221
    v_fma_f32 v179, v179, s37, -v221
    v_fma_f32 v180, v180, s37, -v222
    v_fma_f32 v181, v181, s37, -v222
    v_fma_f32 v182, v182, s37, -v222
    v_fma_f32 v183, v183, s37, -v222
    v_fma_f32 v184, v184, s37, -v223
    v_fma_f32 v185, v185, s37, -v223
    v_fma_f32 v186, v186, s37, -v223
    v_fma_f32 v187, v187, s37, -v223
    v_exp_f32 v168, v168
    v_exp_f32 v169, v169
    v_exp_f32 v170, v170
    v_exp_f32 v171, v171
    v_exp_f32 v172, v172
    v_exp_f32 v173, v173
    v_exp_f32 v174, v174
    v_exp_f32 v175, v175
    v_exp_f32 v176, v176
    v_exp_f32 v177, v177
    v_exp_f32 v178, v178
    v_exp_f32 v179, v179
    v_exp_f32 v180, v180
    v_exp_f32 v181, v181
    v_exp_f32 v182, v182
    v_exp_f32 v183, v183
    v_exp_f32 v184, v184
    v_exp_f32 v185, v185
    v_exp_f32 v186, v186
    v_exp_f32 v187, v187
    v_add_f32 v230, v230, v168
    v_add_f32 v252, v169, v170
    v_add_f32 v230, v230, v171
    v_cvt_pk_bf16_f32 v168, v168, v169
    v_add_f32 v230, v230, v252
    v_cvt_pk_bf16_f32 v169, v170, v171
    ds_write_b64 v250, v[168:169]
    v_add_f32 v231, v231, v172
    v_add_f32 v252, v173, v174
    v_add_f32 v231, v231, v175
    v_cvt_pk_bf16_f32 v172, v172, v173
    v_add_f32 v231, v231, v252
    v_cvt_pk_bf16_f32 v173, v174, v175
    ds_write_b64 v250, v[172:173] offset:2048
    v_add_f32 v232, v232, v176
    v_add_f32 v252, v177, v178
    v_add_f32 v232, v232, v179
    v_cvt_pk_bf16_f32 v176, v176, v177
    v_add_f32 v232, v232, v252
    v_cvt_pk_bf16_f32 v177, v178, v179
    ds_write_b64 v250, v[176:177] offset:4096
    v_add_f32 v233, v233, v180
    v_add_f32 v252, v181, v182
    v_add_f32 v233, v233, v183
    v_cvt_pk_bf16_f32 v180, v180, v181
    v_add_f32 v233, v233, v252
    v_cvt_pk_bf16_f32 v181, v182, v183
    ds_write_b64 v250, v[180:181] offset:6144
    v_add_f32 v234, v234, v184
    v_add_f32 v252, v185, v186
    v_add_f32 v234, v234, v187
    v_cvt_pk_bf16_f32 v184, v184, v185
    v_add_f32 v234, v234, v252
    v_cvt_pk_bf16_f32 v185, v186, v187
    ds_write_b64 v250, v[184:185] offset:8192
    ds_read_b128 v[208:211], v244 offset:25600
    ds_read_b128 v[212:215], v245 offset:25600
    ds_read_b128 v[216:219], v244 offset:26624
    s_waitcnt lgkmcnt(9)
    v_mfma_f32_16x16x32_bf16 v[168:171], v[188:191], v[0:3], 0
    s_add_u32 s45, s32, 49152
    s_add_u32 m0, s30, 73728
    s_nop 0
    buffer_load_dwordx4 v241, s[8:11], s45 offen nt lds
    v_mfma_f32_16x16x32_bf16 v[172:175], v[188:191], v[24:27], 0
    s_add_u32 m0, s30, 74624
    s_nop 0
    buffer_load_dwordx4 v241, s[8:11], s45 offen offset:128 nt lds
    v_mfma_f32_16x16x32_bf16 v[176:179], v[188:191], v[48:51], 0
    s_add_u32 m0, s30, 75520
    s_nop 0
    buffer_load_dwordx4 v241, s[8:11], s45 offen offset:256 nt lds
    v_mfma_f32_16x16x32_bf16 v[180:183], v[188:191], v[72:75], 0
    v_mfma_f32_16x16x32_bf16 v[184:187], v[188:191], v[96:99], 0
    ds_read_b128 v[188:191], v245 offset:26624
    s_waitcnt lgkmcnt(9)
    v_mfma_f32_16x16x32_bf16 v[168:171], v[192:195], v[4:7], v[168:171]
    v_mfma_f32_16x16x32_bf16 v[172:175], v[192:195], v[28:31], v[172:175]
    v_mfma_f32_16x16x32_bf16 v[176:179], v[192:195], v[52:55], v[176:179]
    v_mfma_f32_16x16x32_bf16 v[180:183], v[192:195], v[76:79], v[180:183]
    v_mfma_f32_16x16x32_bf16 v[184:187], v[192:195], v[100:103], v[184:187]
    s_waitcnt lgkmcnt(3)
    v_mfma_f32_16x16x32_bf16 v[168:171], v[208:211], v[8:11], v[168:171]
    v_mfma_f32_16x16x32_bf16 v[172:175], v[208:211], v[32:35], v[172:175]
    v_mfma_f32_16x16x32_bf16 v[176:179], v[208:211], v[56:59], v[176:179]
    v_mfma_f32_16x16x32_bf16 v[180:183], v[208:211], v[80:83], v[180:183]
    v_mfma_f32_16x16x32_bf16 v[184:187], v[208:211], v[104:107], v[184:187]
    s_waitcnt lgkmcnt(2)
    v_mfma_f32_16x16x32_bf16 v[168:171], v[212:215], v[12:15], v[168:171]
    v_mfma_f32_16x16x32_bf16 v[172:175], v[212:215], v[36:39], v[172:175]
    v_mfma_f32_16x16x32_bf16 v[176:179], v[212:215], v[60:63], v[176:179]
    v_mfma_f32_16x16x32_bf16 v[180:183], v[212:215], v[84:87], v[180:183]
    v_mfma_f32_16x16x32_bf16 v[184:187], v[212:215], v[108:111], v[184:187]
    s_waitcnt lgkmcnt(1)
    v_mfma_f32_16x16x32_bf16 v[168:171], v[216:219], v[16:19], v[168:171]
    v_mfma_f32_16x16x32_bf16 v[172:175], v[216:219], v[40:43], v[172:175]
    v_mfma_f32_16x16x32_bf16 v[176:179], v[216:219], v[64:67], v[176:179]
    v_mfma_f32_16x16x32_bf16 v[180:183], v[216:219], v[88:91], v[180:183]
    v_mfma_f32_16x16x32_bf16 v[184:187], v[216:219], v[112:115], v[184:187]
    s_waitcnt lgkmcnt(0)
    v_mfma_f32_16x16x32_bf16 v[168:171], v[188:191], v[20:23], v[168:171]
    v_mfma_f32_16x16x32_bf16 v[172:175], v[188:191], v[44:47], v[172:175]
    v_mfma_f32_16x16x32_bf16 v[176:179], v[188:191], v[68:71], v[176:179]
    v_mfma_f32_16x16x32_bf16 v[180:183], v[188:191], v[92:95], v[180:183]
    v_mfma_f32_16x16x32_bf16 v[184:187], v[188:191], v[116:119], v[184:187]
    s_nop 3
    v_max3_f32 v253, v168, v169, v170
    v_max_f32 v253, v253, v171
    ds_max_f32 v251, v253 offset:780
    v_max3_f32 v254, v172, v173, v174
    v_max_f32 v254, v254, v175
    ds_max_f32 v251, v254 offset:784
    v_max3_f32 v253, v176, v177, v178
    v_max_f32 v253, v253, v179
    ds_max_f32 v251, v253 offset:788
    v_max3_f32 v254, v180, v181, v182
    v_max_f32 v254, v254, v183
    ds_max_f32 v251, v254 offset:792
    v_max3_f32 v253, v184, v185, v186
    v_max_f32 v253, v253, v187
    ds_max_f32 v251, v253 offset:796
    s_waitcnt vmcnt(9)
    s_waitcnt lgkmcnt(0)
    s_barrier
    ds_read_b32 v229, v251 offset:780
    ds_read_b128 v[224:227], v251 offset:784
    v_add_u32 v246, 24576, v246
    v_add_u32 v247, 24576, v247
    v_add_u32 v248, 24576, v248
    ds_read_b64_tr_b16 v[196:197], v246
    ds_read_b64_tr_b16 v[198:199], v246 offset:6144
    ds_read_b64_tr_b16 v[200:201], v247
    ds_read_b64_tr_b16 v[202:203], v247 offset:6144
    ds_read_b64_tr_b16 v[204:205], v248
    ds_read_b64_tr_b16 v[206:207], v248 offset:6144
    ds_read_b128 v[208:211], v249
    ds_read_b128 v[212:215], v249 offset:2048
    ds_read_b128 v[216:219], v249 offset:4096
    s_waitcnt lgkmcnt(2)
    v_mfma_f32_16x16x32_bf16 v[120:123], v[196:199], v[208:211], 0
    v_mul_f32 v229, s37, v229
    v_mul_f32 v224, s37, v224
    v_mul_f32 v225, s37, v225
    v_mul_f32 v226, s37, v226
    v_mul_f32 v227, s37, v227
    s_add_u32 s45, s32, 73728
    s_add_u32 m0, s30, 98304
    s_nop 0
    buffer_load_dwordx4 v241, s[8:11], s45 offen nt lds
    v_mfma_f32_16x16x32_bf16 v[124:127], v[200:203], v[208:211], 0
    v_sub_f32 v235, v229, v228
    v_sub_f32 v236, v224, v220
    v_sub_f32 v237, v225, v221
    v_sub_f32 v238, v226, v222
    s_add_u32 m0, s30, 99200
    s_nop 0
    buffer_load_dwordx4 v241, s[8:11], s45 offen offset:128 nt lds
    v_mfma_f32_16x16x32_bf16 v[128:131], v[204:207], v[208:211], 0
    v_sub_f32 v239, v227, v223
    v_cmp_lt_f32 s[78:79], 4.0, v235
    v_cmp_lt_f32 s[80:81], 4.0, v236
    v_cmp_lt_f32 s[82:83], 4.0, v237
    s_add_u32 m0, s30, 100096
    s_nop 0
    buffer_load_dwordx4 v241, s[8:11], s45 offen offset:256 nt lds
    ds_read_b128 v[208:211], v249 offset:6144
    s_waitcnt lgkmcnt(2)
    v_mfma_f32_16x16x32_bf16 v[132:135], v[196:199], v[212:215], 0
    v_cmp_lt_f32 s[84:85], 4.0, v238
    v_cmp_lt_f32 s[86:87], 4.0, v239
    v_cndmask_b32 v229, v228, v229, s[78:79]
    v_cndmask_b32 v224, v220, v224, s[80:81]
    v_mfma_f32_16x16x32_bf16 v[136:139], v[200:203], v[212:215], 0
    v_cndmask_b32 v225, v221, v225, s[82:83]
    v_cndmask_b32 v226, v222, v226, s[84:85]
    v_cndmask_b32 v227, v223, v227, s[86:87]
    s_or_b64 s[76:77], s[78:79], s[80:81]
    s_or_b64 s[82:83], s[82:83], s[84:85]
    s_or_b64 s[76:77], s[76:77], s[86:87]
    s_or_b64 s[76:77], s[76:77], s[82:83]
    s_cbranch_scc0 L_nl_0_1
    v_sub_f32 v235, v228, v229
    v_sub_f32 v236, v220, v224
    v_sub_f32 v237, v221, v225
    v_sub_f32 v238, v222, v226
    v_sub_f32 v239, v223, v227
    v_exp_f32 v235, v235
    v_exp_f32 v236, v236
    v_exp_f32 v237, v237
    v_exp_f32 v238, v238
    v_exp_f32 v239, v239
    v_mul_f32 v230, v235, v230
    v_mul_f32 v231, v236, v231
    v_mul_f32 v232, v237, v232
    v_mul_f32 v233, v238, v233
    v_mul_f32 v234, v239, v234
L_nl_0_1:
    v_mfma_f32_16x16x32_bf16 v[140:143], v[204:207], v[212:215], 0
    v_fma_f32 v168, v168, s37, -v229
    v_fma_f32 v169, v169, s37, -v229
    v_fma_f32 v170, v170, s37, -v229
    v_fma_f32 v171, v171, s37, -v229
    v_fma_f32 v172, v172, s37, -v224
    ds_read_b128 v[212:215], v249 offset:1024
    s_waitcnt lgkmcnt(2)
    v_mfma_f32_16x16x32_bf16 v[144:147], v[196:199], v[216:219], 0
    v_fma_f32 v173, v173, s37, -v224
    v_fma_f32 v174, v174, s37, -v224
    v_fma_f32 v175, v175, s37, -v224
    v_fma_f32 v176, v176, s37, -v225
    v_mfma_f32_16x16x32_bf16 v[148:151], v[200:203], v[216:219], 0
    v_fma_f32 v177, v177, s37, -v225
    v_fma_f32 v178, v178, s37, -v225
    v_fma_f32 v179, v179, s37, -v225
    v_fma_f32 v180, v180, s37, -v226
    v_mfma_f32_16x16x32_bf16 v[152:155], v[204:207], v[216:219], 0
    v_fma_f32 v181, v181, s37, -v226
    v_fma_f32 v182, v182, s37, -v226
    v_fma_f32 v183, v183, s37, -v226
    v_fma_f32 v184, v184, s37, -v227
    ds_read_b128 v[216:219], v249 offset:3072
    s_waitcnt lgkmcnt(2)
    v_mfma_f32_16x16x32_bf16 v[156:159], v[196:199], v[208:211], 0
    v_fma_f32 v185, v185, s37, -v227
    v_fma_f32 v186, v186, s37, -v227
    v_fma_f32 v187, v187, s37, -v227
    v_exp_f32 v168, v168
    ds_read_b64_tr_b16 v[196:197], v246 offset:12288
    ds_read_b64_tr_b16 v[198:199], v246 offset:18432
    v_mfma_f32_16x16x32_bf16 v[160:163], v[200:203], v[208:211], 0
    v_exp_f32 v169, v169
    v_exp_f32 v170, v170
    v_exp_f32 v171, v171
    v_exp_f32 v172, v172
    ds_read_b64_tr_b16 v[200:201], v247 offset:12288
    ds_read_b64_tr_b16 v[202:203], v247 offset:18432
    v_mfma_f32_16x16x32_bf16 v[164:167], v[204:207], v[208:211], 0
    v_exp_f32 v173, v173
    v_exp_f32 v174, v174
    v_exp_f32 v175, v175
    v_exp_f32 v176, v176
    v_exp_f32 v177, v177
    ds_read_b64_tr_b16 v[204:205], v248 offset:12288
    ds_read_b64_tr_b16 v[206:207], v248 offset:18432
    ds_read_b128 v[208:211], v249 offset:5120
    s_waitcnt lgkmcnt(5)
    v_mfma_f32_16x16x32_bf16 v[120:123], v[196:199], v[212:215], v[120:123]
    v_exp_f32 v178, v178
    v_exp_f32 v179, v179
    v_exp_f32 v180, v180
    v_exp_f32 v181, v181
    s_waitcnt lgkmcnt(3)
    v_mfma_f32_16x16x32_bf16 v[124:127], v[200:203], v[212:215], v[124:127]
    v_exp_f32 v182, v182
    v_exp_f32 v183, v183
    v_exp_f32 v184, v184
    v_exp_f32 v185, v185
    s_waitcnt lgkmcnt(1)
    v_mfma_f32_16x16x32_bf16 v[128:131], v[204:207], v[212:215], v[128:131]
    v_exp_f32 v186, v186
    v_exp_f32 v187, v187
    v_add_f32 v230, v230, v168
    v_add_f32 v252, v169, v170
    ds_read_b128 v[212:215], v249 offset:7168
    v_mfma_f32_16x16x32_bf16 v[132:135], v[196:199], v[216:219], v[132:135]
    v_add_f32 v230, v230, v171
    v_cvt_pk_bf16_f32 v168, v168, v169
    v_add_f32 v230, v230, v252
    v_cvt_pk_bf16_f32 v169, v170, v171
    v_mfma_f32_16x16x32_bf16 v[136:139], v[200:203], v[216:219], v[136:139]
    ds_write_b64 v250, v[168:169] offset:18432
    v_add_f32 v231, v231, v172
    v_add_f32 v252, v173, v174
    v_add_f32 v231, v231, v175
    v_mfma_f32_16x16x32_bf16 v[140:143], v[204:207], v[216:219], v[140:143]
    v_cvt_pk_bf16_f32 v172, v172, v173
    v_add_f32 v231, v231, v252
    v_cvt_pk_bf16_f32 v173, v174, v175
    ds_write_b64 v250, v[172:173] offset:20480
    v_add_f32 v232, v232, v176
    s_waitcnt lgkmcnt(3)
    v_mfma_f32_16x16x32_bf16 v[144:147], v[196:199], v[208:211], v[144:147]
    v_add_f32 v252, v177, v178
    v_add_f32 v232, v232, v179
    v_cvt_pk_bf16_f32 v176, v176, v177
    v_add_f32 v232, v232, v252
    v_mfma_f32_16x16x32_bf16 v[148:151], v[200:203], v[208:211], v[148:151]
    v_cvt_pk_bf16_f32 v177, v178, v179
    ds_write_b64 v250, v[176:177] offset:22528
    v_add_f32 v233, v233, v180
    v_add_f32 v252, v181, v182
    v_mfma_f32_16x16x32_bf16 v[152:155], v[204:207], v[208:211], v[152:155]
    v_add_f32 v233, v233, v183
    v_cvt_pk_bf16_f32 v180, v180, v181
    v_add_f32 v233, v233, v252
    v_cvt_pk_bf16_f32 v181, v182, v183
    s_waitcnt lgkmcnt(3)
    v_mfma_f32_16x16x32_bf16 v[156:159], v[196:199], v[212:215], v[156:159]
    ds_write_b64 v250, v[180:181] offset:24576
    v_add_f32 v234, v234, v184
    v_add_f32 v252, v185, v186
    v_add_f32 v234, v234, v187
    v_mfma_f32_16x16x32_bf16 v[160:163], v[200:203], v[212:215], v[160:163]
    v_cvt_pk_bf16_f32 v184, v184, v185
    v_add_f32 v234, v234, v252
    v_cvt_pk_bf16_f32 v185, v186, v187
    ds_write_b64 v250, v[184:185] offset:26624
    v_mfma_f32_16x16x32_bf16 v[164:167], v[204:207], v[212:215], v[164:167]
    s_waitcnt vmcnt(3)
    s_waitcnt lgkmcnt(0)
    s_barrier
    ds_read_b128 v[188:191], v244
    ds_read_b128 v[192:195], v245
    ds_read_b128 v[208:211], v244 offset:1024
    ds_read_b128 v[212:215], v245 offset:1024
    ds_read_b128 v[216:219], v244 offset:2048
    s_cmp_eq_u64 s[76:77], 0
    s_cbranch_scc1 L_nr_0_1
    v_mul_f32 v120, v235, v120
    v_mul_f32 v121, v235, v121
    v_mul_f32 v122, v235, v122
    v_mul_f32 v123, v235, v123
    v_mul_f32 v124, v235, v124
    v_mul_f32 v125, v235, v125
    v_mul_f32 v126, v235, v126
    v_mul_f32 v127, v235, v127
    v_mul_f32 v128, v235, v128
    v_mul_f32 v129, v235, v129
    v_mul_f32 v130, v235, v130
    v_mul_f32 v131, v235, v131
    v_mul_f32 v132, v236, v132
    v_mul_f32 v133, v236, v133
    v_mul_f32 v134, v236, v134
    v_mul_f32 v135, v236, v135
    v_mul_f32 v136, v236, v136
    v_mul_f32 v137, v236, v137
    v_mul_f32 v138, v236, v138
    v_mul_f32 v139, v236, v139
    v_mul_f32 v140, v236, v140
    v_mul_f32 v141, v236, v141
    v_mul_f32 v142, v236, v142
    v_mul_f32 v143, v236, v143
    v_mul_f32 v144, v237, v144
    v_mul_f32 v145, v237, v145
    v_mul_f32 v146, v237, v146
    v_mul_f32 v147, v237, v147
    v_mul_f32 v148, v237, v148
    v_mul_f32 v149, v237, v149
    v_mul_f32 v150, v237, v150
    v_mul_f32 v151, v237, v151
    v_mul_f32 v152, v237, v152
    v_mul_f32 v153, v237, v153
    v_mul_f32 v154, v237, v154
    v_mul_f32 v155, v237, v155
    v_mul_f32 v156, v238, v156
    v_mul_f32 v157, v238, v157
    v_mul_f32 v158, v238, v158
    v_mul_f32 v159, v238, v159
    v_mul_f32 v160, v238, v160
    v_mul_f32 v161, v238, v161
    v_mul_f32 v162, v238, v162
    v_mul_f32 v163, v238, v163
    v_mul_f32 v164, v238, v164
    v_mul_f32 v165, v238, v165
    v_mul_f32 v166, v238, v166
    v_mul_f32 v167, v238, v167
L_nr_0_1:
    s_waitcnt lgkmcnt(4)
    v_mfma_f32_16x16x32_bf16 v[168:171], v[188:191], v[0:3], 0
    s_add_u32 s45, s32, 73728
    s_add_u32 m0, s30, 24576
    s_nop 0
    buffer_load_dwordx4 v241, s[12:15], s45 offen nt lds
    v_mfma_f32_16x16x32_bf16 v[172:175], v[188:191], v[24:27], 0
    s_add_u32 m0, s30, 25472
    s_nop 0
    buffer_load_dwordx4 v241, s[12:15], s45 offen offset:128 nt lds
    v_mfma_f32_16x16x32_bf16 v[176:179], v[188:191], v[48:51], 0
    s_add_u32 m0, s30, 26368
    s_nop 0
    buffer_load_dwordx4 v241, s[12:15], s45 offen offset:256 nt lds
    v_mfma_f32_16x16x32_bf16 v[180:183], v[188:191], v[72:75], 0
    v_mfma_f32_16x16x32_bf16 v[184:187], v[188:191], v[96:99], 0
    ds_read_b128 v[188:191], v245 offset:2048
    s_waitcnt lgkmcnt(4)
    v_mfma_f32_16x16x32_bf16 v[168:171], v[192:195], v[4:7], v[168:171]
    v_mfma_f32_16x16x32_bf16 v[172:175], v[192:195], v[28:31], v[172:175]
    v_mfma_f32_16x16x32_bf16 v[176:179], v[192:195], v[52:55], v[176:179]
    v_mfma_f32_16x16x32_bf16 v[180:183], v[192:195], v[76:79], v[180:183]
    v_mfma_f32_16x16x32_bf16 v[184:187], v[192:195], v[100:103], v[184:187]
    s_waitcnt lgkmcnt(3)
    v_mfma_f32_16x16x32_bf16 v[168:171], v[208:211], v[8:11], v[168:171]
    v_mfma_f32_16x16x32_bf16 v[172:175], v[208:211], v[32:35], v[172:175]
    v_mfma_f32_16x16x32_bf16 v[176:179], v[208:211], v[56:59], v[176:179]
    v_mfma_f32_16x16x32_bf16 v[180:183], v[208:211], v[80:83], v[180:183]
    v_mfma_f32_16x16x32_bf16 v[184:187], v[208:211], v[104:107], v[184:187]
    s_waitcnt lgkmcnt(2)
    v_mfma_f32_16x16x32_bf16 v[168:171], v[212:215], v[12:15], v[168:171]
    v_mfma_f32_16x16x32_bf16 v[172:175], v[212:215], v[36:39], v[172:175]
    v_mfma_f32_16x16x32_bf16 v[176:179], v[212:215], v[60:63], v[176:179]
    v_mfma_f32_16x16x32_bf16 v[180:183], v[212:215], v[84:87], v[180:183]
    v_mfma_f32_16x16x32_bf16 v[184:187], v[212:215], v[108:111], v[184:187]
    s_waitcnt lgkmcnt(1)
    v_mfma_f32_16x16x32_bf16 v[168:171], v[216:219], v[16:19], v[168:171]
    v_mfma_f32_16x16x32_bf16 v[172:175], v[216:219], v[40:43], v[172:175]
    v_mfma_f32_16x16x32_bf16 v[176:179], v[216:219], v[64:67], v[176:179]
    v_mfma_f32_16x16x32_bf16 v[180:183], v[216:219], v[88:91], v[180:183]
    v_mfma_f32_16x16x32_bf16 v[184:187], v[216:219], v[112:115], v[184:187]
    s_waitcnt lgkmcnt(0)
    v_mfma_f32_16x16x32_bf16 v[168:171], v[188:191], v[20:23], v[168:171]
    v_mfma_f32_16x16x32_bf16 v[172:175], v[188:191], v[44:47], v[172:175]
    v_mfma_f32_16x16x32_bf16 v[176:179], v[188:191], v[68:71], v[176:179]
    v_mfma_f32_16x16x32_bf16 v[180:183], v[188:191], v[92:95], v[180:183]
    v_mfma_f32_16x16x32_bf16 v[184:187], v[188:191], v[116:119], v[184:187]
    s_nop 3
    v_max3_f32 v253, v168, v169, v170
    v_max_f32 v253, v253, v171
    ds_max_f32 v251, v253 offset:12
    v_max3_f32 v254, v172, v173, v174
    v_max_f32 v254, v254, v175
    ds_max_f32 v251, v254 offset:16
    v_max3_f32 v253, v176, v177, v178
    v_max_f32 v253, v253, v179
    ds_max_f32 v251, v253 offset:20
    v_max3_f32 v254, v180, v181, v182
    v_max_f32 v254, v254, v183
    ds_max_f32 v251, v254 offset:24
    v_max3_f32 v253, v184, v185, v186
    v_max_f32 v253, v253, v187
    ds_max_f32 v251, v253 offset:28
    s_waitcnt lgkmcnt(0)
    s_barrier
    ds_read_b32 v228, v251 offset:12
    ds_read_b128 v[220:223], v251 offset:16
    v_add_u32 v246, 24576, v246
    v_add_u32 v247, 24576, v247
    v_add_u32 v248, 24576, v248
    ds_read_b64_tr_b16 v[196:197], v246
    ds_read_b64_tr_b16 v[198:199], v246 offset:6144
    ds_read_b64_tr_b16 v[200:201], v247
    ds_read_b64_tr_b16 v[202:203], v247 offset:6144
    ds_read_b64_tr_b16 v[204:205], v248
    ds_read_b64_tr_b16 v[206:207], v248 offset:6144
    ds_read_b128 v[208:211], v249 offset:18432
    ds_read_b128 v[212:215], v249 offset:20480
    ds_read_b128 v[216:219], v249 offset:22528
    s_waitcnt lgkmcnt(2)
    v_mfma_f32_16x16x32_bf16 v[120:123], v[196:199], v[208:211], v[120:123]
    v_mul_f32 v228, s37, v228
    v_mul_f32 v220, s37, v220
    v_mul_f32 v221, s37, v221
    v_mul_f32 v222, s37, v222
    v_mul_f32 v223, s37, v223
    s_add_u32 s45, s32, 98304
    s_add_u32 m0, s30, 73728
    s_nop 0
    buffer_load_dwordx4 v241, s[8:11], s45 offen nt lds
    v_mfma_f32_16x16x32_bf16 v[124:127], v[200:203], v[208:211], v[124:127]
    v_sub_f32 v235, v228, v229
    v_sub_f32 v236, v220, v224
    v_sub_f32 v237, v221, v225
    v_sub_f32 v238, v222, v226
    s_add_u32 m0, s30, 74624
    s_nop 0
    buffer_load_dwordx4 v241, s[8:11], s45 offen offset:128 nt lds
    v_mfma_f32_16x16x32_bf16 v[128:131], v[204:207], v[208:211], v[128:131]
    v_sub_f32 v239, v223, v227
    v_cmp_lt_f32 s[78:79], 4.0, v235
    v_cmp_lt_f32 s[80:81], 4.0, v236
    v_cmp_lt_f32 s[82:83], 4.0, v237
    s_add_u32 m0, s30, 75520
    s_nop 0
    buffer_load_dwordx4 v241, s[8:11], s45 offen offset:256 nt lds
    ds_read_b128 v[208:211], v249 offset:24576
    s_waitcnt lgkmcnt(2)
    v_mfma_f32_16x16x32_bf16 v[132:135], v[196:199], v[212:215], v[132:135]
    v_cmp_lt_f32 s[84:85], 4.0, v238
    v_cmp_lt_f32 s[86:87], 4.0, v239
    v_cndmask_b32 v228, v229, v228, s[78:79]
    v_cndmask_b32 v220, v224, v220, s[80:81]
    v_mfma_f32_16x16x32_bf16 v[136:139], v[200:203], v[212:215], v[136:139]
    v_cndmask_b32 v221, v225, v221, s[82:83]
    v_cndmask_b32 v222, v226, v222, s[84:85]
    v_cndmask_b32 v223, v227, v223, s[86:87]
    s_or_b64 s[76:77], s[78:79], s[80:81]
    s_or_b64 s[82:83], s[82:83], s[84:85]
    s_or_b64 s[76:77], s[76:77], s[86:87]
    s_or_b64 s[76:77], s[76:77], s[82:83]
    s_cbranch_scc0 L_nl_0_2
    v_sub_f32 v235, v229, v228
    v_sub_f32 v236, v224, v220
    v_sub_f32 v237, v225, v221
    v_sub_f32 v238, v226, v222
    v_sub_f32 v239, v227, v223
    v_exp_f32 v235, v235
    v_exp_f32 v236, v236
    v_exp_f32 v237, v237
    v_exp_f32 v238, v238
    v_exp_f32 v239, v239
    v_mul_f32 v230, v235, v230
    v_mul_f32 v231, v236, v231
    v_mul_f32 v232, v237, v232
    v_mul_f32 v233, v238, v233
    v_mul_f32 v234, v239, v234
L_nl_0_2:
    v_mfma_f32_16x16x32_bf16 v[140:143], v[204:207], v[212:215], v[140:143]
    v_fma_f32 v168, v168, s37, -v228
    v_fma_f32 v169, v169, s37, -v228
    v_fma_f32 v170, v170, s37, -v228
    v_fma_f32 v171, v171, s37, -v228
    v_fma_f32 v172, v172, s37, -v220
    ds_read_b128 v[212:215], v249 offset:19456
    s_waitcnt lgkmcnt(2)
    v_mfma_f32_16x16x32_bf16 v[144:147], v[196:199], v[216:219], v[144:147]
    v_fma_f32 v173, v173, s37, -v220
    v_fma_f32 v174, v174, s37, -v220
    v_fma_f32 v175, v175, s37, -v220
    v_fma_f32 v176, v176, s37, -v221
    v_mfma_f32_16x16x32_bf16 v[148:151], v[200:203], v[216:219], v[148:151]
    v_fma_f32 v177, v177, s37, -v221
    v_fma_f32 v178, v178, s37, -v221
    v_fma_f32 v179, v179, s37, -v221
    v_fma_f32 v180, v180, s37, -v222
    v_mfma_f32_16x16x32_bf16 v[152:155], v[204:207], v[216:219], v[152:155]
    v_fma_f32 v181, v181, s37, -v222
    v_fma_f32 v182, v182, s37, -v222
    v_fma_f32 v183, v183, s37, -v222
    v_fma_f32 v184, v184, s37, -v223
    ds_read_b128 v[216:219], v249 offset:21504
    s_waitcnt lgkmcnt(2)
    v_mfma_f32_16x16x32_bf16 v[156:159], v[196:199], v[208:211], v[156:159]
    v_fma_f32 v185, v185, s37, -v223
    v_fma_f32 v186, v186, s37, -v223
    v_fma_f32 v187, v187, s37, -v223
    v_exp_f32 v168, v168
    ds_read_b64_tr_b16 v[196:197], v246 offset:12288
    ds_read_b64_tr_b16 v[198:199], v246 offset:18432
    v_mfma_f32_16x16x32_bf16 v[160:163], v[200:203], v[208:211], v[160:163]
    v_exp_f32 v169, v169
    v_exp_f32 v170, v170
    v_exp_f32 v171, v171
    v_exp_f32 v172, v172
    ds_read_b64_tr_b16 v[200:201], v247 offset:12288
    ds_read_b64_tr_b16 v[202:203], v247 offset:18432
    v_mfma_f32_16x16x32_bf16 v[164:167], v[204:207], v[208:211], v[164:167]
    v_exp_f32 v173, v173
    v_exp_f32 v174, v174
    v_exp_f32 v175, v175
    v_exp_f32 v176, v176
    v_exp_f32 v177, v177
    ds_read_b64_tr_b16 v[204:205], v248 offset:12288
    ds_read_b64_tr_b16 v[206:207], v248 offset:18432
    ds_read_b128 v[208:211], v249 offset:23552
    s_waitcnt lgkmcnt(5)
    v_mfma_f32_16x16x32_bf16 v[120:123], v[196:199], v[212:215], v[120:123]
    v_exp_f32 v178, v178
    v_exp_f32 v179, v179
    v_exp_f32 v180, v180
    v_exp_f32 v181, v181
    s_waitcnt lgkmcnt(3)
    v_mfma_f32_16x16x32_bf16 v[124:127], v[200:203], v[212:215], v[124:127]
    v_exp_f32 v182, v182
    v_exp_f32 v183, v183
    v_exp_f32 v184, v184
    v_exp_f32 v185, v185
    s_waitcnt lgkmcnt(1)
    v_mfma_f32_16x16x32_bf16 v[128:131], v[204:207], v[212:215], v[128:131]
    v_exp_f32 v186, v186
    v_exp_f32 v187, v187
    v_add_f32 v230, v230, v168
    v_add_f32 v252, v169, v170
    ds_read_b128 v[212:215], v249 offset:25600
    v_mfma_f32_16x16x32_bf16 v[132:135], v[196:199], v[216:219], v[132:135]
    v_add_f32 v230, v230, v171
    v_cvt_pk_bf16_f32 v168, v168, v169
    v_add_f32 v230, v230, v252
    v_cvt_pk_bf16_f32 v169, v170, v171
    v_mfma_f32_16x16x32_bf16 v[136:139], v[200:203], v[216:219], v[136:139]
    ds_write_b64 v250, v[168:169]
    v_add_f32 v231, v231, v172
    v_add_f32 v252, v173, v174
    v_add_f32 v231, v231, v175
    v_mfma_f32_16x16x32_bf16 v[140:143], v[204:207], v[216:219], v[140:143]
    v_cvt_pk_bf16_f32 v172, v172, v173
    v_add_f32 v231, v231, v252
    v_cvt_pk_bf16_f32 v173, v174, v175
    ds_write_b64 v250, v[172:173] offset:2048
    v_add_f32 v232, v232, v176
    s_waitcnt lgkmcnt(3)
    v_mfma_f32_16x16x32_bf16 v[144:147], v[196:199], v[208:211], v[144:147]
    v_add_f32 v252, v177, v178
    v_add_f32 v232, v232, v179
    v_cvt_pk_bf16_f32 v176, v176, v177
    v_add_f32 v232, v232, v252
    v_mfma_f32_16x16x32_bf16 v[148:151], v[200:203], v[208:211], v[148:151]
    v_cvt_pk_bf16_f32 v177, v178, v179
    ds_write_b64 v250, v[176:177] offset:4096
    v_add_f32 v233, v233, v180
    v_add_f32 v252, v181, v182
    v_mfma_f32_16x16x32_bf16 v[152:155], v[204:207], v[208:211], v[152:155]
    v_add_f32 v233, v233, v183
    v_cvt_pk_bf16_f32 v180, v180, v181
    v_add_f32 v233, v233, v252
    v_cvt_pk_bf16_f32 v181, v182, v183
    s_waitcnt lgkmcnt(3)
    v_mfma_f32_16x16x32_bf16 v[156:159], v[196:199], v[212:215], v[156:159]
    ds_write_b64 v250, v[180:181] offset:6144
    v_add_f32 v234, v234, v184
    v_add_f32 v252, v185, v186
    v_add_f32 v234, v234, v187
    v_mfma_f32_16x16x32_bf16 v[160:163], v[200:203], v[212:215], v[160:163]
    v_cvt_pk_bf16_f32 v184, v184, v185
    v_add_f32 v234, v234, v252
    v_cvt_pk_bf16_f32 v185, v186, v187
    ds_write_b64 v250, v[184:185] offset:8192
    v_mfma_f32_16x16x32_bf16 v[164:167], v[204:207], v[212:215], v[164:167]
    s_waitcnt vmcnt(6)
    s_waitcnt lgkmcnt(0)
    s_barrier
    ds_read_b128 v[188:191], v244 offset:24576
    ds_read_b128 v[192:195], v245 offset:24576
    ds_read_b128 v[208:211], v244 offset:25600
    ds_read_b128 v[212:215], v245 offset:25600
    ds_read_b128 v[216:219], v244 offset:26624
    s_cmp_eq_u64 s[76:77], 0
    s_cbranch_scc1 L_nr_0_2
    v_mul_f32 v120, v235, v120
    v_mul_f32 v121, v235, v121
    v_mul_f32 v122, v235, v122
    v_mul_f32 v123, v235, v123
    v_mul_f32 v124, v235, v124
    v_mul_f32 v125, v235, v125
    v_mul_f32 v126, v235, v126
    v_mul_f32 v127, v235, v127
    v_mul_f32 v128, v235, v128
    v_mul_f32 v129, v235, v129
    v_mul_f32 v130, v235, v130
    v_mul_f32 v131, v235, v131
    v_mul_f32 v132, v236, v132
    v_mul_f32 v133, v236, v133
    v_mul_f32 v134, v236, v134
    v_mul_f32 v135, v236, v135
    v_mul_f32 v136, v236, v136
    v_mul_f32 v137, v236, v137
    v_mul_f32 v138, v236, v138
    v_mul_f32 v139, v236, v139
    v_mul_f32 v140, v236, v140
    v_mul_f32 v141, v236, v141
    v_mul_f32 v142, v236, v142
    v_mul_f32 v143, v236, v143
    v_mul_f32 v144, v237, v144
    v_mul_f32 v145, v237, v145
    v_mul_f32 v146, v237, v146
    v_mul_f32 v147, v237, v147
    v_mul_f32 v148, v237, v148
    v_mul_f32 v149, v237, v149
    v_mul_f32 v150, v237, v150
    v_mul_f32 v151, v237, v151
    v_mul_f32 v152, v237, v152
    v_mul_f32 v153, v237, v153
    v_mul_f32 v154, v237, v154
    v_mul_f32 v155, v237, v155
    v_mul_f32 v156, v238, v156
    v_mul_f32 v157, v238, v157
    v_mul_f32 v158, v238, v158
    v_mul_f32 v159, v238, v159
    v_mul_f32 v160, v238, v160
    v_mul_f32 v161, v238, v161
    v_mul_f32 v162, v238, v162
    v_mul_f32 v163, v238, v163
    v_mul_f32 v164, v238, v164
    v_mul_f32 v165, v238, v165
    v_mul_f32 v166, v238, v166
    v_mul_f32 v167, v238, v167
L_nr_0_2:
    s_waitcnt lgkmcnt(4)
    v_mfma_f32_16x16x32_bf16 v[168:171], v[188:191], v[0:3], 0
    s_add_u32 s45, s32, 98304
    s_add_u32 m0, s30, 49152
    s_nop 0
    buffer_load_dwordx4 v241, s[12:15], s45 offen nt lds
    v_mfma_f32_16x16x32_bf16 v[172:175], v[188:191], v[24:27], 0
    s_add_u32 m0, s30, 50048
    s_nop 0
    buffer_load_dwordx4 v241, s[12:15], s45 offen offset:128 nt lds
    v_mfma_f32_16x16x32_bf16 v[176:179], v[188:191], v[48:51], 0
    s_add_u32 m0, s30, 50944
    s_nop 0
    buffer_load_dwordx4 v241, s[12:15], s45 offen offset:256 nt lds
    v_mfma_f32_16x16x32_bf16 v[180:183], v[188:191], v[72:75], 0
    v_mfma_f32_16x16x32_bf16 v[184:187], v[188:191], v[96:99], 0
    ds_read_b128 v[188:191], v245 offset:26624
    s_waitcnt lgkmcnt(4)
    v_mfma_f32_16x16x32_bf16 v[168:171], v[192:195], v[4:7], v[168:171]
    v_mfma_f32_16x16x32_bf16 v[172:175], v[192:195], v[28:31], v[172:175]
    v_mfma_f32_16x16x32_bf16 v[176:179], v[192:195], v[52:55], v[176:179]
    v_mfma_f32_16x16x32_bf16 v[180:183], v[192:195], v[76:79], v[180:183]
    v_mfma_f32_16x16x32_bf16 v[184:187], v[192:195], v[100:103], v[184:187]
    s_waitcnt lgkmcnt(3)
    v_mfma_f32_16x16x32_bf16 v[168:171], v[208:211], v[8:11], v[168:171]
    v_mfma_f32_16x16x32_bf16 v[172:175], v[208:211], v[32:35], v[172:175]
    v_mfma_f32_16x16x32_bf16 v[176:179], v[208:211], v[56:59], v[176:179]
    v_mfma_f32_16x16x32_bf16 v[180:183], v[208:211], v[80:83], v[180:183]
    v_mfma_f32_16x16x32_bf16 v[184:187], v[208:211], v[104:107], v[184:187]
    s_waitcnt lgkmcnt(2)
    v_mfma_f32_16x16x32_bf16 v[168:171], v[212:215], v[12:15], v[168:171]
    v_mfma_f32_16x16x32_bf16 v[172:175], v[212:215], v[36:39], v[172:175]
    v_mfma_f32_16x16x32_bf16 v[176:179], v[212:215], v[60:63], v[176:179]
    v_mfma_f32_16x16x32_bf16 v[180:183], v[212:215], v[84:87], v[180:183]
    v_mfma_f32_16x16x32_bf16 v[184:187], v[212:215], v[108:111], v[184:187]
    s_waitcnt lgkmcnt(1)
    v_mfma_f32_16x16x32_bf16 v[168:171], v[216:219], v[16:19], v[168:171]
    v_mfma_f32_16x16x32_bf16 v[172:175], v[216:219], v[40:43], v[172:175]
    v_mfma_f32_16x16x32_bf16 v[176:179], v[216:219], v[64:67], v[176:179]
    v_mfma_f32_16x16x32_bf16 v[180:183], v[216:219], v[88:91], v[180:183]
    v_mfma_f32_16x16x32_bf16 v[184:187], v[216:219], v[112:115], v[184:187]
    s_waitcnt lgkmcnt(0)
    v_mfma_f32_16x16x32_bf16 v[168:171], v[188:191], v[20:23], v[168:171]
    v_mfma_f32_16x16x32_bf16 v[172:175], v[188:191], v[44:47], v[172:175]
    v_mfma_f32_16x16x32_bf16 v[176:179], v[188:191], v[68:71], v[176:179]
    v_mfma_f32_16x16x32_bf16 v[180:183], v[188:191], v[92:95], v[180:183]
    v_mfma_f32_16x16x32_bf16 v[184:187], v[188:191], v[116:119], v[184:187]
    s_nop 3
    v_max3_f32 v253, v168, v169, v170
    v_max_f32 v253, v253, v171
    ds_max_f32 v251, v253 offset:780
    v_max3_f32 v254, v172, v173, v174
    v_max_f32 v254, v254, v175
    ds_max_f32 v251, v254 offset:784
    v_max3_f32 v253, v176, v177, v178
    v_max_f32 v253, v253, v179
    ds_max_f32 v251, v253 offset:788
    v_max3_f32 v254, v180, v181, v182
    v_max_f32 v254, v254, v183
    ds_max_f32 v251, v254 offset:792
    v_max3_f32 v253, v184, v185, v186
    v_max_f32 v253, v253, v187
    ds_max_f32 v251, v253 offset:796
    s_waitcnt lgkmcnt(0)
    s_barrier
    ds_read_b32 v229, v251 offset:780
    ds_read_b128 v[224:227], v251 offset:784
    v_subrev_u32 v246, 49152, v246
    v_subrev_u32 v247, 49152, v247
    v_subrev_u32 v248, 49152, v248
    ds_read_b64_tr_b16 v[196:197], v246
    ds_read_b64_tr_b16 v[198:199], v246 offset:6144
    ds_read_b64_tr_b16 v[200:201], v247
    ds_read_b64_tr_b16 v[202:203], v247 offset:6144
    ds_read_b64_tr_b16 v[204:205], v248
    ds_read_b64_tr_b16 v[206:207], v248 offset:6144
    ds_read_b128 v[208:211], v249
    ds_read_b128 v[212:215], v249 offset:2048
    ds_read_b128 v[216:219], v249 offset:4096
    s_waitcnt lgkmcnt(2)
    v_mfma_f32_16x16x32_bf16 v[120:123], v[196:199], v[208:211], v[120:123]
    v_mul_f32 v229, s37, v229
    v_mul_f32 v224, s37, v224
    v_mul_f32 v225, s37, v225
    v_mul_f32 v226, s37, v226
    v_mul_f32 v227, s37, v227
    s_add_u32 s45, s32, 122880
    s_add_u32 m0, s30, 98304
    s_nop 0
    buffer_load_dwordx4 v241, s[8:11], s45 offen nt lds
    v_mfma_f32_16x16x32_bf16 v[124:127], v[200:203], v[208:211], v[124:127]
    v_sub_f32 v235, v229, v228
    v_sub_f32 v236, v224, v220
    v_sub_f32 v237, v225, v221
    v_sub_f32 v238, v226, v222
    s_add_u32 m0, s30, 99200
    s_nop 0
    buffer_load_dwordx4 v241, s[8:11], s45 offen offset:128 nt lds
    v_mfma_f32_16x16x32_bf16 v[128:131], v[204:207], v[208:211], v[128:131]
    v_sub_f32 v239, v227, v223
    v_cmp_lt_f32 s[78:79], 4.0, v235
    v_cmp_lt_f32 s[80:81], 4.0, v236
    v_cmp_lt_f32 s[82:83], 4.0, v237
    s_add_u32 m0, s30, 100096
    s_nop 0
    buffer_load_dwordx4 v241, s[8:11], s45 offen offset:256 nt lds
    ds_read_b128 v[208:211], v249 offset:6144
    s_waitcnt lgkmcnt(2)
    v_mfma_f32_16x16x32_bf16 v[132:135], v[196:199], v[212:215], v[132:135]
    v_cmp_lt_f32 s[84:85], 4.0, v238
    v_cmp_lt_f32 s[86:87], 4.0, v239
    v_cndmask_b32 v229, v228, v229, s[78:79]
    v_cndmask_b32 v224, v220, v224, s[80:81]
    v_mfma_f32_16x16x32_bf16 v[136:139], v[200:203], v[212:215], v[136:139]
    v_cndmask_b32 v225, v221, v225, s[82:83]
    v_cndmask_b32 v226, v222, v226, s[84:85]
    v_cndmask_b32 v227, v223, v227, s[86:87]
    s_or_b64 s[76:77], s[78:79], s[80:81]
    s_or_b64 s[82:83], s[82:83], s[84:85]
    s_or_b64 s[76:77], s[76:77], s[86:87]
    s_or_b64 s[76:77], s[76:77], s[82:83]
    s_cbranch_scc0 L_nl_0_3
    v_sub_f32 v235, v228, v229
    v_sub_f32 v236, v220, v224
    v_sub_f32 v237, v221, v225
    v_sub_f32 v238, v222, v226
    v_sub_f32 v239, v223, v227
    v_exp_f32 v235, v235
    v_exp_f32 v236, v236
    v_exp_f32 v237, v237
    v_exp_f32 v238, v238
    v_exp_f32 v239, v239
    v_mul_f32 v230, v235, v230
    v_mul_f32 v231, v236, v231
    v_mul_f32 v232, v237, v232
    v_mul_f32 v233, v238, v233
    v_mul_f32 v234, v239, v234
L_nl_0_3:
    v_mfma_f32_16x16x32_bf16 v[140:143], v[204:207], v[212:215], v[140:143]
    v_fma_f32 v168, v168, s37, -v229
    v_fma_f32 v169, v169, s37, -v229
    v_fma_f32 v170, v170, s37, -v229
    v_fma_f32 v171, v171, s37, -v229
    v_fma_f32 v172, v172, s37, -v224
    ds_read_b128 v[212:215], v249 offset:1024
    s_waitcnt lgkmcnt(2)
    v_mfma_f32_16x16x32_bf16 v[144:147], v[196:199], v[216:219], v[144:147]
    v_fma_f32 v173, v173, s37, -v224
    v_fma_f32 v174, v174, s37, -v224
    v_fma_f32 v175, v175, s37, -v224
    v_fma_f32 v176, v176, s37, -v225
    v_mfma_f32_16x16x32_bf16 v[148:151], v[200:203], v[216:219], v[148:151]
    v_fma_f32 v177, v177, s37, -v225
    v_fma_f32 v178, v178, s37, -v225
    v_fma_f32 v179, v179, s37, -v225
    v_fma_f32 v180, v180, s37, -v226
    v_mfma_f32_16x16x32_bf16 v[152:155], v[204:207], v[216:219], v[152:155]
    v_fma_f32 v181, v181, s37, -v226
    v_fma_f32 v182, v182, s37, -v226
    v_fma_f32 v183, v183, s37, -v226
    v_fma_f32 v184, v184, s37, -v227
    ds_read_b128 v[216:219], v249 offset:3072
    s_waitcnt lgkmcnt(2)
    v_mfma_f32_16x16x32_bf16 v[156:159], v[196:199], v[208:211], v[156:159]
    v_fma_f32 v185, v185, s37, -v227
    v_fma_f32 v186, v186, s37, -v227
    v_fma_f32 v187, v187, s37, -v227
    v_exp_f32 v168, v168
    ds_read_b64_tr_b16 v[196:197], v246 offset:12288
    ds_read_b64_tr_b16 v[198:199], v246 offset:18432
    v_mfma_f32_16x16x32_bf16 v[160:163], v[200:203], v[208:211], v[160:163]
    v_exp_f32 v169, v169
    v_exp_f32 v170, v170
    v_exp_f32 v171, v171
    v_exp_f32 v172, v172
    ds_read_b64_tr_b16 v[200:201], v247 offset:12288
    ds_read_b64_tr_b16 v[202:203], v247 offset:18432
    v_mfma_f32_16x16x32_bf16 v[164:167], v[204:207], v[208:211], v[164:167]
    v_exp_f32 v173, v173
    v_exp_f32 v174, v174
    v_exp_f32 v175, v175
    v_exp_f32 v176, v176
    v_exp_f32 v177, v177
    ds_read_b64_tr_b16 v[204:205], v248 offset:12288
    ds_read_b64_tr_b16 v[206:207], v248 offset:18432
    ds_read_b128 v[208:211], v249 offset:5120
    s_waitcnt lgkmcnt(5)
    v_mfma_f32_16x16x32_bf16 v[120:123], v[196:199], v[212:215], v[120:123]
    v_exp_f32 v178, v178
    v_exp_f32 v179, v179
    v_exp_f32 v180, v180
    v_exp_f32 v181, v181
    s_waitcnt lgkmcnt(3)
    v_mfma_f32_16x16x32_bf16 v[124:127], v[200:203], v[212:215], v[124:127]
    v_exp_f32 v182, v182
    v_exp_f32 v183, v183
    v_exp_f32 v184, v184
    v_exp_f32 v185, v185
    s_waitcnt lgkmcnt(1)
    v_mfma_f32_16x16x32_bf16 v[128:131], v[204:207], v[212:215], v[128:131]
    v_exp_f32 v186, v186
    v_exp_f32 v187, v187
    v_add_f32 v230, v230, v168
    v_add_f32 v252, v169, v170
    ds_read_b128 v[212:215], v249 offset:7168
    v_mfma_f32_16x16x32_bf16 v[132:135], v[196:199], v[216:219], v[132:135]
    v_add_f32 v230, v230, v171
    v_cvt_pk_bf16_f32 v168, v168, v169
    v_add_f32 v230, v230, v252
    v_cvt_pk_bf16_f32 v169, v170, v171
    v_mfma_f32_16x16x32_bf16 v[136:139], v[200:203], v[216:219], v[136:139]
    ds_write_b64 v250, v[168:169] offset:18432
    v_add_f32 v231, v231, v172
    v_add_f32 v252, v173, v174
    v_add_f32 v231, v231, v175
    v_mfma_f32_16x16x32_bf16 v[140:143], v[204:207], v[216:219], v[140:143]
    v_cvt_pk_bf16_f32 v172, v172, v173
    v_add_f32 v231, v231, v252
    v_cvt_pk_bf16_f32 v173, v174, v175
    ds_write_b64 v250, v[172:173] offset:20480
    v_add_f32 v232, v232, v176
    s_waitcnt lgkmcnt(3)
    v_mfma_f32_16x16x32_bf16 v[144:147], v[196:199], v[208:211], v[144:147]
    v_add_f32 v252, v177, v178
    v_add_f32 v232, v232, v179
    v_cvt_pk_bf16_f32 v176, v176, v177
    v_add_f32 v232, v232, v252
    v_mfma_f32_16x16x32_bf16 v[148:151], v[200:203], v[208:211], v[148:151]
    v_cvt_pk_bf16_f32 v177, v178, v179
    ds_write_b64 v250, v[176:177] offset:22528
    v_add_f32 v233, v233, v180
    v_add_f32 v252, v181, v182
    v_mfma_f32_16x16x32_bf16 v[152:155], v[204:207], v[208:211], v[152:155]
    v_add_f32 v233, v233, v183
    v_cvt_pk_bf16_f32 v180, v180, v181
    v_add_f32 v233, v233, v252
    v_cvt_pk_bf16_f32 v181, v182, v183
    s_waitcnt lgkmcnt(3)
    v_mfma_f32_16x16x32_bf16 v[156:159], v[196:199], v[212:215], v[156:159]
    ds_write_b64 v250, v[180:181] offset:24576
    v_add_f32 v234, v234, v184
    v_add_f32 v252, v185, v186
    v_add_f32 v234, v234, v187
    v_mfma_f32_16x16x32_bf16 v[160:163], v[200:203], v[212:215], v[160:163]
    v_cvt_pk_bf16_f32 v184, v184, v185
    v_add_f32 v234, v234, v252
    v_cvt_pk_bf16_f32 v185, v186, v187
    ds_write_b64 v250, v[184:185] offset:26624
    v_mfma_f32_16x16x32_bf16 v[164:167], v[204:207], v[212:215], v[164:167]
    s_waitcnt vmcnt(6)
    s_waitcnt lgkmcnt(0)
    s_barrier
    ds_read_b128 v[188:191], v244
    ds_read_b128 v[192:195], v245
    ds_read_b128 v[208:211], v244 offset:1024
    ds_read_b128 v[212:215], v245 offset:1024
    ds_read_b128 v[216:219], v244 offset:2048
    s_cmp_eq_u64 s[76:77], 0
    s_cbranch_scc1 L_nr_0_3
    v_mul_f32 v120, v235, v120
    v_mul_f32 v121, v235, v121
    v_mul_f32 v122, v235, v122
    v_mul_f32 v123, v235, v123
    v_mul_f32 v124, v235, v124
    v_mul_f32 v125, v235, v125
    v_mul_f32 v126, v235, v126
    v_mul_f32 v127, v235, v127
    v_mul_f32 v128, v235, v128
    v_mul_f32 v129, v235, v129
    v_mul_f32 v130, v235, v130
    v_mul_f32 v131, v235, v131
    v_mul_f32 v132, v236, v132
    v_mul_f32 v133, v236, v133
    v_mul_f32 v134, v236, v134
    v_mul_f32 v135, v236, v135
    v_mul_f32 v136, v236, v136
    v_mul_f32 v137, v236, v137
    v_mul_f32 v138, v236, v138
    v_mul_f32 v139, v236, v139
    v_mul_f32 v140, v236, v140
    v_mul_f32 v141, v236, v141
    v_mul_f32 v142, v236, v142
    v_mul_f32 v143, v236, v143
    v_mul_f32 v144, v237, v144
    v_mul_f32 v145, v237, v145
    v_mul_f32 v146, v237, v146
    v_mul_f32 v147, v237, v147
    v_mul_f32 v148, v237, v148
    v_mul_f32 v149, v237, v149
    v_mul_f32 v150, v237, v150
    v_mul_f32 v151, v237, v151
    v_mul_f32 v152, v237, v152
    v_mul_f32 v153, v237, v153
    v_mul_f32 v154, v237, v154
    v_mul_f32 v155, v237, v155
    v_mul_f32 v156, v238, v156
    v_mul_f32 v157, v238, v157
    v_mul_f32 v158, v238, v158
    v_mul_f32 v159, v238, v159
    v_mul_f32 v160, v238, v160
    v_mul_f32 v161, v238, v161
    v_mul_f32 v162, v238, v162
    v_mul_f32 v163, v238, v163
    v_mul_f32 v164, v238, v164
    v_mul_f32 v165, v238, v165
    v_mul_f32 v166, v238, v166
    v_mul_f32 v167, v238, v167
L_nr_0_3:
    s_waitcnt lgkmcnt(4)
    v_mfma_f32_16x16x32_bf16 v[168:171], v[188:191], v[0:3], 0
    s_add_u32 s45, s32, 122880
    s_add_u32 m0, s30, 0
    s_nop 0
    buffer_load_dwordx4 v241, s[12:15], s45 offen nt lds
    v_mfma_f32_16x16x32_bf16 v[172:175], v[188:191], v[24:27], 0
    s_add_u32 m0, s30, 896
    s_nop 0
    buffer_load_dwordx4 v241, s[12:15], s45 offen offset:128 nt lds
    v_mfma_f32_16x16x32_bf16 v[176:179], v[188:191], v[48:51], 0
    s_add_u32 m0, s30, 1792
    s_nop 0
    buffer_load_dwordx4 v241, s[12:15], s45 offen offset:256 nt lds
    v_mfma_f32_16x16x32_bf16 v[180:183], v[188:191], v[72:75], 0
    v_mfma_f32_16x16x32_bf16 v[184:187], v[188:191], v[96:99], 0
    ds_read_b128 v[188:191], v245 offset:2048
    s_waitcnt lgkmcnt(4)
    v_mfma_f32_16x16x32_bf16 v[168:171], v[192:195], v[4:7], v[168:171]
    v_mfma_f32_16x16x32_bf16 v[172:175], v[192:195], v[28:31], v[172:175]
    v_mfma_f32_16x16x32_bf16 v[176:179], v[192:195], v[52:55], v[176:179]
    v_mfma_f32_16x16x32_bf16 v[180:183], v[192:195], v[76:79], v[180:183]
    v_mfma_f32_16x16x32_bf16 v[184:187], v[192:195], v[100:103], v[184:187]
    s_waitcnt lgkmcnt(3)
    v_mfma_f32_16x16x32_bf16 v[168:171], v[208:211], v[8:11], v[168:171]
    v_mfma_f32_16x16x32_bf16 v[172:175], v[208:211], v[32:35], v[172:175]
    v_mfma_f32_16x16x32_bf16 v[176:179], v[208:211], v[56:59], v[176:179]
    v_mfma_f32_16x16x32_bf16 v[180:183], v[208:211], v[80:83], v[180:183]
    v_mfma_f32_16x16x32_bf16 v[184:187], v[208:211], v[104:107], v[184:187]
    s_waitcnt lgkmcnt(2)
    v_mfma_f32_16x16x32_bf16 v[168:171], v[212:215], v[12:15], v[168:171]
    v_mfma_f32_16x16x32_bf16 v[172:175], v[212:215], v[36:39], v[172:175]
    v_mfma_f32_16x16x32_bf16 v[176:179], v[212:215], v[60:63], v[176:179]
    v_mfma_f32_16x16x32_bf16 v[180:183], v[212:215], v[84:87], v[180:183]
    v_mfma_f32_16x16x32_bf16 v[184:187], v[212:215], v[108:111], v[184:187]
    s_waitcnt lgkmcnt(1)
    v_mfma_f32_16x16x32_bf16 v[168:171], v[216:219], v[16:19], v[168:171]
    v_mfma_f32_16x16x32_bf16 v[172:175], v[216:219], v[40:43], v[172:175]
    v_mfma_f32_16x16x32_bf16 v[176:179], v[216:219], v[64:67], v[176:179]
    v_mfma_f32_16x16x32_bf16 v[180:183], v[216:219], v[88:91], v[180:183]
    v_mfma_f32_16x16x32_bf16 v[184:187], v[216:219], v[112:115], v[184:187]
    s_waitcnt lgkmcnt(0)
    v_mfma_f32_16x16x32_bf16 v[168:171], v[188:191], v[20:23], v[168:171]
    v_mfma_f32_16x16x32_bf16 v[172:175], v[188:191], v[44:47], v[172:175]
    v_mfma_f32_16x16x32_bf16 v[176:179], v[188:191], v[68:71], v[176:179]
    v_mfma_f32_16x16x32_bf16 v[180:183], v[188:191], v[92:95], v[180:183]
    v_mfma_f32_16x16x32_bf16 v[184:187], v[188:191], v[116:119], v[184:187]
    s_nop 3
    v_max3_f32 v253, v168, v169, v170
    v_max_f32 v253, v253, v171
    ds_max_f32 v251, v253 offset:12
    v_max3_f32 v254, v172, v173, v174
    v_max_f32 v254, v254, v175
    ds_max_f32 v251, v254 offset:16
    v_max3_f32 v253, v176, v177, v178
    v_max_f32 v253, v253, v179
    ds_max_f32 v251, v253 offset:20
    v_max3_f32 v254, v180, v181, v182
    v_max_f32 v254, v254, v183
    ds_max_f32 v251, v254 offset:24
    v_max3_f32 v253, v184, v185, v186
    v_max_f32 v253, v253, v187
    ds_max_f32 v251, v253 offset:28
    s_waitcnt lgkmcnt(0)
    s_barrier
    ds_read_b32 v228, v251 offset:12
    ds_read_b128 v[220:223], v251 offset:16
    v_add_u32 v246, 24576, v246
    v_add_u32 v247, 24576, v247
    v_add_u32 v248, 24576, v248
    ds_read_b64_tr_b16 v[196:197], v246
    ds_read_b64_tr_b16 v[198:199], v246 offset:6144
    ds_read_b64_tr_b16 v[200:201], v247
    ds_read_b64_tr_b16 v[202:203], v247 offset:6144
    ds_read_b64_tr_b16 v[204:205], v248
    ds_read_b64_tr_b16 v[206:207], v248 offset:6144
    ds_read_b128 v[208:211], v249 offset:18432
    ds_read_b128 v[212:215], v249 offset:20480
    ds_read_b128 v[216:219], v249 offset:22528
    s_waitcnt lgkmcnt(2)
    v_mfma_f32_16x16x32_bf16 v[120:123], v[196:199], v[208:211], v[120:123]
    v_mul_f32 v228, s37, v228
    v_mul_f32 v220, s37, v220
    v_mul_f32 v221, s37, v221
    v_mul_f32 v222, s37, v222
    v_mul_f32 v223, s37, v223
    s_add_u32 s45, s32, 147456
    s_add_u32 m0, s30, 73728
    s_nop 0
    buffer_load_dwordx4 v241, s[8:11], s45 offen nt lds
    v_mfma_f32_16x16x32_bf16 v[124:127], v[200:203], v[208:211], v[124:127]
    v_sub_f32 v235, v228, v229
    v_sub_f32 v236, v220, v224
    v_sub_f32 v237, v221, v225
    v_sub_f32 v238, v222, v226
    s_add_u32 m0, s30, 74624
    s_nop 0
    buffer_load_dwordx4 v241, s[8:11], s45 offen offset:128 nt lds
    v_mfma_f32_16x16x32_bf16 v[128:131], v[204:207], v[208:211], v[128:131]
    v_sub_f32 v239, v223, v227
    v_cmp_lt_f32 s[78:79], 4.0, v235
    v_cmp_lt_f32 s[80:81], 4.0, v236
    v_cmp_lt_f32 s[82:83], 4.0, v237
    s_add_u32 m0, s30, 75520
    s_nop 0
    buffer_load_dwordx4 v241, s[8:11], s45 offen offset:256 nt lds
    ds_read_b128 v[208:211], v249 offset:24576
    s_waitcnt lgkmcnt(2)
    v_mfma_f32_16x16x32_bf16 v[132:135], v[196:199], v[212:215], v[132:135]
    v_cmp_lt_f32 s[84:85], 4.0, v238
    v_cmp_lt_f32 s[86:87], 4.0, v239
    v_cndmask_b32 v228, v229, v228, s[78:79]
    v_cndmask_b32 v220, v224, v220, s[80:81]
    v_mfma_f32_16x16x32_bf16 v[136:139], v[200:203], v[212:215], v[136:139]
    v_cndmask_b32 v221, v225, v221, s[82:83]
    v_cndmask_b32 v222, v226, v222, s[84:85]
    v_cndmask_b32 v223, v227, v223, s[86:87]
    s_or_b64 s[76:77], s[78:79], s[80:81]
    s_or_b64 s[82:83], s[82:83], s[84:85]
    s_or_b64 s[76:77], s[76:77], s[86:87]
    s_or_b64 s[76:77], s[76:77], s[82:83]
    s_cbranch_scc0 L_nl_0_4
    v_sub_f32 v235, v229, v228
    v_sub_f32 v236, v224, v220
    v_sub_f32 v237, v225, v221
    v_sub_f32 v238, v226, v222
    v_sub_f32 v239, v227, v223
    v_exp_f32 v235, v235
    v_exp_f32 v236, v236
    v_exp_f32 v237, v237
    v_exp_f32 v238, v238
    v_exp_f32 v239, v239
    v_mul_f32 v230, v235, v230
    v_mul_f32 v231, v236, v231
    v_mul_f32 v232, v237, v232
    v_mul_f32 v233, v238, v233
    v_mul_f32 v234, v239, v234
L_nl_0_4:
    v_mfma_f32_16x16x32_bf16 v[140:143], v[204:207], v[212:215], v[140:143]
    v_fma_f32 v168, v168, s37, -v228
    v_fma_f32 v169, v169, s37, -v228
    v_fma_f32 v170, v170, s37, -v228
    v_fma_f32 v171, v171, s37, -v228
    v_fma_f32 v172, v172, s37, -v220
    ds_read_b128 v[212:215], v249 offset:19456
    s_waitcnt lgkmcnt(2)
    v_mfma_f32_16x16x32_bf16 v[144:147], v[196:199], v[216:219], v[144:147]
    v_fma_f32 v173, v173, s37, -v220
    v_fma_f32 v174, v174, s37, -v220
    v_fma_f32 v175, v175, s37, -v220
    v_fma_f32 v176, v176, s37, -v221
    v_mfma_f32_16x16x32_bf16 v[148:151], v[200:203], v[216:219], v[148:151]
    v_fma_f32 v177, v177, s37, -v221
    v_fma_f32 v178, v178, s37, -v221
    v_fma_f32 v179, v179, s37, -v221
    v_fma_f32 v180, v180, s37, -v222
    v_mfma_f32_16x16x32_bf16 v[152:155], v[204:207], v[216:219], v[152:155]
    v_fma_f32 v181, v181, s37, -v222
    v_fma_f32 v182, v182, s37, -v222
    v_fma_f32 v183, v183, s37, -v222
    v_fma_f32 v184, v184, s37, -v223
    ds_read_b128 v[216:219], v249 offset:21504
    s_waitcnt lgkmcnt(2)
    v_mfma_f32_16x16x32_bf16 v[156:159], v[196:199], v[208:211], v[156:159]
    v_fma_f32 v185, v185, s37, -v223
    v_fma_f32 v186, v186, s37, -v223
    v_fma_f32 v187, v187, s37, -v223
    v_exp_f32 v168, v168
    ds_read_b64_tr_b16 v[196:197], v246 offset:12288
    ds_read_b64_tr_b16 v[198:199], v246 offset:18432
    v_mfma_f32_16x16x32_bf16 v[160:163], v[200:203], v[208:211], v[160:163]
    v_exp_f32 v169, v169
    v_exp_f32 v170, v170
    v_exp_f32 v171, v171
    v_exp_f32 v172, v172
    ds_read_b64_tr_b16 v[200:201], v247 offset:12288
    ds_read_b64_tr_b16 v[202:203], v247 offset:18432
    v_mfma_f32_16x16x32_bf16 v[164:167], v[204:207], v[208:211], v[164:167]
    v_exp_f32 v173, v173
    v_exp_f32 v174, v174
    v_exp_f32 v175, v175
    v_exp_f32 v176, v176
    v_exp_f32 v177, v177
    ds_read_b64_tr_b16 v[204:205], v248 offset:12288
    ds_read_b64_tr_b16 v[206:207], v248 offset:18432
    ds_read_b128 v[208:211], v249 offset:23552
    s_waitcnt lgkmcnt(5)
    v_mfma_f32_16x16x32_bf16 v[120:123], v[196:199], v[212:215], v[120:123]
    v_exp_f32 v178, v178
    v_exp_f32 v179, v179
    v_exp_f32 v180, v180
    v_exp_f32 v181, v181
    s_waitcnt lgkmcnt(3)
    v_mfma_f32_16x16x32_bf16 v[124:127], v[200:203], v[212:215], v[124:127]
    v_exp_f32 v182, v182
    v_exp_f32 v183, v183
    v_exp_f32 v184, v184
    v_exp_f32 v185, v185
    s_waitcnt lgkmcnt(1)
    v_mfma_f32_16x16x32_bf16 v[128:131], v[204:207], v[212:215], v[128:131]
    v_exp_f32 v186, v186
    v_exp_f32 v187, v187
    v_add_f32 v230, v230, v168
    v_add_f32 v252, v169, v170
    ds_read_b128 v[212:215], v249 offset:25600
    v_mfma_f32_16x16x32_bf16 v[132:135], v[196:199], v[216:219], v[132:135]
    v_add_f32 v230, v230, v171
    v_cvt_pk_bf16_f32 v168, v168, v169
    v_add_f32 v230, v230, v252
    v_cvt_pk_bf16_f32 v169, v170, v171
    v_mfma_f32_16x16x32_bf16 v[136:139], v[200:203], v[216:219], v[136:139]
    ds_write_b64 v250, v[168:169]
    v_add_f32 v231, v231, v172
    v_add_f32 v252, v173, v174
    v_add_f32 v231, v231, v175
    v_mfma_f32_16x16x32_bf16 v[140:143], v[204:207], v[216:219], v[140:143]
    v_cvt_pk_bf16_f32 v172, v172, v173
    v_add_f32 v231, v231, v252
    v_cvt_pk_bf16_f32 v173, v174, v175
    ds_write_b64 v250, v[172:173] offset:2048
    v_add_f32 v232, v232, v176
    s_waitcnt lgkmcnt(3)
    v_mfma_f32_16x16x32_bf16 v[144:147], v[196:199], v[208:211], v[144:147]
    v_add_f32 v252, v177, v178
    v_add_f32 v232, v232, v179
    v_cvt_pk_bf16_f32 v176, v176, v177
    v_add_f32 v232, v232, v252
    v_mfma_f32_16x16x32_bf16 v[148:151], v[200:203], v[208:211], v[148:151]
    v_cvt_pk_bf16_f32 v177, v178, v179
    ds_write_b64 v250, v[176:177] offset:4096
    v_add_f32 v233, v233, v180
    v_add_f32 v252, v181, v182
    v_mfma_f32_16x16x32_bf16 v[152:155], v[204:207], v[208:211], v[152:155]
    v_add_f32 v233, v233, v183
    v_cvt_pk_bf16_f32 v180, v180, v181
    v_add_f32 v233, v233, v252
    v_cvt_pk_bf16_f32 v181, v182, v183
    s_waitcnt lgkmcnt(3)
    v_mfma_f32_16x16x32_bf16 v[156:159], v[196:199], v[212:215], v[156:159]
    ds_write_b64 v250, v[180:181] offset:6144
    v_add_f32 v234, v234, v184
    v_add_f32 v252, v185, v186
    v_add_f32 v234, v234, v187
    v_mfma_f32_16x16x32_bf16 v[160:163], v[200:203], v[212:215], v[160:163]
    v_cvt_pk_bf16_f32 v184, v184, v185
    v_add_f32 v234, v234, v252
    v_cvt_pk_bf16_f32 v185, v186, v187
    ds_write_b64 v250, v[184:185] offset:8192
    v_mfma_f32_16x16x32_bf16 v[164:167], v[204:207], v[212:215], v[164:167]
    s_waitcnt vmcnt(6)
    s_waitcnt lgkmcnt(0)
    s_barrier
    ds_read_b128 v[188:191], v244 offset:24576
    ds_read_b128 v[192:195], v245 offset:24576
    ds_read_b128 v[208:211], v244 offset:25600
    ds_read_b128 v[212:215], v245 offset:25600
    ds_read_b128 v[216:219], v244 offset:26624
    s_cmp_eq_u64 s[76:77], 0
    s_cbranch_scc1 L_nr_0_4
    v_mul_f32 v120, v235, v120
    v_mul_f32 v121, v235, v121
    v_mul_f32 v122, v235, v122
    v_mul_f32 v123, v235, v123
    v_mul_f32 v124, v235, v124
    v_mul_f32 v125, v235, v125
    v_mul_f32 v126, v235, v126
    v_mul_f32 v127, v235, v127
    v_mul_f32 v128, v235, v128
    v_mul_f32 v129, v235, v129
    v_mul_f32 v130, v235, v130
    v_mul_f32 v131, v235, v131
    v_mul_f32 v132, v236, v132
    v_mul_f32 v133, v236, v133
    v_mul_f32 v134, v236, v134
    v_mul_f32 v135, v236, v135
    v_mul_f32 v136, v236, v136
    v_mul_f32 v137, v236, v137
    v_mul_f32 v138, v236, v138
    v_mul_f32 v139, v236, v139
    v_mul_f32 v140, v236, v140
    v_mul_f32 v141, v236, v141
    v_mul_f32 v142, v236, v142
    v_mul_f32 v143, v236, v143
    v_mul_f32 v144, v237, v144
    v_mul_f32 v145, v237, v145
    v_mul_f32 v146, v237, v146
    v_mul_f32 v147, v237, v147
    v_mul_f32 v148, v237, v148
    v_mul_f32 v149, v237, v149
    v_mul_f32 v150, v237, v150
    v_mul_f32 v151, v237, v151
    v_mul_f32 v152, v237, v152
    v_mul_f32 v153, v237, v153
    v_mul_f32 v154, v237, v154
    v_mul_f32 v155, v237, v155
    v_mul_f32 v156, v238, v156
    v_mul_f32 v157, v238, v157
    v_mul_f32 v158, v238, v158
    v_mul_f32 v159, v238, v159
    v_mul_f32 v160, v238, v160
    v_mul_f32 v161, v238, v161
    v_mul_f32 v162, v238, v162
    v_mul_f32 v163, v238, v163
    v_mul_f32 v164, v238, v164
    v_mul_f32 v165, v238, v165
    v_mul_f32 v166, v238, v166
    v_mul_f32 v167, v238, v167
L_nr_0_4:
    s_waitcnt lgkmcnt(4)
    v_mfma_f32_16x16x32_bf16 v[168:171], v[188:191], v[0:3], 0
    s_add_u32 s45, s32, 147456
    s_add_u32 m0, s30, 24576
    s_nop 0
    buffer_load_dwordx4 v241, s[12:15], s45 offen nt lds
    v_mfma_f32_16x16x32_bf16 v[172:175], v[188:191], v[24:27], 0
    s_add_u32 m0, s30, 25472
    s_nop 0
    buffer_load_dwordx4 v241, s[12:15], s45 offen offset:128 nt lds
    v_mfma_f32_16x16x32_bf16 v[176:179], v[188:191], v[48:51], 0
    s_add_u32 m0, s30, 26368
    s_nop 0
    buffer_load_dwordx4 v241, s[12:15], s45 offen offset:256 nt lds
    v_mfma_f32_16x16x32_bf16 v[180:183], v[188:191], v[72:75], 0
    v_mfma_f32_16x16x32_bf16 v[184:187], v[188:191], v[96:99], 0
    ds_read_b128 v[188:191], v245 offset:26624
    s_waitcnt lgkmcnt(4)
    v_mfma_f32_16x16x32_bf16 v[168:171], v[192:195], v[4:7], v[168:171]
    v_mfma_f32_16x16x32_bf16 v[172:175], v[192:195], v[28:31], v[172:175]
    v_mfma_f32_16x16x32_bf16 v[176:179], v[192:195], v[52:55], v[176:179]
    v_mfma_f32_16x16x32_bf16 v[180:183], v[192:195], v[76:79], v[180:183]
    v_mfma_f32_16x16x32_bf16 v[184:187], v[192:195], v[100:103], v[184:187]
    s_waitcnt lgkmcnt(3)
    v_mfma_f32_16x16x32_bf16 v[168:171], v[208:211], v[8:11], v[168:171]
    v_mfma_f32_16x16x32_bf16 v[172:175], v[208:211], v[32:35], v[172:175]
    v_mfma_f32_16x16x32_bf16 v[176:179], v[208:211], v[56:59], v[176:179]
    v_mfma_f32_16x16x32_bf16 v[180:183], v[208:211], v[80:83], v[180:183]
    v_mfma_f32_16x16x32_bf16 v[184:187], v[208:211], v[104:107], v[184:187]
    s_waitcnt lgkmcnt(2)
    v_mfma_f32_16x16x32_bf16 v[168:171], v[212:215], v[12:15], v[168:171]
    v_mfma_f32_16x16x32_bf16 v[172:175], v[212:215], v[36:39], v[172:175]
    v_mfma_f32_16x16x32_bf16 v[176:179], v[212:215], v[60:63], v[176:179]
    v_mfma_f32_16x16x32_bf16 v[180:183], v[212:215], v[84:87], v[180:183]
    v_mfma_f32_16x16x32_bf16 v[184:187], v[212:215], v[108:111], v[184:187]
    s_waitcnt lgkmcnt(1)
    v_mfma_f32_16x16x32_bf16 v[168:171], v[216:219], v[16:19], v[168:171]
    v_mfma_f32_16x16x32_bf16 v[172:175], v[216:219], v[40:43], v[172:175]
    v_mfma_f32_16x16x32_bf16 v[176:179], v[216:219], v[64:67], v[176:179]
    v_mfma_f32_16x16x32_bf16 v[180:183], v[216:219], v[88:91], v[180:183]
    v_mfma_f32_16x16x32_bf16 v[184:187], v[216:219], v[112:115], v[184:187]
    s_waitcnt lgkmcnt(0)
    v_mfma_f32_16x16x32_bf16 v[168:171], v[188:191], v[20:23], v[168:171]
    v_mfma_f32_16x16x32_bf16 v[172:175], v[188:191], v[44:47], v[172:175]
    v_mfma_f32_16x16x32_bf16 v[176:179], v[188:191], v[68:71], v[176:179]
    v_mfma_f32_16x16x32_bf16 v[180:183], v[188:191], v[92:95], v[180:183]
    v_mfma_f32_16x16x32_bf16 v[184:187], v[188:191], v[116:119], v[184:187]
    s_nop 3
    v_max3_f32 v253, v168, v169, v170
    v_max_f32 v253, v253, v171
    ds_max_f32 v251, v253 offset:780
    v_max3_f32 v254, v172, v173, v174
    v_max_f32 v254, v254, v175
    ds_max_f32 v251, v254 offset:784
    v_max3_f32 v253, v176, v177, v178
    v_max_f32 v253, v253, v179
    ds_max_f32 v251, v253 offset:788
    v_max3_f32 v254, v180, v181, v182
    v_max_f32 v254, v254, v183
    ds_max_f32 v251, v254 offset:792
    v_max3_f32 v253, v184, v185, v186
    v_max_f32 v253, v253, v187
    ds_max_f32 v251, v253 offset:796
    s_waitcnt lgkmcnt(0)
    s_barrier
    ds_read_b32 v229, v251 offset:780
    ds_read_b128 v[224:227], v251 offset:784
    v_add_u32 v246, 24576, v246
    v_add_u32 v247, 24576, v247
    v_add_u32 v248, 24576, v248
    ds_read_b64_tr_b16 v[196:197], v246
    ds_read_b64_tr_b16 v[198:199], v246 offset:6144
    ds_read_b64_tr_b16 v[200:201], v247
    ds_read_b64_tr_b16 v[202:203], v247 offset:6144
    ds_read_b64_tr_b16 v[204:205], v248
    ds_read_b64_tr_b16 v[206:207], v248 offset:6144
    ds_read_b128 v[208:211], v249
    ds_read_b128 v[212:215], v249 offset:2048
    ds_read_b128 v[216:219], v249 offset:4096
    s_waitcnt lgkmcnt(2)
    v_mfma_f32_16x16x32_bf16 v[120:123], v[196:199], v[208:211], v[120:123]
    v_mul_f32 v229, s37, v229
    v_mul_f32 v224, s37, v224
    v_mul_f32 v225, s37, v225
    v_mul_f32 v226, s37, v226
    v_mul_f32 v227, s37, v227
    s_add_u32 s45, s32, 172032
    s_add_u32 m0, s30, 98304
    s_nop 0
    buffer_load_dwordx4 v241, s[8:11], s45 offen nt lds
    v_mfma_f32_16x16x32_bf16 v[124:127], v[200:203], v[208:211], v[124:127]
    v_sub_f32 v235, v229, v228
    v_sub_f32 v236, v224, v220
    v_sub_f32 v237, v225, v221
    v_sub_f32 v238, v226, v222
    s_add_u32 m0, s30, 99200
    s_nop 0
    buffer_load_dwordx4 v241, s[8:11], s45 offen offset:128 nt lds
    v_mfma_f32_16x16x32_bf16 v[128:131], v[204:207], v[208:211], v[128:131]
    v_sub_f32 v239, v227, v223
    v_cmp_lt_f32 s[78:79], 4.0, v235
    v_cmp_lt_f32 s[80:81], 4.0, v236
    v_cmp_lt_f32 s[82:83], 4.0, v237
    s_add_u32 m0, s30, 100096
    s_nop 0
    buffer_load_dwordx4 v241, s[8:11], s45 offen offset:256 nt lds
    ds_read_b128 v[208:211], v249 offset:6144
    s_waitcnt lgkmcnt(2)
    v_mfma_f32_16x16x32_bf16 v[132:135], v[196:199], v[212:215], v[132:135]
    v_cmp_lt_f32 s[84:85], 4.0, v238
    v_cmp_lt_f32 s[86:87], 4.0, v239
    v_cndmask_b32 v229, v228, v229, s[78:79]
    v_cndmask_b32 v224, v220, v224, s[80:81]
    v_mfma_f32_16x16x32_bf16 v[136:139], v[200:203], v[212:215], v[136:139]
    v_cndmask_b32 v225, v221, v225, s[82:83]
    v_cndmask_b32 v226, v222, v226, s[84:85]
    v_cndmask_b32 v227, v223, v227, s[86:87]
    s_or_b64 s[76:77], s[78:79], s[80:81]
    s_or_b64 s[82:83], s[82:83], s[84:85]
    s_or_b64 s[76:77], s[76:77], s[86:87]
    s_or_b64 s[76:77], s[76:77], s[82:83]
    s_cbranch_scc0 L_nl_0_5
    v_sub_f32 v235, v228, v229
    v_sub_f32 v236, v220, v224
    v_sub_f32 v237, v221, v225
    v_sub_f32 v238, v222, v226
    v_sub_f32 v239, v223, v227
    v_exp_f32 v235, v235
    v_exp_f32 v236, v236
    v_exp_f32 v237, v237
    v_exp_f32 v238, v238
    v_exp_f32 v239, v239
    v_mul_f32 v230, v235, v230
    v_mul_f32 v231, v236, v231
    v_mul_f32 v232, v237, v232
    v_mul_f32 v233, v238, v233
    v_mul_f32 v234, v239, v234
L_nl_0_5:
    v_mfma_f32_16x16x32_bf16 v[140:143], v[204:207], v[212:215], v[140:143]
    v_fma_f32 v168, v168, s37, -v229
    v_fma_f32 v169, v169, s37, -v229
    v_fma_f32 v170, v170, s37, -v229
    v_fma_f32 v171, v171, s37, -v229
    v_fma_f32 v172, v172, s37, -v224
    ds_read_b128 v[212:215], v249 offset:1024
    s_waitcnt lgkmcnt(2)
    v_mfma_f32_16x16x32_bf16 v[144:147], v[196:199], v[216:219], v[144:147]
    v_fma_f32 v173, v173, s37, -v224
    v_fma_f32 v174, v174, s37, -v224
    v_fma_f32 v175, v175, s37, -v224
    v_fma_f32 v176, v176, s37, -v225
    v_mfma_f32_16x16x32_bf16 v[148:151], v[200:203], v[216:219], v[148:151]
    v_fma_f32 v177, v177, s37, -v225
    v_fma_f32 v178, v178, s37, -v225
    v_fma_f32 v179, v179, s37, -v225
    v_fma_f32 v180, v180, s37, -v226
    v_mfma_f32_16x16x32_bf16 v[152:155], v[204:207], v[216:219], v[152:155]
    v_fma_f32 v181, v181, s37, -v226
    v_fma_f32 v182, v182, s37, -v226
    v_fma_f32 v183, v183, s37, -v226
    v_fma_f32 v184, v184, s37, -v227
    ds_read_b128 v[216:219], v249 offset:3072
    s_waitcnt lgkmcnt(2)
    v_mfma_f32_16x16x32_bf16 v[156:159], v[196:199], v[208:211], v[156:159]
    v_fma_f32 v185, v185, s37, -v227
    v_fma_f32 v186, v186, s37, -v227
    v_fma_f32 v187, v187, s37, -v227
    v_exp_f32 v168, v168
    ds_read_b64_tr_b16 v[196:197], v246 offset:12288
    ds_read_b64_tr_b16 v[198:199], v246 offset:18432
    v_mfma_f32_16x16x32_bf16 v[160:163], v[200:203], v[208:211], v[160:163]
    v_exp_f32 v169, v169
    v_exp_f32 v170, v170
    v_exp_f32 v171, v171
    v_exp_f32 v172, v172
    ds_read_b64_tr_b16 v[200:201], v247 offset:12288
    ds_read_b64_tr_b16 v[202:203], v247 offset:18432
    v_mfma_f32_16x16x32_bf16 v[164:167], v[204:207], v[208:211], v[164:167]
    v_exp_f32 v173, v173
    v_exp_f32 v174, v174
    v_exp_f32 v175, v175
    v_exp_f32 v176, v176
    v_exp_f32 v177, v177
    ds_read_b64_tr_b16 v[204:205], v248 offset:12288
    ds_read_b64_tr_b16 v[206:207], v248 offset:18432
    ds_read_b128 v[208:211], v249 offset:5120
    s_waitcnt lgkmcnt(5)
    v_mfma_f32_16x16x32_bf16 v[120:123], v[196:199], v[212:215], v[120:123]
    v_exp_f32 v178, v178
    v_exp_f32 v179, v179
    v_exp_f32 v180, v180
    v_exp_f32 v181, v181
    s_waitcnt lgkmcnt(3)
    v_mfma_f32_16x16x32_bf16 v[124:127], v[200:203], v[212:215], v[124:127]
    v_exp_f32 v182, v182
    v_exp_f32 v183, v183
    v_exp_f32 v184, v184
    v_exp_f32 v185, v185
    s_waitcnt lgkmcnt(1)
    v_mfma_f32_16x16x32_bf16 v[128:131], v[204:207], v[212:215], v[128:131]
    v_exp_f32 v186, v186
    v_exp_f32 v187, v187
    v_add_f32 v230, v230, v168
    v_add_f32 v252, v169, v170
    ds_read_b128 v[212:215], v249 offset:7168
    v_mfma_f32_16x16x32_bf16 v[132:135], v[196:199], v[216:219], v[132:135]
    v_add_f32 v230, v230, v171
    v_cvt_pk_bf16_f32 v168, v168, v169
    v_add_f32 v230, v230, v252
    v_cvt_pk_bf16_f32 v169, v170, v171
    v_mfma_f32_16x16x32_bf16 v[136:139], v[200:203], v[216:219], v[136:139]
    ds_write_b64 v250, v[168:169] offset:18432
    v_add_f32 v231, v231, v172
    v_add_f32 v252, v173, v174
    v_add_f32 v231, v231, v175
    v_mfma_f32_16x16x32_bf16 v[140:143], v[204:207], v[216:219], v[140:143]
    v_cvt_pk_bf16_f32 v172, v172, v173
    v_add_f32 v231, v231, v252
    v_cvt_pk_bf16_f32 v173, v174, v175
    ds_write_b64 v250, v[172:173] offset:20480
    v_add_f32 v232, v232, v176
    s_waitcnt lgkmcnt(3)
    v_mfma_f32_16x16x32_bf16 v[144:147], v[196:199], v[208:211], v[144:147]
    v_add_f32 v252, v177, v178
    v_add_f32 v232, v232, v179
    v_cvt_pk_bf16_f32 v176, v176, v177
    v_add_f32 v232, v232, v252
    v_mfma_f32_16x16x32_bf16 v[148:151], v[200:203], v[208:211], v[148:151]
    v_cvt_pk_bf16_f32 v177, v178, v179
    ds_write_b64 v250, v[176:177] offset:22528
    v_add_f32 v233, v233, v180
    v_add_f32 v252, v181, v182
    v_mfma_f32_16x16x32_bf16 v[152:155], v[204:207], v[208:211], v[152:155]
    v_add_f32 v233, v233, v183
    v_cvt_pk_bf16_f32 v180, v180, v181
    v_add_f32 v233, v233, v252
    v_cvt_pk_bf16_f32 v181, v182, v183
    s_waitcnt lgkmcnt(3)
    v_mfma_f32_16x16x32_bf16 v[156:159], v[196:199], v[212:215], v[156:159]
    ds_write_b64 v250, v[180:181] offset:24576
    v_add_f32 v234, v234, v184
    v_add_f32 v252, v185, v186
    v_add_f32 v234, v234, v187
    v_mfma_f32_16x16x32_bf16 v[160:163], v[200:203], v[212:215], v[160:163]
    v_cvt_pk_bf16_f32 v184, v184, v185
    v_add_f32 v234, v234, v252
    v_cvt_pk_bf16_f32 v185, v186, v187
    ds_write_b64 v250, v[184:185] offset:26624
    v_mfma_f32_16x16x32_bf16 v[164:167], v[204:207], v[212:215], v[164:167]
    s_waitcnt vmcnt(6)
    s_waitcnt lgkmcnt(0)
    s_barrier
    ds_read_b128 v[188:191], v244
    ds_read_b128 v[192:195], v245
    ds_read_b128 v[208:211], v244 offset:1024
    ds_read_b128 v[212:215], v245 offset:1024
    ds_read_b128 v[216:219], v244 offset:2048
    s_cmp_eq_u64 s[76:77], 0
    s_cbranch_scc1 L_nr_0_5
    v_mul_f32 v120, v235, v120
    v_mul_f32 v121, v235, v121
    v_mul_f32 v122, v235, v122
    v_mul_f32 v123, v235, v123
    v_mul_f32 v124, v235, v124
    v_mul_f32 v125, v235, v125
    v_mul_f32 v126, v235, v126
    v_mul_f32 v127, v235, v127
    v_mul_f32 v128, v235, v128
    v_mul_f32 v129, v235, v129
    v_mul_f32 v130, v235, v130
    v_mul_f32 v131, v235, v131
    v_mul_f32 v132, v236, v132
    v_mul_f32 v133, v236, v133
    v_mul_f32 v134, v236, v134
    v_mul_f32 v135, v236, v135
    v_mul_f32 v136, v236, v136
    v_mul_f32 v137, v236, v137
    v_mul_f32 v138, v236, v138
    v_mul_f32 v139, v236, v139
    v_mul_f32 v140, v236, v140
    v_mul_f32 v141, v236, v141
    v_mul_f32 v142, v236, v142
    v_mul_f32 v143, v236, v143
    v_mul_f32 v144, v237, v144
    v_mul_f32 v145, v237, v145
    v_mul_f32 v146, v237, v146
    v_mul_f32 v147, v237, v147
    v_mul_f32 v148, v237, v148
    v_mul_f32 v149, v237, v149
    v_mul_f32 v150, v237, v150
    v_mul_f32 v151, v237, v151
    v_mul_f32 v152, v237, v152
    v_mul_f32 v153, v237, v153
    v_mul_f32 v154, v237, v154
    v_mul_f32 v155, v237, v155
    v_mul_f32 v156, v238, v156
    v_mul_f32 v157, v238, v157
    v_mul_f32 v158, v238, v158
    v_mul_f32 v159, v238, v159
    v_mul_f32 v160, v238, v160
    v_mul_f32 v161, v238, v161
    v_mul_f32 v162, v238, v162
    v_mul_f32 v163, v238, v163
    v_mul_f32 v164, v238, v164
    v_mul_f32 v165, v238, v165
    v_mul_f32 v166, v238, v166
    v_mul_f32 v167, v238, v167
L_nr_0_5:
    s_waitcnt lgkmcnt(4)
    v_mfma_f32_16x16x32_bf16 v[168:171], v[188:191], v[0:3], 0
    s_add_u32 s45, s32, 172032
    s_add_u32 m0, s30, 49152
    s_nop 0
    buffer_load_dwordx4 v241, s[12:15], s45 offen nt lds
    v_mfma_f32_16x16x32_bf16 v[172:175], v[188:191], v[24:27], 0
    s_add_u32 m0, s30, 50048
    s_nop 0
    buffer_load_dwordx4 v241, s[12:15], s45 offen offset:128 nt lds
    v_mfma_f32_16x16x32_bf16 v[176:179], v[188:191], v[48:51], 0
    s_add_u32 m0, s30, 50944
    s_nop 0
    buffer_load_dwordx4 v241, s[12:15], s45 offen offset:256 nt lds
    v_mfma_f32_16x16x32_bf16 v[180:183], v[188:191], v[72:75], 0
    v_mfma_f32_16x16x32_bf16 v[184:187], v[188:191], v[96:99], 0
    ds_read_b128 v[188:191], v245 offset:2048
    s_waitcnt lgkmcnt(4)
    v_mfma_f32_16x16x32_bf16 v[168:171], v[192:195], v[4:7], v[168:171]
    v_mfma_f32_16x16x32_bf16 v[172:175], v[192:195], v[28:31], v[172:175]
    v_mfma_f32_16x16x32_bf16 v[176:179], v[192:195], v[52:55], v[176:179]
    v_mfma_f32_16x16x32_bf16 v[180:183], v[192:195], v[76:79], v[180:183]
    v_mfma_f32_16x16x32_bf16 v[184:187], v[192:195], v[100:103], v[184:187]
    s_waitcnt lgkmcnt(3)
    v_mfma_f32_16x16x32_bf16 v[168:171], v[208:211], v[8:11], v[168:171]
    v_mfma_f32_16x16x32_bf16 v[172:175], v[208:211], v[32:35], v[172:175]
    v_mfma_f32_16x16x32_bf16 v[176:179], v[208:211], v[56:59], v[176:179]
    v_mfma_f32_16x16x32_bf16 v[180:183], v[208:211], v[80:83], v[180:183]
    v_mfma_f32_16x16x32_bf16 v[184:187], v[208:211], v[104:107], v[184:187]
    s_waitcnt lgkmcnt(2)
    v_mfma_f32_16x16x32_bf16 v[168:171], v[212:215], v[12:15], v[168:171]
    v_mfma_f32_16x16x32_bf16 v[172:175], v[212:215], v[36:39], v[172:175]
    v_mfma_f32_16x16x32_bf16 v[176:179], v[212:215], v[60:63], v[176:179]
    v_mfma_f32_16x16x32_bf16 v[180:183], v[212:215], v[84:87], v[180:183]
    v_mfma_f32_16x16x32_bf16 v[184:187], v[212:215], v[108:111], v[184:187]
    s_waitcnt lgkmcnt(1)
    v_mfma_f32_16x16x32_bf16 v[168:171], v[216:219], v[16:19], v[168:171]
    v_mfma_f32_16x16x32_bf16 v[172:175], v[216:219], v[40:43], v[172:175]
    v_mfma_f32_16x16x32_bf16 v[176:179], v[216:219], v[64:67], v[176:179]
    v_mfma_f32_16x16x32_bf16 v[180:183], v[216:219], v[88:91], v[180:183]
    v_mfma_f32_16x16x32_bf16 v[184:187], v[216:219], v[112:115], v[184:187]
    s_waitcnt lgkmcnt(0)
    v_mfma_f32_16x16x32_bf16 v[168:171], v[188:191], v[20:23], v[168:171]
    v_mfma_f32_16x16x32_bf16 v[172:175], v[188:191], v[44:47], v[172:175]
    v_mfma_f32_16x16x32_bf16 v[176:179], v[188:191], v[68:71], v[176:179]
    v_mfma_f32_16x16x32_bf16 v[180:183], v[188:191], v[92:95], v[180:183]
    v_mfma_f32_16x16x32_bf16 v[184:187], v[188:191], v[116:119], v[184:187]
    s_nop 3
    v_max3_f32 v253, v168, v169, v170
    v_max_f32 v253, v253, v171
    ds_max_f32 v251, v253 offset:12
    v_max3_f32 v254, v172, v173, v174
    v_max_f32 v254, v254, v175
    ds_max_f32 v251, v254 offset:16
    v_max3_f32 v253, v176, v177, v178
    v_max_f32 v253, v253, v179
    ds_max_f32 v251, v253 offset:20
    v_max3_f32 v254, v180, v181, v182
    v_max_f32 v254, v254, v183
    ds_max_f32 v251, v254 offset:24
    v_max3_f32 v253, v184, v185, v186
    v_max_f32 v253, v253, v187
    ds_max_f32 v251, v253 offset:28
    s_waitcnt lgkmcnt(0)
    s_barrier
    ds_read_b32 v228, v251 offset:12
    ds_read_b128 v[220:223], v251 offset:16
    v_subrev_u32 v246, 49152, v246
    v_subrev_u32 v247, 49152, v247
    v_subrev_u32 v248, 49152, v248
    ds_read_b64_tr_b16 v[196:197], v246
    ds_read_b64_tr_b16 v[198:199], v246 offset:6144
    ds_read_b64_tr_b16 v[200:201], v247
    ds_read_b64_tr_b16 v[202:203], v247 offset:6144
    ds_read_b64_tr_b16 v[204:205], v248
    ds_read_b64_tr_b16 v[206:207], v248 offset:6144
    ds_read_b128 v[208:211], v249 offset:18432
    ds_read_b128 v[212:215], v249 offset:20480
    ds_read_b128 v[216:219], v249 offset:22528
    s_waitcnt lgkmcnt(2)
    v_mfma_f32_16x16x32_bf16 v[120:123], v[196:199], v[208:211], v[120:123]
    v_mul_f32 v228, s37, v228
    v_mul_f32 v220, s37, v220
    v_mul_f32 v221, s37, v221
    v_mul_f32 v222, s37, v222
    v_mul_f32 v223, s37, v223
    v_mfma_f32_16x16x32_bf16 v[124:127], v[200:203], v[208:211], v[124:127]
    v_sub_f32 v235, v228, v229
    v_sub_f32 v236, v220, v224
    v_sub_f32 v237, v221, v225
    v_sub_f32 v238, v222, v226
    v_mfma_f32_16x16x32_bf16 v[128:131], v[204:207], v[208:211], v[128:131]
    v_sub_f32 v239, v223, v227
    v_cmp_lt_f32 s[78:79], 4.0, v235
    v_cmp_lt_f32 s[80:81], 4.0, v236
    v_cmp_lt_f32 s[82:83], 4.0, v237
    ds_read_b128 v[208:211], v249 offset:24576
    s_waitcnt lgkmcnt(2)
    v_mfma_f32_16x16x32_bf16 v[132:135], v[196:199], v[212:215], v[132:135]
    v_cmp_lt_f32 s[84:85], 4.0, v238
    v_cmp_lt_f32 s[86:87], 4.0, v239
    v_cndmask_b32 v228, v229, v228, s[78:79]
    v_cndmask_b32 v220, v224, v220, s[80:81]
    v_mfma_f32_16x16x32_bf16 v[136:139], v[200:203], v[212:215], v[136:139]
    v_cndmask_b32 v221, v225, v221, s[82:83]
    v_cndmask_b32 v222, v226, v222, s[84:85]
    v_cndmask_b32 v223, v227, v223, s[86:87]
    s_or_b64 s[76:77], s[78:79], s[80:81]
    s_or_b64 s[82:83], s[82:83], s[84:85]
    s_or_b64 s[76:77], s[76:77], s[86:87]
    s_or_b64 s[76:77], s[76:77], s[82:83]
    s_cbranch_scc0 L_nl_0_6
    v_sub_f32 v235, v229, v228
    v_sub_f32 v236, v224, v220
    v_sub_f32 v237, v225, v221
    v_sub_f32 v238, v226, v222
    v_sub_f32 v239, v227, v223
    v_exp_f32 v235, v235
    v_exp_f32 v236, v236
    v_exp_f32 v237, v237
    v_exp_f32 v238, v238
    v_exp_f32 v239, v239
    v_mul_f32 v230, v235, v230
    v_mul_f32 v231, v236, v231
    v_mul_f32 v232, v237, v232
    v_mul_f32 v233, v238, v233
    v_mul_f32 v234, v239, v234
L_nl_0_6:
    v_mfma_f32_16x16x32_bf16 v[140:143], v[204:207], v[212:215], v[140:143]
    v_fma_f32 v168, v168, s37, -v228
    v_fma_f32 v169, v169, s37, -v228
    v_fma_f32 v170, v170, s37, -v228
    v_fma_f32 v171, v171, s37, -v228
    v_fma_f32 v172, v172, s37, -v220
    ds_read_b128 v[212:215], v249 offset:19456
    s_waitcnt lgkmcnt(2)
    v_mfma_f32_16x16x32_bf16 v[144:147], v[196:199], v[216:219], v[144:147]
    v_fma_f32 v173, v173, s37, -v220
    v_fma_f32 v174, v174, s37, -v220
    v_fma_f32 v175, v175, s37, -v220
    v_fma_f32 v176, v176, s37, -v221
    v_mfma_f32_16x16x32_bf16 v[148:151], v[200:203], v[216:219], v[148:151]
    v_fma_f32 v177, v177, s37, -v221
    v_fma_f32 v178, v178, s37, -v221
    v_fma_f32 v179, v179, s37, -v221
    v_fma_f32 v180, v180, s37, -v222
    v_mfma_f32_16x16x32_bf16 v[152:155], v[204:207], v[216:219], v[152:155]
    v_fma_f32 v181, v181, s37, -v222
    v_fma_f32 v182, v182, s37, -v222
    v_fma_f32 v183, v183, s37, -v222
    v_fma_f32 v184, v184, s37, -v223
    ds_read_b128 v[216:219], v249 offset:21504
    s_waitcnt lgkmcnt(2)
    v_mfma_f32_16x16x32_bf16 v[156:159], v[196:199], v[208:211], v[156:159]
    v_fma_f32 v185, v185, s37, -v223
    v_fma_f32 v186, v186, s37, -v223
    v_fma_f32 v187, v187, s37, -v223
    v_exp_f32 v168, v168
    ds_read_b64_tr_b16 v[196:197], v246 offset:12288
    ds_read_b64_tr_b16 v[198:199], v246 offset:18432
    v_mfma_f32_16x16x32_bf16 v[160:163], v[200:203], v[208:211], v[160:163]
    v_exp_f32 v169, v169
    v_exp_f32 v170, v170
    v_exp_f32 v171, v171
    v_exp_f32 v172, v172
    ds_read_b64_tr_b16 v[200:201], v247 offset:12288
    ds_read_b64_tr_b16 v[202:203], v247 offset:18432
    v_mfma_f32_16x16x32_bf16 v[164:167], v[204:207], v[208:211], v[164:167]
    v_exp_f32 v173, v173
    v_exp_f32 v174, v174
    v_exp_f32 v175, v175
    v_exp_f32 v176, v176
    v_exp_f32 v177, v177
    ds_read_b64_tr_b16 v[204:205], v248 offset:12288
    ds_read_b64_tr_b16 v[206:207], v248 offset:18432
    ds_read_b128 v[208:211], v249 offset:23552
    s_waitcnt lgkmcnt(5)
    v_mfma_f32_16x16x32_bf16 v[120:123], v[196:199], v[212:215], v[120:123]
    v_exp_f32 v178, v178
    v_exp_f32 v179, v179
    v_exp_f32 v180, v180
    v_exp_f32 v181, v181
    s_waitcnt lgkmcnt(3)
    v_mfma_f32_16x16x32_bf16 v[124:127], v[200:203], v[212:215], v[124:127]
    v_exp_f32 v182, v182
    v_exp_f32 v183, v183
    v_exp_f32 v184, v184
    v_exp_f32 v185, v185
    s_waitcnt lgkmcnt(1)
    v_mfma_f32_16x16x32_bf16 v[128:131], v[204:207], v[212:215], v[128:131]
    v_exp_f32 v186, v186
    v_exp_f32 v187, v187
    v_add_f32 v230, v230, v168
    v_add_f32 v252, v169, v170
    ds_read_b128 v[212:215], v249 offset:25600
    v_mfma_f32_16x16x32_bf16 v[132:135], v[196:199], v[216:219], v[132:135]
    v_add_f32 v230, v230, v171
    v_cvt_pk_bf16_f32 v168, v168, v169
    v_add_f32 v230, v230, v252
    v_cvt_pk_bf16_f32 v169, v170, v171
    v_mfma_f32_16x16x32_bf16 v[136:139], v[200:203], v[216:219], v[136:139]
    ds_write_b64 v250, v[168:169]
    v_add_f32 v231, v231, v172
    v_add_f32 v252, v173, v174
    v_add_f32 v231, v231, v175
    v_mfma_f32_16x16x32_bf16 v[140:143], v[204:207], v[216:219], v[140:143]
    v_cvt_pk_bf16_f32 v172, v172, v173
    v_add_f32 v231, v231, v252
    v_cvt_pk_bf16_f32 v173, v174, v175
    ds_write_b64 v250, v[172:173] offset:2048
    v_add_f32 v232, v232, v176
    s_waitcnt lgkmcnt(3)
    v_mfma_f32_16x16x32_bf16 v[144:147], v[196:199], v[208:211], v[144:147]
    v_add_f32 v252, v177, v178
    v_add_f32 v232, v232, v179
    v_cvt_pk_bf16_f32 v176, v176, v177
    v_add_f32 v232, v232, v252
    v_mfma_f32_16x16x32_bf16 v[148:151], v[200:203], v[208:211], v[148:151]
    v_cvt_pk_bf16_f32 v177, v178, v179
    ds_write_b64 v250, v[176:177] offset:4096
    v_add_f32 v233, v233, v180
    v_add_f32 v252, v181, v182
    v_mfma_f32_16x16x32_bf16 v[152:155], v[204:207], v[208:211], v[152:155]
    v_add_f32 v233, v233, v183
    v_cvt_pk_bf16_f32 v180, v180, v181
    v_add_f32 v233, v233, v252
    v_cvt_pk_bf16_f32 v181, v182, v183
    s_waitcnt lgkmcnt(3)
    v_mfma_f32_16x16x32_bf16 v[156:159], v[196:199], v[212:215], v[156:159]
    ds_write_b64 v250, v[180:181] offset:6144
    v_add_f32 v234, v234, v184
    v_add_f32 v252, v185, v186
    v_add_f32 v234, v234, v187
    v_mfma_f32_16x16x32_bf16 v[160:163], v[200:203], v[212:215], v[160:163]
    v_cvt_pk_bf16_f32 v184, v184, v185
    v_add_f32 v234, v234, v252
    v_cvt_pk_bf16_f32 v185, v186, v187
    ds_write_b64 v250, v[184:185] offset:8192
    v_mfma_f32_16x16x32_bf16 v[164:167], v[204:207], v[212:215], v[164:167]
    s_waitcnt vmcnt(3)
    s_waitcnt lgkmcnt(0)
    s_barrier
    ds_read_b128 v[188:191], v244 offset:24576
    ds_read_b128 v[192:195], v245 offset:24576
    ds_read_b128 v[208:211], v244 offset:25600
    ds_read_b128 v[212:215], v245 offset:25600
    ds_read_b128 v[216:219], v244 offset:26624
    s_cmp_eq_u64 s[76:77], 0
    s_cbranch_scc1 L_nr_0_6
    v_mul_f32 v120, v235, v120
    v_mul_f32 v121, v235, v121
    v_mul_f32 v122, v235, v122
    v_mul_f32 v123, v235, v123
    v_mul_f32 v124, v235, v124
    v_mul_f32 v125, v235, v125
    v_mul_f32 v126, v235, v126
    v_mul_f32 v127, v235, v127
    v_mul_f32 v128, v235, v128
    v_mul_f32 v129, v235, v129
    v_mul_f32 v130, v235, v130
    v_mul_f32 v131, v235, v131
    v_mul_f32 v132, v236, v132
    v_mul_f32 v133, v236, v133
    v_mul_f32 v134, v236, v134
    v_mul_f32 v135, v236, v135
    v_mul_f32 v136, v236, v136
    v_mul_f32 v137, v236, v137
    v_mul_f32 v138, v236, v138
    v_mul_f32 v139, v236, v139
    v_mul_f32 v140, v236, v140
    v_mul_f32 v141, v236, v141
    v_mul_f32 v142, v236, v142
    v_mul_f32 v143, v236, v143
    v_mul_f32 v144, v237, v144
    v_mul_f32 v145, v237, v145
    v_mul_f32 v146, v237, v146
    v_mul_f32 v147, v237, v147
    v_mul_f32 v148, v237, v148
    v_mul_f32 v149, v237, v149
    v_mul_f32 v150, v237, v150
    v_mul_f32 v151, v237, v151
    v_mul_f32 v152, v237, v152
    v_mul_f32 v153, v237, v153
    v_mul_f32 v154, v237, v154
    v_mul_f32 v155, v237, v155
    v_mul_f32 v156, v238, v156
    v_mul_f32 v157, v238, v157
    v_mul_f32 v158, v238, v158
    v_mul_f32 v159, v238, v159
    v_mul_f32 v160, v238, v160
    v_mul_f32 v161, v238, v161
    v_mul_f32 v162, v238, v162
    v_mul_f32 v163, v238, v163
    v_mul_f32 v164, v238, v164
    v_mul_f32 v165, v238, v165
    v_mul_f32 v166, v238, v166
    v_mul_f32 v167, v238, v167
L_nr_0_6:
    s_waitcnt lgkmcnt(4)
    v_mfma_f32_16x16x32_bf16 v[168:171], v[188:191], v[0:3], 0
    v_min_u32 v254, 29, v240
    v_mul_u32_u24 v255, 43, v254
    v_lshrrev_b32 v255, 7, v255
    v_mul_u32_u24 v253, 3, v255
    v_sub_u32 v254, v254, v253
    v_lshlrev_b32 v254, 7, v254
    v_mul_u32_u24 v255, 12288, v255
    v_add_u32 v254, v254, v255
    s_add_u32 s47, s74, s42
    buffer_load_dword v255, v254, s[16:19], s47 offen
    v_mfma_f32_16x16x32_bf16 v[172:175], v[188:191], v[24:27], 0
    v_min_u32 v254, 44, v240
    v_lshlrev_b32 v254, 7, v254
    buffer_load_dword v255, v254, s[20:23], s75 offen
    v_mfma_f32_16x16x32_bf16 v[176:179], v[188:191], v[48:51], 0
    s_add_u32 s45, s42, 0
    s_add_u32 m0, s30, 0
    s_nop 0
    buffer_load_dwordx4 v242, s[16:19], s45 offen lds
    v_mfma_f32_16x16x32_bf16 v[180:183], v[188:191], v[72:75], 0
    s_add_u32 m0, s30, 896
    s_nop 0
    buffer_load_dwordx4 v242, s[16:19], s45 offen offset:128 lds
    v_mfma_f32_16x16x32_bf16 v[184:187], v[188:191], v[96:99], 0
    s_add_u32 m0, s30, 1792
    s_nop 0
    buffer_load_dwordx4 v242, s[16:19], s45 offen offset:256 lds
    ds_read_b128 v[188:191], v245 offset:26624
    s_waitcnt lgkmcnt(4)
    v_mfma_f32_16x16x32_bf16 v[168:171], v[192:195], v[4:7], v[168:171]
    v_mfma_f32_16x16x32_bf16 v[172:175], v[192:195], v[28:31], v[172:175]
    v_mfma_f32_16x16x32_bf16 v[176:179], v[192:195], v[52:55], v[176:179]
    v_mfma_f32_16x16x32_bf16 v[180:183], v[192:195], v[76:79], v[180:183]
    v_mfma_f32_16x16x32_bf16 v[184:187], v[192:195], v[100:103], v[184:187]
    s_waitcnt lgkmcnt(3)
    v_mfma_f32_16x16x32_bf16 v[168:171], v[208:211], v[8:11], v[168:171]
    v_mfma_f32_16x16x32_bf16 v[172:175], v[208:211], v[32:35], v[172:175]
    v_mfma_f32_16x16x32_bf16 v[176:179], v[208:211], v[56:59], v[176:179]
    v_mfma_f32_16x16x32_bf16 v[180:183], v[208:211], v[80:83], v[180:183]
    v_mfma_f32_16x16x32_bf16 v[184:187], v[208:211], v[104:107], v[184:187]
    s_waitcnt lgkmcnt(2)
    v_mfma_f32_16x16x32_bf16 v[168:171], v[212:215], v[12:15], v[168:171]
    v_mfma_f32_16x16x32_bf16 v[172:175], v[212:215], v[36:39], v[172:175]
    v_mfma_f32_16x16x32_bf16 v[176:179], v[212:215], v[60:63], v[176:179]
    v_mfma_f32_16x16x32_bf16 v[180:183], v[212:215], v[84:87], v[180:183]
    v_mfma_f32_16x16x32_bf16 v[184:187], v[212:215], v[108:111], v[184:187]
    s_waitcnt lgkmcnt(1)
    v_mfma_f32_16x16x32_bf16 v[168:171], v[216:219], v[16:19], v[168:171]
    v_mfma_f32_16x16x32_bf16 v[172:175], v[216:219], v[40:43], v[172:175]
    v_mfma_f32_16x16x32_bf16 v[176:179], v[216:219], v[64:67], v[176:179]
    v_mfma_f32_16x16x32_bf16 v[180:183], v[216:219], v[88:91], v[180:183]
    v_mfma_f32_16x16x32_bf16 v[184:187], v[216:219], v[112:115], v[184:187]
    s_waitcnt lgkmcnt(0)
    v_mfma_f32_16x16x32_bf16 v[168:171], v[188:191], v[20:23], v[168:171]
    v_mfma_f32_16x16x32_bf16 v[172:175], v[188:191], v[44:47], v[172:175]
    v_mfma_f32_16x16x32_bf16 v[176:179], v[188:191], v[68:71], v[176:179]
    v_mfma_f32_16x16x32_bf16 v[180:183], v[188:191], v[92:95], v[180:183]
    v_mfma_f32_16x16x32_bf16 v[184:187], v[188:191], v[116:119], v[184:187]
    s_nop 3
    v_max3_f32 v253, v168, v169, v170
    v_max_f32 v253, v253, v171
    ds_max_f32 v251, v253 offset:780
    v_max3_f32 v254, v172, v173, v174
    v_max_f32 v254, v254, v175
    ds_max_f32 v251, v254 offset:784
    v_max3_f32 v253, v176, v177, v178
    v_max_f32 v253, v253, v179
    ds_max_f32 v251, v253 offset:788
    v_max3_f32 v254, v180, v181, v182
    v_max_f32 v254, v254, v183
    ds_max_f32 v251, v254 offset:792
    v_max3_f32 v253, v184, v185, v186
    v_max_f32 v253, v253, v187
    ds_max_f32 v251, v253 offset:796
    s_waitcnt lgkmcnt(0)
    s_barrier
    ds_read_b32 v229, v251 offset:780
    ds_read_b128 v[224:227], v251 offset:784
    v_add_u32 v246, 24576, v246
    v_add_u32 v247, 24576, v247
    v_add_u32 v248, 24576, v248
    ds_read_b64_tr_b16 v[196:197], v246
    ds_read_b64_tr_b16 v[198:199], v246 offset:6144
    ds_read_b64_tr_b16 v[200:201], v247
    ds_read_b64_tr_b16 v[202:203], v247 offset:6144
    ds_read_b64_tr_b16 v[204:205], v248
    ds_read_b64_tr_b16 v[206:207], v248 offset:6144
    ds_read_b128 v[208:211], v249
    ds_read_b128 v[212:215], v249 offset:2048
    ds_read_b128 v[216:219], v249 offset:4096
    s_waitcnt lgkmcnt(2)
    v_mfma_f32_16x16x32_bf16 v[120:123], v[196:199], v[208:211], v[120:123]
    v_mul_f32 v229, s37, v229
    v_mul_f32 v224, s37, v224
    v_mul_f32 v225, s37, v225
    v_mul_f32 v226, s37, v226
    v_mul_f32 v227, s37, v227
    s_add_u32 s45, s41, 0
    s_add_u32 m0, s30, 73728
    s_nop 0
    buffer_load_dwordx4 v241, s[8:11], s45 offen nt lds
    v_mfma_f32_16x16x32_bf16 v[124:127], v[200:203], v[208:211], v[124:127]
    v_sub_f32 v235, v229, v228
    v_sub_f32 v236, v224, v220
    v_sub_f32 v237, v225, v221
    v_sub_f32 v238, v226, v222
    s_add_u32 m0, s30, 74624
    s_nop 0
    buffer_load_dwordx4 v241, s[8:11], s45 offen offset:128 nt lds
    v_mfma_f32_16x16x32_bf16 v[128:131], v[204:207], v[208:211], v[128:131]
    v_sub_f32 v239, v227, v223
    v_cmp_lt_f32 s[78:79], 4.0, v235
    v_cmp_lt_f32 s[80:81], 4.0, v236
    v_cmp_lt_f32 s[82:83], 4.0, v237
    s_add_u32 m0, s30, 75520
    s_nop 0
    buffer_load_dwordx4 v241, s[8:11], s45 offen offset:256 nt lds
    ds_read_b128 v[208:211], v249 offset:6144
    s_waitcnt lgkmcnt(2)
    v_mfma_f32_16x16x32_bf16 v[132:135], v[196:199], v[212:215], v[132:135]
    v_cmp_lt_f32 s[84:85], 4.0, v238
    v_cmp_lt_f32 s[86:87], 4.0, v239
    v_cndmask_b32 v229, v228, v229, s[78:79]
    v_cndmask_b32 v224, v220, v224, s[80:81]
    v_mfma_f32_16x16x32_bf16 v[136:139], v[200:203], v[212:215], v[136:139]
    v_cndmask_b32 v225, v221, v225, s[82:83]
    v_cndmask_b32 v226, v222, v226, s[84:85]
    v_cndmask_b32 v227, v223, v227, s[86:87]
    s_or_b64 s[76:77], s[78:79], s[80:81]
    s_or_b64 s[82:83], s[82:83], s[84:85]
    s_or_b64 s[76:77], s[76:77], s[86:87]
    s_or_b64 s[76:77], s[76:77], s[82:83]
    s_cbranch_scc0 L_nl_0_7
    v_sub_f32 v235, v228, v229
    v_sub_f32 v236, v220, v224
    v_sub_f32 v237, v221, v225
    v_sub_f32 v238, v222, v226
    v_sub_f32 v239, v223, v227
    v_exp_f32 v235, v235
    v_exp_f32 v236, v236
    v_exp_f32 v237, v237
    v_exp_f32 v238, v238
    v_exp_f32 v239, v239
    v_mul_f32 v230, v235, v230
    v_mul_f32 v231, v236, v231
    v_mul_f32 v232, v237, v232
    v_mul_f32 v233, v238, v233
    v_mul_f32 v234, v239, v234
L_nl_0_7:
    v_mfma_f32_16x16x32_bf16 v[140:143], v[204:207], v[212:215], v[140:143]
    v_fma_f32 v168, v168, s37, -v229
    v_fma_f32 v169, v169, s37, -v229
    v_fma_f32 v170, v170, s37, -v229
    v_fma_f32 v171, v171, s37, -v229
    v_fma_f32 v172, v172, s37, -v224
    ds_read_b128 v[212:215], v249 offset:1024
    s_waitcnt lgkmcnt(2)
    v_mfma_f32_16x16x32_bf16 v[144:147], v[196:199], v[216:219], v[144:147]
    v_fma_f32 v173, v173, s37, -v224
    v_fma_f32 v174, v174, s37, -v224
    v_fma_f32 v175, v175, s37, -v224
    v_fma_f32 v176, v176, s37, -v225
    v_mfma_f32_16x16x32_bf16 v[148:151], v[200:203], v[216:219], v[148:151]
    v_fma_f32 v177, v177, s37, -v225
    v_fma_f32 v178, v178, s37, -v225
    v_fma_f32 v179, v179, s37, -v225
    v_fma_f32 v180, v180, s37, -v226
    v_mfma_f32_16x16x32_bf16 v[152:155], v[204:207], v[216:219], v[152:155]
    v_fma_f32 v181, v181, s37, -v226
    v_fma_f32 v182, v182, s37, -v226
    v_fma_f32 v183, v183, s37, -v226
    v_fma_f32 v184, v184, s37, -v227
    ds_read_b128 v[216:219], v249 offset:3072
    s_waitcnt lgkmcnt(2)
    v_mfma_f32_16x16x32_bf16 v[156:159], v[196:199], v[208:211], v[156:159]
    v_fma_f32 v185, v185, s37, -v227
    v_fma_f32 v186, v186, s37, -v227
    v_fma_f32 v187, v187, s37, -v227
    v_exp_f32 v168, v168
    ds_read_b64_tr_b16 v[196:197], v246 offset:12288
    ds_read_b64_tr_b16 v[198:199], v246 offset:18432
    v_mfma_f32_16x16x32_bf16 v[160:163], v[200:203], v[208:211], v[160:163]
    v_exp_f32 v169, v169
    v_exp_f32 v170, v170
    v_exp_f32 v171, v171
    v_exp_f32 v172, v172
    ds_read_b64_tr_b16 v[200:201], v247 offset:12288
    ds_read_b64_tr_b16 v[202:203], v247 offset:18432
    v_mfma_f32_16x16x32_bf16 v[164:167], v[204:207], v[208:211], v[164:167]
    v_exp_f32 v173, v173
    v_exp_f32 v174, v174
    v_exp_f32 v175, v175
    v_exp_f32 v176, v176
    v_exp_f32 v177, v177
    ds_read_b64_tr_b16 v[204:205], v248 offset:12288
    ds_read_b64_tr_b16 v[206:207], v248 offset:18432
    ds_read_b128 v[208:211], v249 offset:5120
    s_waitcnt lgkmcnt(5)
    v_mfma_f32_16x16x32_bf16 v[120:123], v[196:199], v[212:215], v[120:123]
    v_exp_f32 v178, v178
    v_exp_f32 v179, v179
    v_exp_f32 v180, v180
    v_exp_f32 v181, v181
    s_waitcnt lgkmcnt(3)
    v_mfma_f32_16x16x32_bf16 v[124:127], v[200:203], v[212:215], v[124:127]
    v_exp_f32 v182, v182
    v_exp_f32 v183, v183
    v_exp_f32 v184, v184
    v_exp_f32 v185, v185
    s_waitcnt lgkmcnt(1)
    v_mfma_f32_16x16x32_bf16 v[128:131], v[204:207], v[212:215], v[128:131]
    v_exp_f32 v186, v186
    v_exp_f32 v187, v187
    v_add_f32 v230, v230, v168
    v_add_f32 v252, v169, v170
    ds_read_b128 v[212:215], v249 offset:7168
    v_mfma_f32_16x16x32_bf16 v[132:135], v[196:199], v[216:219], v[132:135]
    v_add_f32 v230, v230, v171
    v_cvt_pk_bf16_f32 v168, v168, v169
    v_add_f32 v230, v230, v252
    v_cvt_pk_bf16_f32 v169, v170, v171
    v_mfma_f32_16x16x32_bf16 v[136:139], v[200:203], v[216:219], v[136:139]
    ds_write_b64 v250, v[168:169] offset:18432
    v_add_f32 v231, v231, v172
    v_add_f32 v252, v173, v174
    v_add_f32 v231, v231, v175
    v_mfma_f32_16x16x32_bf16 v[140:143], v[204:207], v[216:219], v[140:143]
    v_cvt_pk_bf16_f32 v172, v172, v173
    v_add_f32 v231, v231, v252
    v_cvt_pk_bf16_f32 v173, v174, v175
    ds_write_b64 v250, v[172:173] offset:20480
    v_add_f32 v232, v232, v176
    s_waitcnt lgkmcnt(3)
    v_mfma_f32_16x16x32_bf16 v[144:147], v[196:199], v[208:211], v[144:147]
    v_add_f32 v252, v177, v178
    v_add_f32 v232, v232, v179
    v_cvt_pk_bf16_f32 v176, v176, v177
    v_add_f32 v232, v232, v252
    v_mfma_f32_16x16x32_bf16 v[148:151], v[200:203], v[208:211], v[148:151]
    v_cvt_pk_bf16_f32 v177, v178, v179
    ds_write_b64 v250, v[176:177] offset:22528
    v_add_f32 v233, v233, v180
    v_add_f32 v252, v181, v182
    v_mfma_f32_16x16x32_bf16 v[152:155], v[204:207], v[208:211], v[152:155]
    v_add_f32 v233, v233, v183
    v_cvt_pk_bf16_f32 v180, v180, v181
    v_add_f32 v233, v233, v252
    v_cvt_pk_bf16_f32 v181, v182, v183
    s_waitcnt lgkmcnt(3)
    v_mfma_f32_16x16x32_bf16 v[156:159], v[196:199], v[212:215], v[156:159]
    ds_write_b64 v250, v[180:181] offset:24576
    v_add_f32 v234, v234, v184
    v_add_f32 v252, v185, v186
    v_add_f32 v234, v234, v187
    v_mfma_f32_16x16x32_bf16 v[160:163], v[200:203], v[212:215], v[160:163]
    v_cvt_pk_bf16_f32 v184, v184, v185
    v_add_f32 v234, v234, v252
    v_cvt_pk_bf16_f32 v185, v186, v187
    ds_write_b64 v250, v[184:185] offset:26624
    v_mfma_f32_16x16x32_bf16 v[164:167], v[204:207], v[212:215], v[164:167]
    v_and_b32 v0, 15, v240
    v_lshrrev_b32 v1, 4, v240
    v_permlane16_swap_b32 v231, v232
    v_permlane16_swap_b32 v233, v234
    v_add_f32 v231, v231, v232
    v_add_f32 v233, v233, v234
    s_nop 1
    v_permlane32_swap_b32 v231, v233
    v_add_f32 v231, v231, v233
    s_lshl_b32 s45, s29, 2
    s_add_u32 s45, s45, 159744
    v_lshlrev_b32 v2, 4, v0
    v_add_u32 v2, s45, v2
    v_lshl_add_u32 v3, v1, 8, v2
    ds_write_b32 v3, v231 offset:256
    v_mov_b32 v5, v230
    s_nop 1
    v_permlane16_swap_b32 v230, v5
    v_add_f32 v230, v230, v5
    v_mov_b32 v5, v230
    s_nop 1
    v_permlane32_swap_b32 v230, v5
    v_add_f32 v230, v230, v5
    ds_write_b32 v2, v230
    s_waitcnt lgkmcnt(0)
    s_barrier
    s_cmp_eq_u64 s[76:77], 0
    s_cbranch_scc1 L_nr_0_7
    v_mul_f32 v120, v235, v120
    v_mul_f32 v121, v235, v121
    v_mul_f32 v122, v235, v122
    v_mul_f32 v123, v235, v123
    v_mul_f32 v124, v235, v124
    v_mul_f32 v125, v235, v125
    v_mul_f32 v126, v235, v126
    v_mul_f32 v127, v235, v127
    v_mul_f32 v128, v235, v128
    v_mul_f32 v129, v235, v129
    v_mul_f32 v130, v235, v130
    v_mul_f32 v131, v235, v131
    v_mul_f32 v132, v236, v132
    v_mul_f32 v133, v236, v133
    v_mul_f32 v134, v236, v134
    v_mul_f32 v135, v236, v135
    v_mul_f32 v136, v236, v136
    v_mul_f32 v137, v236, v137
    v_mul_f32 v138, v236, v138
    v_mul_f32 v139, v236, v139
    v_mul_f32 v140, v236, v140
    v_mul_f32 v141, v236, v141
    v_mul_f32 v142, v236, v142
    v_mul_f32 v143, v236, v143
    v_mul_f32 v144, v237, v144
    v_mul_f32 v145, v237, v145
    v_mul_f32 v146, v237, v146
    v_mul_f32 v147, v237, v147
    v_mul_f32 v148, v237, v148
    v_mul_f32 v149, v237, v149
    v_mul_f32 v150, v237, v150
    v_mul_f32 v151, v237, v151
    v_mul_f32 v152, v237, v152
    v_mul_f32 v153, v237, v153
    v_mul_f32 v154, v237, v154
    v_mul_f32 v155, v237, v155
    v_mul_f32 v156, v238, v156
    v_mul_f32 v157, v238, v157
    v_mul_f32 v158, v238, v158
    v_mul_f32 v159, v238, v159
    v_mul_f32 v160, v238, v160
    v_mul_f32 v161, v238, v161
    v_mul_f32 v162, v238, v162
    v_mul_f32 v163, v238, v163
    v_mul_f32 v164, v238, v164
    v_mul_f32 v165, v238, v165
    v_mul_f32 v166, v238, v166
    v_mul_f32 v167, v238, v167
L_nr_0_7:
    s_add_u32 s45, s42, 786432
    s_add_u32 m0, s30, 24576
    s_nop 0
    buffer_load_dwordx4 v242, s[16:19], s45 offen lds
    s_add_u32 m0, s30, 25472
    s_nop 0
    buffer_load_dwordx4 v242, s[16:19], s45 offen offset:128 lds
    s_add_u32 m0, s30, 26368
    s_nop 0
    buffer_load_dwordx4 v242, s[16:19], s45 offen offset:256 lds
    s_waitcnt vmcnt(11)
    s_barrier
    v_add_u32 v246, 24576, v246
    v_add_u32 v247, 24576, v247
    v_add_u32 v248, 24576, v248
    ds_read_b64_tr_b16 v[196:197], v246
    ds_read_b64_tr_b16 v[198:199], v246 offset:6144
    ds_read_b64_tr_b16 v[200:201], v247
    ds_read_b64_tr_b16 v[202:203], v247 offset:6144
    ds_read_b64_tr_b16 v[204:205], v248
    ds_read_b64_tr_b16 v[206:207], v248 offset:6144
    ds_read_b128 v[208:211], v249 offset:18432
    ds_read_b128 v[212:215], v249 offset:20480
    ds_read_b128 v[216:219], v249 offset:22528
    s_waitcnt lgkmcnt(2)
    v_mfma_f32_16x16x32_bf16 v[120:123], v[196:199], v[208:211], v[120:123]
    s_add_u32 s46, s34, 0
    s_add_u32 m0, s31, 122880
    s_nop 0
    buffer_load_dwordx4 v243, s[20:23], s46 offen lds
    s_add_u32 s46, s34, 9216
    buffer_load_dwordx4 v243, s[20:23], s46 offen offset:1024 lds
    s_add_u32 s46, s34, 18432
    s_mov_b64 exec, 0xffff
    buffer_load_dwordx4 v243, s[20:23], s46 offen offset:2048 lds
    s_mov_b64 exec, -1
    v_mfma_f32_16x16x32_bf16 v[124:127], v[200:203], v[208:211], v[124:127]
    s_add_u32 s46, s34, 256
    s_add_u32 m0, s31, 98304
    s_nop 0
    buffer_load_dwordx4 v243, s[20:23], s46 offen lds
    s_add_u32 s46, s34, 9472
    buffer_load_dwordx4 v243, s[20:23], s46 offen offset:1024 lds
    s_add_u32 s46, s34, 18688
    s_mov_b64 exec, 0xffff
    buffer_load_dwordx4 v243, s[20:23], s46 offen offset:2048 lds
    s_mov_b64 exec, -1
    v_mfma_f32_16x16x32_bf16 v[128:131], v[204:207], v[208:211], v[128:131]
    ds_read_b128 v[208:211], v249 offset:24576
    s_waitcnt lgkmcnt(2)
    v_mfma_f32_16x16x32_bf16 v[132:135], v[196:199], v[212:215], v[132:135]
    v_mfma_f32_16x16x32_bf16 v[136:139], v[200:203], v[212:215], v[136:139]
    v_mfma_f32_16x16x32_bf16 v[140:143], v[204:207], v[212:215], v[140:143]
    ds_read_b128 v[212:215], v249 offset:19456
    s_waitcnt lgkmcnt(2)
    v_mfma_f32_16x16x32_bf16 v[144:147], v[196:199], v[216:219], v[144:147]
    v_mfma_f32_16x16x32_bf16 v[148:151], v[200:203], v[216:219], v[148:151]
    v_mfma_f32_16x16x32_bf16 v[152:155], v[204:207], v[216:219], v[152:155]
    ds_read_b128 v[216:219], v249 offset:21504
    s_waitcnt lgkmcnt(2)
    v_mfma_f32_16x16x32_bf16 v[156:159], v[196:199], v[208:211], v[156:159]
    ds_read_b64_tr_b16 v[196:197], v246 offset:12288
    ds_read_b64_tr_b16 v[198:199], v246 offset:18432
    v_mfma_f32_16x16x32_bf16 v[160:163], v[200:203], v[208:211], v[160:163]
    ds_read_b64_tr_b16 v[200:201], v247 offset:12288
    ds_read_b64_tr_b16 v[202:203], v247 offset:18432
    v_mfma_f32_16x16x32_bf16 v[164:167], v[204:207], v[208:211], v[164:167]
    ds_read_b64_tr_b16 v[204:205], v248 offset:12288
    ds_read_b64_tr_b16 v[206:207], v248 offset:18432
    ds_read_b128 v[208:211], v249 offset:23552
    s_waitcnt lgkmcnt(5)
    v_mfma_f32_16x16x32_bf16 v[120:123], v[196:199], v[212:215], v[120:123]
    s_waitcnt lgkmcnt(3)
    v_mfma_f32_16x16x32_bf16 v[124:127], v[200:203], v[212:215], v[124:127]
    s_waitcnt lgkmcnt(1)
    v_mfma_f32_16x16x32_bf16 v[128:131], v[204:207], v[212:215], v[128:131]
    ds_read_b128 v[212:215], v249 offset:25600
    v_mfma_f32_16x16x32_bf16 v[132:135], v[196:199], v[216:219], v[132:135]
    v_mfma_f32_16x16x32_bf16 v[136:139], v[200:203], v[216:219], v[136:139]
    v_mfma_f32_16x16x32_bf16 v[140:143], v[204:207], v[216:219], v[140:143]
    s_waitcnt lgkmcnt(1)
    v_mfma_f32_16x16x32_bf16 v[144:147], v[196:199], v[208:211], v[144:147]
    v_mfma_f32_16x16x32_bf16 v[148:151], v[200:203], v[208:211], v[148:151]
    v_mfma_f32_16x16x32_bf16 v[152:155], v[204:207], v[208:211], v[152:155]
    s_waitcnt lgkmcnt(0)
    v_mfma_f32_16x16x32_bf16 v[156:159], v[196:199], v[212:215], v[156:159]
    v_mfma_f32_16x16x32_bf16 v[160:163], v[200:203], v[212:215], v[160:163]
    v_mfma_f32_16x16x32_bf16 v[164:167], v[204:207], v[212:215], v[164:167]
    v_and_b32 v0, 15, v240
    v_lshlrev_b32 v1, 4, v0
    v_add_u32 v1, 159744, v1
    v_lshlrev_b32 v2, 4, v240
    ds_read_b128 v[4:7], v1
    ds_read_b128 v[8:11], v1 offset:256
    ds_read_b128 v[12:15], v1 offset:512
    ds_read_b128 v[16:19], v1 offset:768
    s_waitcnt lgkmcnt(3)
    v_add_f32 v4, v4, v5
    v_add_f32 v6, v6, v7
    v_add_f32 v4, v4, v6
    v_rcp_f32 v4, v4
    s_waitcnt lgkmcnt(2)
    v_add_f32 v8, v8, v9
    v_add_f32 v10, v10, v11
    v_add_f32 v8, v8, v10
    v_rcp_f32 v8, v8
    s_waitcnt lgkmcnt(1)
    v_add_f32 v12, v12, v13
    v_add_f32 v14, v14, v15
    v_add_f32 v12, v12, v14
    v_rcp_f32 v12, v12
    s_waitcnt lgkmcnt(0)
    v_add_f32 v16, v16, v17
    v_add_f32 v18, v18, v19
    v_add_f32 v16, v16, v18
    v_rcp_f32 v16, v16
    v_mul_f32 v120, v4, v120
    v_mul_f32 v121, v4, v121
    v_mul_f32 v122, v4, v122
    v_mul_f32 v123, v4, v123
    v_mul_f32 v124, v4, v124
    v_mul_f32 v125, v4, v125
    v_mul_f32 v126, v4, v126
    v_mul_f32 v127, v4, v127
    v_mul_f32 v128, v4, v128
    v_mul_f32 v129, v4, v129
    v_mul_f32 v130, v4, v130
    v_mul_f32 v131, v4, v131
    v_cvt_pk_bf16_f32 v120, v120, v121
    v_cvt_pk_bf16_f32 v121, v122, v123
    v_cvt_pk_bf16_f32 v122, v124, v125
    v_cvt_pk_bf16_f32 v123, v126, v127
    v_cvt_pk_bf16_f32 v124, v128, v129
    v_cvt_pk_bf16_f32 v125, v130, v131
    s_add_u32 s45, s35, s43
    s_add_u32 s46, s35, s44
    buffer_store_dwordx4 v[120:123], v2, s[24:27], s45 offen
    buffer_store_dwordx2 v[124:125], v2, s[24:27], s46 offen
    v_mul_f32 v132, v8, v132
    v_mul_f32 v133, v8, v133
    v_mul_f32 v134, v8, v134
    v_mul_f32 v135, v8, v135
    v_mul_f32 v136, v8, v136
    v_mul_f32 v137, v8, v137
    v_mul_f32 v138, v8, v138
    v_mul_f32 v139, v8, v139
    v_mul_f32 v140, v8, v140
    v_mul_f32 v141, v8, v141
    v_mul_f32 v142, v8, v142
    v_mul_f32 v143, v8, v143
    v_cvt_pk_bf16_f32 v132, v132, v133
    v_cvt_pk_bf16_f32 v133, v134, v135
    v_cvt_pk_bf16_f32 v134, v136, v137
    v_cvt_pk_bf16_f32 v135, v138, v139
    v_cvt_pk_bf16_f32 v136, v140, v141
    v_cvt_pk_bf16_f32 v137, v142, v143
    s_add_u32 s45, s35, s43
    s_add_u32 s46, s35, s44
    buffer_store_dwordx4 v[132:135], v2, s[24:27], s45 offen offset:1024
    buffer_store_dwordx2 v[136:137], v2, s[24:27], s46 offen offset:1024
    v_mul_f32 v144, v12, v144
    v_mul_f32 v145, v12, v145
    v_mul_f32 v146, v12, v146
    v_mul_f32 v147, v12, v147
    v_mul_f32 v148, v12, v148
    v_mul_f32 v149, v12, v149
    v_mul_f32 v150, v12, v150
    v_mul_f32 v151, v12, v151
    v_mul_f32 v152, v12, v152
    v_mul_f32 v153, v12, v153
    v_mul_f32 v154, v12, v154
    v_mul_f32 v155, v12, v155
    v_cvt_pk_bf16_f32 v144, v144, v145
    v_cvt_pk_bf16_f32 v145, v146, v147
    v_cvt_pk_bf16_f32 v146, v148, v149
    v_cvt_pk_bf16_f32 v147, v150, v151
    v_cvt_pk_bf16_f32 v148, v152, v153
    v_cvt_pk_bf16_f32 v149, v154, v155
    s_add_u32 s45, s35, s43
    s_add_u32 s46, s35, s44
    buffer_store_dwordx4 v[144:147], v2, s[24:27], s45 offen offset:2048
    buffer_store_dwordx2 v[148:149], v2, s[24:27], s46 offen offset:2048
    v_mul_f32 v156, v16, v156
    v_mul_f32 v157, v16, v157
    v_mul_f32 v158, v16, v158
    v_mul_f32 v159, v16, v159
    v_mul_f32 v160, v16, v160
    v_mul_f32 v161, v16, v161
    v_mul_f32 v162, v16, v162
    v_mul_f32 v163, v16, v163
    v_mul_f32 v164, v16, v164
    v_mul_f32 v165, v16, v165
    v_mul_f32 v166, v16, v166
    v_mul_f32 v167, v16, v167
    v_cvt_pk_bf16_f32 v156, v156, v157
    v_cvt_pk_bf16_f32 v157, v158, v159
    v_cvt_pk_bf16_f32 v158, v160, v161
    v_cvt_pk_bf16_f32 v159, v162, v163
    v_cvt_pk_bf16_f32 v160, v164, v165
    v_cvt_pk_bf16_f32 v161, v166, v167
    s_add_u32 s45, s35, s43
    s_add_u32 s46, s35, s44
    buffer_store_dwordx4 v[156:159], v2, s[24:27], s45 offen offset:3072
    buffer_store_dwordx2 v[160:161], v2, s[24:27], s46 offen offset:3072
    s_waitcnt vmcnt(11)
    s_barrier
    s_mov_b32 s32, s41
    s_mov_b32 s33, s42
    s_add_u32 s41, s41, 196608
    s_add_u32 s42, s42, 384
    s_add_u32 s35, s35, 884736
    s_add_u32 s36, s36, 1
    s_nop 9
    s_cmp_lt_u32 s36, 4
    s_cbranch_scc1 L_head_0
    s_endpgm
L_grp1:
    s_nop 9
    v_and_b32 v240, 63, v0
    v_lshrrev_b32 v252, 3, v240
    v_lshrrev_b32 v253, 4, v240
    v_lshlrev_b32 v253, 1, v253
    v_and_b32 v254, 7, v240
    v_xor_b32 v253, v253, v254
    v_lshlrev_b32 v253, 4, v253
    v_mul_u32_u24 v241, 384, v252
    v_add3_u32 v241, v241, v253, s30
    s_and_b32 s45, s28, 1
    s_lshl_b32 s45, s45, 2
    v_bfe_u32 v253, v240, 4, 1
    v_lshlrev_b32 v253, 1, v253
    v_or_b32 v253, s45, v253
    v_xor_b32 v253, v253, v254
    v_lshlrev_b32 v253, 4, v253
    v_mul_u32_u24 v242, 12288, v252
    s_mul_i32 s45, s28, 98304
    v_add3_u32 v242, v242, v253, s45
    s_mul_i32 s45, s28, 9
    v_lshrrev_b32 v253, 4, v240
    v_add_u32 v253, s45, v253
    v_and_b32 v253, 3, v253
    v_lshlrev_b32 v253, 1, v253
    v_xor_b32 v253, v253, v254
    v_lshlrev_b32 v253, 4, v253
    v_mul_u32_u24 v243, 1280, v252
    s_mul_i32 s45, s28, 23040
    v_add3_u32 v243, v243, v253, s45
    v_lshlrev_b32 v252, 4, v240
    v_add_u32 v249, 122880, v252
    s_and_b32 s45, s29, 1
    s_lshl_b32 s45, s45, 3
    s_lshr_b32 s46, s29, 1
    s_lshl_b32 s46, s46, 10
    s_add_u32 s45, s45, s46
    v_add_u32 v250, s45, v249
    v_and_b32 v252, 15, v240
    v_mul_u32_u24 v252, 48, v252
    v_add_u32 v251, 162048, v252
    s_add_u32 s45, s33, 0
    s_add_u32 m0, s30, 0
    s_nop 0
    buffer_load_dwordx4 v242, s[16:19], s45 offen lds
    s_add_u32 m0, s30, 896
    s_nop 0
    buffer_load_dwordx4 v242, s[16:19], s45 offen offset:128 lds
    s_add_u32 m0, s30, 1792
    s_nop 0
    buffer_load_dwordx4 v242, s[16:19], s45 offen offset:256 lds
    s_add_u32 s45, s33, 786432
    s_add_u32 m0, s30, 24576
    s_nop 0
    buffer_load_dwordx4 v242, s[16:19], s45 offen lds
    s_add_u32 m0, s30, 25472
    s_nop 0
    buffer_load_dwordx4 v242, s[16:19], s45 offen offset:128 lds
    s_add_u32 m0, s30, 26368
    s_nop 0
    buffer_load_dwordx4 v242, s[16:19], s45 offen offset:256 lds
    s_add_u32 s46, s34, 0
    s_add_u32 m0, s31, 122880
    s_nop 0
    buffer_load_dwordx4 v243, s[20:23], s46 offen lds
    s_add_u32 s46, s34, 9216
    buffer_load_dwordx4 v243, s[20:23], s46 offen offset:1024 lds
    s_add_u32 s46, s34, 18432
    s_mov_b64 exec, 0xffff
    buffer_load_dwordx4 v243, s[20:23], s46 offen offset:2048 lds
    s_mov_b64 exec, -1
    s_add_u32 s46, s34, 256
    s_add_u32 m0, s31, 98304
    s_nop 0
    buffer_load_dwordx4 v243, s[20:23], s46 offen lds
    s_add_u32 s46, s34, 9472
    buffer_load_dwordx4 v243, s[20:23], s46 offen offset:1024 lds
    s_add_u32 s46, s34, 18688
    s_mov_b64 exec, 0xffff
    buffer_load_dwordx4 v243, s[20:23], s46 offen offset:2048 lds
    s_mov_b64 exec, -1
    s_add_u32 s45, s32, 0
    s_add_u32 m0, s30, 73728
    s_nop 0
    buffer_load_dwordx4 v241, s[8:11], s45 offen nt lds
    s_add_u32 m0, s30, 74624
    s_nop 0
    buffer_load_dwordx4 v241, s[8:11], s45 offen offset:128 nt lds
    s_add_u32 m0, s30, 75520
    s_nop 0
    buffer_load_dwordx4 v241, s[8:11], s45 offen offset:256 nt lds
    v_min_u32 v254, 59, v240
    v_lshlrev_b32 v254, 7, v254
    buffer_load_dword v255, v254, s[88:91], s92 offen
    s_waitcnt vmcnt(0)
    s_barrier
    s_waitcnt vmcnt(0)
    s_nop 9
L_head_1:
    v_and_b32 v188, 15, v240
    v_lshrrev_b32 v189, 4, v240
    v_bfe_u32 v190, v240, 2, 2
    v_and_b32 v191, 3, v240
    v_lshrrev_b32 v192, 1, v190
    v_and_b32 v193, 1, v189
    v_lshl_add_u32 v192, v193, 1, v192
    v_lshlrev_b32 v192, 1, v192
    v_mul_u32_u24 v195, 3072, v189
    v_lshl_add_u32 v195, v190, 7, v195
    v_and_b32 v193, 1, v191
    v_lshl_add_u32 v195, v193, 3, v195
    v_lshrrev_b32 v191, 1, v191
    s_lshl_b32 s45, s38, 1
    v_add_u32 v193, s45, v191
    v_lshrrev_b32 v194, 3, v193
    v_and_b32 v193, 7, v193
    v_xor_b32 v193, v193, v192
    v_lshl_add_u32 v193, v193, 4, v195
    v_lshl_add_u32 v246, v194, 10, v193
    s_lshl_b32 s45, s39, 1
    v_add_u32 v193, s45, v191
    v_lshrrev_b32 v194, 3, v193
    v_and_b32 v193, 7, v193
    v_xor_b32 v193, v193, v192
    v_lshl_add_u32 v193, v193, 4, v195
    v_lshl_add_u32 v247, v194, 10, v193
    s_lshl_b32 s45, s40, 1
    v_add_u32 v193, s45, v191
    v_lshrrev_b32 v194, 3, v193
    v_and_b32 v193, 7, v193
    v_xor_b32 v193, v193, v192
    v_lshl_add_u32 v193, v193, 4, v195
    v_lshl_add_u32 v248, v194, 10, v193
    v_and_b32 v188, 15, v240
    v_lshrrev_b32 v189, 4, v240
    v_and_b32 v190, 6, v188
    v_xor_b32 v191, v189, v190
    v_lshlrev_b32 v191, 4, v191
    v_lshl_add_u32 v191, v188, 7, v191
    v_add_u32 v244, 98304, v191
    v_xor_b32 v245, 64, v244
    v_mov_b32 v188, 0xff800000
    v_mov_b32 v189, 0xff800000
    v_lshlrev_b32 v190, 3, v240
    v_add_u32 v190, 162048, v190
    ds_write_b64 v190, v[188:189]
    ds_write_b64 v190, v[188:189] offset:512
    ds_write_b64 v190, v[188:189] offset:1024
    ds_read_b64_tr_b16 v[96:97], v246
    ds_read_b64_tr_b16 v[98:99], v246 offset:512
    ds_read_b64_tr_b16 v[100:101], v247
    ds_read_b64_tr_b16 v[102:103], v247 offset:512
    ds_read_b64_tr_b16 v[104:105], v248
    ds_read_b64_tr_b16 v[106:107], v248 offset:512
    ds_read_b128 v[120:123], v244 offset:34816
    ds_read_b128 v[124:127], v244 offset:36864
    ds_read_b128 v[128:131], v244 offset:38912
    ds_read_b64_tr_b16 v[108:109], v246 offset:12288
    ds_read_b64_tr_b16 v[110:111], v246 offset:12800
    ds_read_b64_tr_b16 v[112:113], v247 offset:12288
    ds_read_b64_tr_b16 v[114:115], v247 offset:12800
    ds_read_b64_tr_b16 v[116:117], v248 offset:12288
    ds_read_b64_tr_b16 v[118:119], v248 offset:12800
    s_waitcnt lgkmcnt(8)
    v_mfma_f32_16x16x32_bf16 v[12:15], v[96:99], v[120:123], 0
    s_add_u32 s45, s33, 1572864
    s_add_u32 m0, s30, 49152
    s_nop 0
    buffer_load_dwordx4 v242, s[16:19], s45 offen lds
    v_mfma_f32_16x16x32_bf16 v[16:19], v[100:103], v[120:123], 0
    s_add_u32 m0, s30, 50048
    s_nop 0
    buffer_load_dwordx4 v242, s[16:19], s45 offen offset:128 lds
    v_mfma_f32_16x16x32_bf16 v[20:23], v[104:107], v[120:123], 0
    s_add_u32 m0, s30, 50944
    s_nop 0
    buffer_load_dwordx4 v242, s[16:19], s45 offen offset:256 lds
    ds_read_b128 v[120:123], v244 offset:40960
    s_waitcnt lgkmcnt(8)
    v_mfma_f32_16x16x32_bf16 v[36:39], v[96:99], v[124:127], 0
    s_add_u32 s46, s34, 128
    s_add_u32 m0, s31, 141312
    s_nop 0
    buffer_load_dwordx4 v243, s[20:23], s46 offen lds
    s_add_u32 s46, s34, 9344
    buffer_load_dwordx4 v243, s[20:23], s46 offen offset:1024 lds
    s_add_u32 s46, s34, 18560
    s_mov_b64 exec, 0xffff
    buffer_load_dwordx4 v243, s[20:23], s46 offen offset:2048 lds
    s_mov_b64 exec, -1
    v_mfma_f32_16x16x32_bf16 v[40:43], v[100:103], v[124:127], 0
    v_mfma_f32_16x16x32_bf16 v[44:47], v[104:107], v[124:127], 0
    ds_read_b128 v[124:127], v245 offset:34816
    s_waitcnt lgkmcnt(8)
    v_mfma_f32_16x16x32_bf16 v[60:63], v[96:99], v[128:131], 0
    v_mfma_f32_16x16x32_bf16 v[64:67], v[100:103], v[128:131], 0
    v_mfma_f32_16x16x32_bf16 v[68:71], v[104:107], v[128:131], 0
    ds_read_b128 v[128:131], v245 offset:36864
    s_waitcnt lgkmcnt(2)
    v_mfma_f32_16x16x32_bf16 v[84:87], v[96:99], v[120:123], 0
    v_mfma_f32_16x16x32_bf16 v[88:91], v[100:103], v[120:123], 0
    v_mfma_f32_16x16x32_bf16 v[92:95], v[104:107], v[120:123], 0
    ds_read_b128 v[120:123], v245 offset:38912
    s_waitcnt lgkmcnt(2)
    v_mfma_f32_16x16x32_bf16 v[12:15], v[108:111], v[124:127], v[12:15]
    v_mfma_f32_16x16x32_bf16 v[16:19], v[112:115], v[124:127], v[16:19]
    v_mfma_f32_16x16x32_bf16 v[20:23], v[116:119], v[124:127], v[20:23]
    ds_read_b128 v[124:127], v245 offset:40960
    s_waitcnt lgkmcnt(2)
    v_mfma_f32_16x16x32_bf16 v[36:39], v[108:111], v[128:131], v[36:39]
    v_mfma_f32_16x16x32_bf16 v[40:43], v[112:115], v[128:131], v[40:43]
    v_mfma_f32_16x16x32_bf16 v[44:47], v[116:119], v[128:131], v[44:47]
    s_waitcnt lgkmcnt(1)
    v_mfma_f32_16x16x32_bf16 v[60:63], v[108:111], v[120:123], v[60:63]
    v_mfma_f32_16x16x32_bf16 v[64:67], v[112:115], v[120:123], v[64:67]
    v_mfma_f32_16x16x32_bf16 v[68:71], v[116:119], v[120:123], v[68:71]
    s_waitcnt lgkmcnt(0)
    v_mfma_f32_16x16x32_bf16 v[84:87], v[108:111], v[124:127], v[84:87]
    v_mfma_f32_16x16x32_bf16 v[88:91], v[112:115], v[124:127], v[88:91]
    v_mfma_f32_16x16x32_bf16 v[92:95], v[116:119], v[124:127], v[92:95]
    s_waitcnt vmcnt(0)
    s_barrier
    ds_read_b64_tr_b16 v[96:97], v246 offset:24576
    ds_read_b64_tr_b16 v[98:99], v246 offset:25088
    ds_read_b64_tr_b16 v[100:101], v247 offset:24576
    ds_read_b64_tr_b16 v[102:103], v247 offset:25088
    ds_read_b64_tr_b16 v[104:105], v248 offset:24576
    ds_read_b64_tr_b16 v[106:107], v248 offset:25088
    ds_read_b128 v[120:123], v244 offset:53248
    ds_read_b128 v[124:127], v244 offset:55296
    ds_read_b128 v[128:131], v244 offset:57344
    ds_read_b64_tr_b16 v[108:109], v246 offset:36864
    ds_read_b64_tr_b16 v[110:111], v246 offset:37376
    ds_read_b64_tr_b16 v[112:113], v247 offset:36864
    ds_read_b64_tr_b16 v[114:115], v247 offset:37376
    ds_read_b64_tr_b16 v[116:117], v248 offset:36864
    ds_read_b64_tr_b16 v[118:119], v248 offset:37376
    s_waitcnt lgkmcnt(8)
    v_mfma_f32_16x16x32_bf16 v[12:15], v[96:99], v[120:123], v[12:15]
    s_add_u32 s45, s33, 2359296
    s_add_u32 m0, s30, 0
    s_nop 0
    buffer_load_dwordx4 v242, s[16:19], s45 offen lds
    v_mfma_f32_16x16x32_bf16 v[16:19], v[100:103], v[120:123], v[16:19]
    s_add_u32 m0, s30, 896
    s_nop 0
    buffer_load_dwordx4 v242, s[16:19], s45 offen offset:128 lds
    v_mfma_f32_16x16x32_bf16 v[20:23], v[104:107], v[120:123], v[20:23]
    s_add_u32 m0, s30, 1792
    s_nop 0
    buffer_load_dwordx4 v242, s[16:19], s45 offen offset:256 lds
    ds_read_b128 v[120:123], v244 offset:59392
    s_waitcnt lgkmcnt(8)
    v_mfma_f32_16x16x32_bf16 v[36:39], v[96:99], v[124:127], v[36:39]
    s_add_u32 s46, s34, 384
    s_add_u32 m0, s31, 122880
    s_nop 0
    buffer_load_dwordx4 v243, s[20:23], s46 offen lds
    s_add_u32 s46, s34, 9600
    buffer_load_dwordx4 v243, s[20:23], s46 offen offset:1024 lds
    s_add_u32 s46, s34, 18816
    s_mov_b64 exec, 0xffff
    buffer_load_dwordx4 v243, s[20:23], s46 offen offset:2048 lds
    s_mov_b64 exec, -1
    v_mfma_f32_16x16x32_bf16 v[40:43], v[100:103], v[124:127], v[40:43]
    v_mfma_f32_16x16x32_bf16 v[44:47], v[104:107], v[124:127], v[44:47]
    ds_read_b128 v[124:127], v245 offset:53248
    s_waitcnt lgkmcnt(8)
    v_mfma_f32_16x16x32_bf16 v[60:63], v[96:99], v[128:131], v[60:63]
    v_mfma_f32_16x16x32_bf16 v[64:67], v[100:103], v[128:131], v[64:67]
    v_mfma_f32_16x16x32_bf16 v[68:71], v[104:107], v[128:131], v[68:71]
    ds_read_b128 v[128:131], v245 offset:55296
    s_waitcnt lgkmcnt(2)
    v_mfma_f32_16x16x32_bf16 v[84:87], v[96:99], v[120:123], v[84:87]
    v_mfma_f32_16x16x32_bf16 v[88:91], v[100:103], v[120:123], v[88:91]
    v_mfma_f32_16x16x32_bf16 v[92:95], v[104:107], v[120:123], v[92:95]
    ds_read_b128 v[120:123], v245 offset:57344
    s_waitcnt lgkmcnt(2)
    v_mfma_f32_16x16x32_bf16 v[12:15], v[108:111], v[124:127], v[12:15]
    v_mfma_f32_16x16x32_bf16 v[16:19], v[112:115], v[124:127], v[16:19]
    v_mfma_f32_16x16x32_bf16 v[20:23], v[116:119], v[124:127], v[20:23]
    ds_read_b128 v[124:127], v245 offset:59392
    s_waitcnt lgkmcnt(2)
    v_mfma_f32_16x16x32_bf16 v[36:39], v[108:111], v[128:131], v[36:39]
    v_mfma_f32_16x16x32_bf16 v[40:43], v[112:115], v[128:131], v[40:43]
    v_mfma_f32_16x16x32_bf16 v[44:47], v[116:119], v[128:131], v[44:47]
    s_waitcnt lgkmcnt(1)
    v_mfma_f32_16x16x32_bf16 v[60:63], v[108:111], v[120:123], v[60:63]
    v_mfma_f32_16x16x32_bf16 v[64:67], v[112:115], v[120:123], v[64:67]
    v_mfma_f32_16x16x32_bf16 v[68:71], v[116:119], v[120:123], v[68:71]
    s_waitcnt lgkmcnt(0)
    v_mfma_f32_16x16x32_bf16 v[84:87], v[108:111], v[124:127], v[84:87]
    v_mfma_f32_16x16x32_bf16 v[88:91], v[112:115], v[124:127], v[88:91]
    v_mfma_f32_16x16x32_bf16 v[92:95], v[116:119], v[124:127], v[92:95]
    s_barrier
    ds_read_b64_tr_b16 v[96:97], v246 offset:49152
    ds_read_b64_tr_b16 v[98:99], v246 offset:49664
    ds_read_b64_tr_b16 v[100:101], v247 offset:49152
    ds_read_b64_tr_b16 v[102:103], v247 offset:49664
    ds_read_b64_tr_b16 v[104:105], v248 offset:49152
    ds_read_b64_tr_b16 v[106:107], v248 offset:49664
    ds_read_b128 v[120:123], v244 offset:10240
    ds_read_b128 v[124:127], v244 offset:12288
    ds_read_b128 v[128:131], v244 offset:14336
    ds_read_b64_tr_b16 v[108:109], v246 offset:61440
    ds_read_b64_tr_b16 v[110:111], v246 offset:61952
    ds_read_b64_tr_b16 v[112:113], v247 offset:61440
    ds_read_b64_tr_b16 v[114:115], v247 offset:61952
    ds_read_b64_tr_b16 v[116:117], v248 offset:61440
    ds_read_b64_tr_b16 v[118:119], v248 offset:61952
    s_waitcnt lgkmcnt(8)
    v_mfma_f32_16x16x32_bf16 v[12:15], v[96:99], v[120:123], v[12:15]
    s_add_u32 s45, s33, 3145728
    s_add_u32 m0, s30, 24576
    s_nop 0
    buffer_load_dwordx4 v242, s[16:19], s45 offen lds
    v_mfma_f32_16x16x32_bf16 v[16:19], v[100:103], v[120:123], v[16:19]
    s_add_u32 m0, s30, 25472
    s_nop 0
    buffer_load_dwordx4 v242, s[16:19], s45 offen offset:128 lds
    v_mfma_f32_16x16x32_bf16 v[20:23], v[104:107], v[120:123], v[20:23]
    s_add_u32 m0, s30, 26368
    s_nop 0
    buffer_load_dwordx4 v242, s[16:19], s45 offen offset:256 lds
    ds_read_b128 v[120:123], v244 offset:16384
    s_waitcnt lgkmcnt(8)
    v_mfma_f32_16x16x32_bf16 v[36:39], v[96:99], v[124:127], v[36:39]
    s_add_u32 s46, s34, 512
    s_add_u32 m0, s31, 141312
    s_nop 0
    buffer_load_dwordx4 v243, s[20:23], s46 offen lds
    s_add_u32 s46, s34, 9728
    buffer_load_dwordx4 v243, s[20:23], s46 offen offset:1024 lds
    s_add_u32 s46, s34, 18944
    s_mov_b64 exec, 0xffff
    buffer_load_dwordx4 v243, s[20:23], s46 offen offset:2048 lds
    s_mov_b64 exec, -1
    v_mfma_f32_16x16x32_bf16 v[40:43], v[100:103], v[124:127], v[40:43]
    v_mfma_f32_16x16x32_bf16 v[44:47], v[104:107], v[124:127], v[44:47]
    ds_read_b128 v[124:127], v245 offset:10240
    s_waitcnt lgkmcnt(8)
    v_mfma_f32_16x16x32_bf16 v[60:63], v[96:99], v[128:131], v[60:63]
    v_mfma_f32_16x16x32_bf16 v[64:67], v[100:103], v[128:131], v[64:67]
    v_mfma_f32_16x16x32_bf16 v[68:71], v[104:107], v[128:131], v[68:71]
    ds_read_b128 v[128:131], v245 offset:12288
    s_waitcnt lgkmcnt(2)
    v_mfma_f32_16x16x32_bf16 v[84:87], v[96:99], v[120:123], v[84:87]
    v_mfma_f32_16x16x32_bf16 v[88:91], v[100:103], v[120:123], v[88:91]
    v_mfma_f32_16x16x32_bf16 v[92:95], v[104:107], v[120:123], v[92:95]
    ds_read_b128 v[120:123], v245 offset:14336
    s_waitcnt lgkmcnt(2)
    v_mfma_f32_16x16x32_bf16 v[12:15], v[108:111], v[124:127], v[12:15]
    v_mfma_f32_16x16x32_bf16 v[16:19], v[112:115], v[124:127], v[16:19]
    v_mfma_f32_16x16x32_bf16 v[20:23], v[116:119], v[124:127], v[20:23]
    ds_read_b128 v[124:127], v245 offset:16384
    s_waitcnt lgkmcnt(2)
    v_mfma_f32_16x16x32_bf16 v[36:39], v[108:111], v[128:131], v[36:39]
    v_mfma_f32_16x16x32_bf16 v[40:43], v[112:115], v[128:131], v[40:43]
    v_mfma_f32_16x16x32_bf16 v[44:47], v[116:119], v[128:131], v[44:47]
    s_waitcnt lgkmcnt(1)
    v_mfma_f32_16x16x32_bf16 v[60:63], v[108:111], v[120:123], v[60:63]
    v_mfma_f32_16x16x32_bf16 v[64:67], v[112:115], v[120:123], v[64:67]
    v_mfma_f32_16x16x32_bf16 v[68:71], v[116:119], v[120:123], v[68:71]
    s_waitcnt lgkmcnt(0)
    v_mfma_f32_16x16x32_bf16 v[84:87], v[108:111], v[124:127], v[84:87]
    v_mfma_f32_16x16x32_bf16 v[88:91], v[112:115], v[124:127], v[88:91]
    v_mfma_f32_16x16x32_bf16 v[92:95], v[116:119], v[124:127], v[92:95]
    s_waitcnt vmcnt(6)
    s_barrier
    ds_read_b64_tr_b16 v[96:97], v246
    ds_read_b64_tr_b16 v[98:99], v246 offset:512
    ds_read_b64_tr_b16 v[100:101], v247
    ds_read_b64_tr_b16 v[102:103], v247 offset:512
    ds_read_b64_tr_b16 v[104:105], v248
    ds_read_b64_tr_b16 v[106:107], v248 offset:512
    ds_read_b128 v[120:123], v244 offset:34816
    ds_read_b128 v[124:127], v244 offset:36864
    ds_read_b128 v[128:131], v244 offset:38912
    ds_read_b64_tr_b16 v[108:109], v246 offset:12288
    ds_read_b64_tr_b16 v[110:111], v246 offset:12800
    ds_read_b64_tr_b16 v[112:113], v247 offset:12288
    ds_read_b64_tr_b16 v[114:115], v247 offset:12800
    ds_read_b64_tr_b16 v[116:117], v248 offset:12288
    ds_read_b64_tr_b16 v[118:119], v248 offset:12800
    s_waitcnt lgkmcnt(8)
    v_mfma_f32_16x16x32_bf16 v[12:15], v[96:99], v[120:123], v[12:15]
    s_add_u32 s45, s33, 3932160
    s_add_u32 m0, s30, 49152
    s_nop 0
    buffer_load_dwordx4 v242, s[16:19], s45 offen lds
    v_mfma_f32_16x16x32_bf16 v[16:19], v[100:103], v[120:123], v[16:19]
    s_add_u32 m0, s30, 50048
    s_nop 0
    buffer_load_dwordx4 v242, s[16:19], s45 offen offset:128 lds
    v_mfma_f32_16x16x32_bf16 v[20:23], v[104:107], v[120:123], v[20:23]
    s_add_u32 m0, s30, 50944
    s_nop 0
    buffer_load_dwordx4 v242, s[16:19], s45 offen offset:256 lds
    ds_read_b128 v[120:123], v244 offset:40960
    s_waitcnt lgkmcnt(8)
    v_mfma_f32_16x16x32_bf16 v[36:39], v[96:99], v[124:127], v[36:39]
    s_add_u32 s46, s34, 640
    s_add_u32 m0, s31, 98304
    s_nop 0
    buffer_load_dwordx4 v243, s[20:23], s46 offen lds
    s_add_u32 s46, s34, 9856
    buffer_load_dwordx4 v243, s[20:23], s46 offen offset:1024 lds
    s_add_u32 s46, s34, 19072
    s_mov_b64 exec, 0xffff
    buffer_load_dwordx4 v243, s[20:23], s46 offen offset:2048 lds
    s_mov_b64 exec, -1
    v_mfma_f32_16x16x32_bf16 v[40:43], v[100:103], v[124:127], v[40:43]
    v_mfma_f32_16x16x32_bf16 v[44:47], v[104:107], v[124:127], v[44:47]
    ds_read_b128 v[124:127], v245 offset:34816
    s_waitcnt lgkmcnt(8)
    v_mfma_f32_16x16x32_bf16 v[60:63], v[96:99], v[128:131], v[60:63]
    v_mfma_f32_16x16x32_bf16 v[64:67], v[100:103], v[128:131], v[64:67]
    v_mfma_f32_16x16x32_bf16 v[68:71], v[104:107], v[128:131], v[68:71]
    ds_read_b128 v[128:131], v245 offset:36864
    s_waitcnt lgkmcnt(2)
    v_mfma_f32_16x16x32_bf16 v[84:87], v[96:99], v[120:123], v[84:87]
    v_mfma_f32_16x16x32_bf16 v[88:91], v[100:103], v[120:123], v[88:91]
    v_mfma_f32_16x16x32_bf16 v[92:95], v[104:107], v[120:123], v[92:95]
    ds_read_b128 v[120:123], v245 offset:38912
    s_waitcnt lgkmcnt(2)
    v_mfma_f32_16x16x32_bf16 v[12:15], v[108:111], v[124:127], v[12:15]
    v_mfma_f32_16x16x32_bf16 v[16:19], v[112:115], v[124:127], v[16:19]
    v_mfma_f32_16x16x32_bf16 v[20:23], v[116:119], v[124:127], v[20:23]
    ds_read_b128 v[124:127], v245 offset:40960
    s_waitcnt lgkmcnt(2)
    v_mfma_f32_16x16x32_bf16 v[36:39], v[108:111], v[128:131], v[36:39]
    v_mfma_f32_16x16x32_bf16 v[40:43], v[112:115], v[128:131], v[40:43]
    v_mfma_f32_16x16x32_bf16 v[44:47], v[116:119], v[128:131], v[44:47]
    s_waitcnt lgkmcnt(1)
    v_mfma_f32_16x16x32_bf16 v[60:63], v[108:111], v[120:123], v[60:63]
    v_mfma_f32_16x16x32_bf16 v[64:67], v[112:115], v[120:123], v[64:67]
    v_mfma_f32_16x16x32_bf16 v[68:71], v[116:119], v[120:123], v[68:71]
    s_waitcnt lgkmcnt(0)
    v_mfma_f32_16x16x32_bf16 v[84:87], v[108:111], v[124:127], v[84:87]
    v_mfma_f32_16x16x32_bf16 v[88:91], v[112:115], v[124:127], v[88:91]
    v_mfma_f32_16x16x32_bf16 v[92:95], v[116:119], v[124:127], v[92:95]
    s_waitcnt vmcnt(6)
    s_barrier
    ds_read_b64_tr_b16 v[96:97], v246 offset:24576
    ds_read_b64_tr_b16 v[98:99], v246 offset:25088
    ds_read_b64_tr_b16 v[100:101], v247 offset:24576
    ds_read_b64_tr_b16 v[102:103], v247 offset:25088
    ds_read_b64_tr_b16 v[104:105], v248 offset:24576
    ds_read_b64_tr_b16 v[106:107], v248 offset:25088
    ds_read_b128 v[120:123], v244 offset:53248
    ds_read_b128 v[124:127], v244 offset:55296
    ds_read_b128 v[128:131], v244 offset:57344
    ds_read_b64_tr_b16 v[108:109], v246 offset:36864
    ds_read_b64_tr_b16 v[110:111], v246 offset:37376
    ds_read_b64_tr_b16 v[112:113], v247 offset:36864
    ds_read_b64_tr_b16 v[114:115], v247 offset:37376
    ds_read_b64_tr_b16 v[116:117], v248 offset:36864
    ds_read_b64_tr_b16 v[118:119], v248 offset:37376
    s_waitcnt lgkmcnt(8)
    v_mfma_f32_16x16x32_bf16 v[12:15], v[96:99], v[120:123], v[12:15]
    s_add_u32 s45, s33, 4718592
    s_add_u32 m0, s30, 0
    s_nop 0
    buffer_load_dwordx4 v242, s[16:19], s45 offen lds
    v_mfma_f32_16x16x32_bf16 v[16:19], v[100:103], v[120:123], v[16:19]
    s_add_u32 m0, s30, 896
    s_nop 0
    buffer_load_dwordx4 v242, s[16:19], s45 offen offset:128 lds
    v_mfma_f32_16x16x32_bf16 v[20:23], v[104:107], v[120:123], v[20:23]
    s_add_u32 m0, s30, 1792
    s_nop 0
    buffer_load_dwordx4 v242, s[16:19], s45 offen offset:256 lds
    ds_read_b128 v[120:123], v244 offset:59392
    s_waitcnt lgkmcnt(8)
    v_mfma_f32_16x16x32_bf16 v[36:39], v[96:99], v[124:127], v[36:39]
    s_add_u32 s46, s34, 768
    s_add_u32 m0, s31, 122880
    s_nop 0
    buffer_load_dwordx4 v243, s[20:23], s46 offen lds
    s_add_u32 s46, s34, 9984
    buffer_load_dwordx4 v243, s[20:23], s46 offen offset:1024 lds
    s_add_u32 s46, s34, 19200
    s_mov_b64 exec, 0xffff
    buffer_load_dwordx4 v243, s[20:23], s46 offen offset:2048 lds
    s_mov_b64 exec, -1
    v_mfma_f32_16x16x32_bf16 v[40:43], v[100:103], v[124:127], v[40:43]
    v_mfma_f32_16x16x32_bf16 v[44:47], v[104:107], v[124:127], v[44:47]
    ds_read_b128 v[124:127], v245 offset:53248
    s_waitcnt lgkmcnt(8)
    v_mfma_f32_16x16x32_bf16 v[60:63], v[96:99], v[128:131], v[60:63]
    v_mfma_f32_16x16x32_bf16 v[64:67], v[100:103], v[128:131], v[64:67]
    v_mfma_f32_16x16x32_bf16 v[68:71], v[104:107], v[128:131], v[68:71]
    ds_read_b128 v[128:131], v245 offset:55296
    s_waitcnt lgkmcnt(2)
    v_mfma_f32_16x16x32_bf16 v[84:87], v[96:99], v[120:123], v[84:87]
    v_mfma_f32_16x16x32_bf16 v[88:91], v[100:103], v[120:123], v[88:91]
    v_mfma_f32_16x16x32_bf16 v[92:95], v[104:107], v[120:123], v[92:95]
    ds_read_b128 v[120:123], v245 offset:57344
    s_waitcnt lgkmcnt(2)
    v_mfma_f32_16x16x32_bf16 v[12:15], v[108:111], v[124:127], v[12:15]
    v_mfma_f32_16x16x32_bf16 v[16:19], v[112:115], v[124:127], v[16:19]
    v_mfma_f32_16x16x32_bf16 v[20:23], v[116:119], v[124:127], v[20:23]
    ds_read_b128 v[124:127], v245 offset:59392
    s_waitcnt lgkmcnt(2)
    v_mfma_f32_16x16x32_bf16 v[36:39], v[108:111], v[128:131], v[36:39]
    v_mfma_f32_16x16x32_bf16 v[40:43], v[112:115], v[128:131], v[40:43]
    v_mfma_f32_16x16x32_bf16 v[44:47], v[116:119], v[128:131], v[44:47]
    s_waitcnt lgkmcnt(1)
    v_mfma_f32_16x16x32_bf16 v[60:63], v[108:111], v[120:123], v[60:63]
    v_mfma_f32_16x16x32_bf16 v[64:67], v[112:115], v[120:123], v[64:67]
    v_mfma_f32_16x16x32_bf16 v[68:71], v[116:119], v[120:123], v[68:71]
    s_waitcnt lgkmcnt(0)
    v_mfma_f32_16x16x32_bf16 v[84:87], v[108:111], v[124:127], v[84:87]
    v_mfma_f32_16x16x32_bf16 v[88:91], v[112:115], v[124:127], v[88:91]
    v_mfma_f32_16x16x32_bf16 v[92:95], v[116:119], v[124:127], v[92:95]
    s_waitcnt vmcnt(6)
    s_barrier
    ds_read_b64_tr_b16 v[96:97], v246 offset:49152
    ds_read_b64_tr_b16 v[98:99], v246 offset:49664
    ds_read_b64_tr_b16 v[100:101], v247 offset:49152
    ds_read_b64_tr_b16 v[102:103], v247 offset:49664
    ds_read_b64_tr_b16 v[104:105], v248 offset:49152
    ds_read_b64_tr_b16 v[106:107], v248 offset:49664
    ds_read_b128 v[120:123], v244 offset:10240
    ds_read_b128 v[124:127], v244 offset:12288
    ds_read_b128 v[128:131], v244 offset:14336
    ds_read_b64_tr_b16 v[108:109], v246 offset:61440
    ds_read_b64_tr_b16 v[110:111], v246 offset:61952
    ds_read_b64_tr_b16 v[112:113], v247 offset:61440
    ds_read_b64_tr_b16 v[114:115], v247 offset:61952
    ds_read_b64_tr_b16 v[116:117], v248 offset:61440
    ds_read_b64_tr_b16 v[118:119], v248 offset:61952
    s_waitcnt lgkmcnt(8)
    v_mfma_f32_16x16x32_bf16 v[12:15], v[96:99], v[120:123], v[12:15]
    s_add_u32 s45, s33, 5505024
    s_add_u32 m0, s30, 24576
    s_nop 0
    buffer_load_dwordx4 v242, s[16:19], s45 offen lds
    v_mfma_f32_16x16x32_bf16 v[16:19], v[100:103], v[120:123], v[16:19]
    s_add_u32 m0, s30, 25472
    s_nop 0
    buffer_load_dwordx4 v242, s[16:19], s45 offen offset:128 lds
    v_mfma_f32_16x16x32_bf16 v[20:23], v[104:107], v[120:123], v[20:23]
    s_add_u32 m0, s30, 26368
    s_nop 0
    buffer_load_dwordx4 v242, s[16:19], s45 offen offset:256 lds
    ds_read_b128 v[120:123], v244 offset:16384
    s_waitcnt lgkmcnt(8)
    v_mfma_f32_16x16x32_bf16 v[36:39], v[96:99], v[124:127], v[36:39]
    s_add_u32 s46, s34, 896
    s_add_u32 m0, s31, 141312
    s_nop 0
    buffer_load_dwordx4 v243, s[20:23], s46 offen lds
    s_add_u32 s46, s34, 10112
    buffer_load_dwordx4 v243, s[20:23], s46 offen offset:1024 lds
    s_add_u32 s46, s34, 19328
    s_mov_b64 exec, 0xffff
    buffer_load_dwordx4 v243, s[20:23], s46 offen offset:2048 lds
    s_mov_b64 exec, -1
    v_mfma_f32_16x16x32_bf16 v[40:43], v[100:103], v[124:127], v[40:43]
    v_mfma_f32_16x16x32_bf16 v[44:47], v[104:107], v[124:127], v[44:47]
    ds_read_b128 v[124:127], v245 offset:10240
    s_waitcnt lgkmcnt(8)
    v_mfma_f32_16x16x32_bf16 v[60:63], v[96:99], v[128:131], v[60:63]
    v_mfma_f32_16x16x32_bf16 v[64:67], v[100:103], v[128:131], v[64:67]
    v_mfma_f32_16x16x32_bf16 v[68:71], v[104:107], v[128:131], v[68:71]
    ds_read_b128 v[128:131], v245 offset:12288
    s_waitcnt lgkmcnt(2)
    v_mfma_f32_16x16x32_bf16 v[84:87], v[96:99], v[120:123], v[84:87]
    v_mfma_f32_16x16x32_bf16 v[88:91], v[100:103], v[120:123], v[88:91]
    v_mfma_f32_16x16x32_bf16 v[92:95], v[104:107], v[120:123], v[92:95]
    ds_read_b128 v[120:123], v245 offset:14336
    s_waitcnt lgkmcnt(2)
    v_mfma_f32_16x16x32_bf16 v[12:15], v[108:111], v[124:127], v[12:15]
    v_mfma_f32_16x16x32_bf16 v[16:19], v[112:115], v[124:127], v[16:19]
    v_mfma_f32_16x16x32_bf16 v[20:23], v[116:119], v[124:127], v[20:23]
    ds_read_b128 v[124:127], v245 offset:16384
    s_waitcnt lgkmcnt(2)
    v_mfma_f32_16x16x32_bf16 v[36:39], v[108:111], v[128:131], v[36:39]
    v_mfma_f32_16x16x32_bf16 v[40:43], v[112:115], v[128:131], v[40:43]
    v_mfma_f32_16x16x32_bf16 v[44:47], v[116:119], v[128:131], v[44:47]
    s_waitcnt lgkmcnt(1)
    v_mfma_f32_16x16x32_bf16 v[60:63], v[108:111], v[120:123], v[60:63]
    v_mfma_f32_16x16x32_bf16 v[64:67], v[112:115], v[120:123], v[64:67]
    v_mfma_f32_16x16x32_bf16 v[68:71], v[116:119], v[120:123], v[68:71]
    s_waitcnt lgkmcnt(0)
    v_mfma_f32_16x16x32_bf16 v[84:87], v[108:111], v[124:127], v[84:87]
    v_mfma_f32_16x16x32_bf16 v[88:91], v[112:115], v[124:127], v[88:91]
    v_mfma_f32_16x16x32_bf16 v[92:95], v[116:119], v[124:127], v[92:95]
    s_waitcnt vmcnt(6)
    s_barrier
    ds_read_b64_tr_b16 v[96:97], v246
    ds_read_b64_tr_b16 v[98:99], v246 offset:512
    ds_read_b64_tr_b16 v[100:101], v247
    ds_read_b64_tr_b16 v[102:103], v247 offset:512
    ds_read_b64_tr_b16 v[104:105], v248
    ds_read_b64_tr_b16 v[106:107], v248 offset:512
    ds_read_b128 v[120:123], v244 offset:34816
    ds_read_b128 v[124:127], v244 offset:36864
    ds_read_b128 v[128:131], v244 offset:38912
    ds_read_b64_tr_b16 v[108:109], v246 offset:12288
    ds_read_b64_tr_b16 v[110:111], v246 offset:12800
    ds_read_b64_tr_b16 v[112:113], v247 offset:12288
    ds_read_b64_tr_b16 v[114:115], v247 offset:12800
    ds_read_b64_tr_b16 v[116:117], v248 offset:12288
    ds_read_b64_tr_b16 v[118:119], v248 offset:12800
    s_waitcnt lgkmcnt(8)
    v_mfma_f32_16x16x32_bf16 v[12:15], v[96:99], v[120:123], v[12:15]
    s_add_u32 s45, s33, 6291456
    s_add_u32 m0, s30, 49152
    s_nop 0
    buffer_load_dwordx4 v242, s[16:19], s45 offen lds
    v_mfma_f32_16x16x32_bf16 v[16:19], v[100:103], v[120:123], v[16:19]
    s_add_u32 m0, s30, 50048
    s_nop 0
    buffer_load_dwordx4 v242, s[16:19], s45 offen offset:128 lds
    v_mfma_f32_16x16x32_bf16 v[20:23], v[104:107], v[120:123], v[20:23]
    s_add_u32 m0, s30, 50944
    s_nop 0
    buffer_load_dwordx4 v242, s[16:19], s45 offen offset:256 lds
    ds_read_b128 v[120:123], v244 offset:40960
    s_waitcnt lgkmcnt(8)
    v_mfma_f32_16x16x32_bf16 v[36:39], v[96:99], v[124:127], v[36:39]
    v_mfma_f32_16x16x32_bf16 v[40:43], v[100:103], v[124:127], v[40:43]
    v_mfma_f32_16x16x32_bf16 v[44:47], v[104:107], v[124:127], v[44:47]
    ds_read_b128 v[124:127], v245 offset:34816
    s_waitcnt lgkmcnt(8)
    v_mfma_f32_16x16x32_bf16 v[60:63], v[96:99], v[128:131], v[60:63]
    v_mfma_f32_16x16x32_bf16 v[64:67], v[100:103], v[128:131], v[64:67]
    v_mfma_f32_16x16x32_bf16 v[68:71], v[104:107], v[128:131], v[68:71]
    ds_read_b128 v[128:131], v245 offset:36864
    s_waitcnt lgkmcnt(2)
    v_mfma_f32_16x16x32_bf16 v[84:87], v[96:99], v[120:123], v[84:87]
    v_mfma_f32_16x16x32_bf16 v[88:91], v[100:103], v[120:123], v[88:91]
    v_mfma_f32_16x16x32_bf16 v[92:95], v[104:107], v[120:123], v[92:95]
    ds_read_b128 v[120:123], v245 offset:38912
    s_waitcnt lgkmcnt(2)
    v_mfma_f32_16x16x32_bf16 v[12:15], v[108:111], v[124:127], v[12:15]
    v_mfma_f32_16x16x32_bf16 v[16:19], v[112:115], v[124:127], v[16:19]
    v_mfma_f32_16x16x32_bf16 v[20:23], v[116:119], v[124:127], v[20:23]
    ds_read_b128 v[124:127], v245 offset:40960
    s_waitcnt lgkmcnt(2)
    v_mfma_f32_16x16x32_bf16 v[36:39], v[108:111], v[128:131], v[36:39]
    v_mfma_f32_16x16x32_bf16 v[40:43], v[112:115], v[128:131], v[40:43]
    v_mfma_f32_16x16x32_bf16 v[44:47], v[116:119], v[128:131], v[44:47]
    s_waitcnt lgkmcnt(1)
    v_mfma_f32_16x16x32_bf16 v[60:63], v[108:111], v[120:123], v[60:63]
    v_mfma_f32_16x16x32_bf16 v[64:67], v[112:115], v[120:123], v[64:67]
    v_mfma_f32_16x16x32_bf16 v[68:71], v[116:119], v[120:123], v[68:71]
    s_waitcnt lgkmcnt(0)
    v_mfma_f32_16x16x32_bf16 v[84:87], v[108:111], v[124:127], v[84:87]
    v_mfma_f32_16x16x32_bf16 v[88:91], v[112:115], v[124:127], v[88:91]
    v_mfma_f32_16x16x32_bf16 v[92:95], v[116:119], v[124:127], v[92:95]
    s_waitcnt vmcnt(3)
    s_barrier
    ds_read_b64_tr_b16 v[96:97], v246 offset:24576
    ds_read_b64_tr_b16 v[98:99], v246 offset:25088
    ds_read_b64_tr_b16 v[100:101], v247 offset:24576
    ds_read_b64_tr_b16 v[102:103], v247 offset:25088
    ds_read_b64_tr_b16 v[104:105], v248 offset:24576
    ds_read_b64_tr_b16 v[106:107], v248 offset:25088
    ds_read_b128 v[120:123], v244 offset:53248
    ds_read_b128 v[124:127], v244 offset:55296
    ds_read_b128 v[128:131], v244 offset:57344
    ds_read_b64_tr_b16 v[108:109], v246 offset:36864
    ds_read_b64_tr_b16 v[110:111], v246 offset:37376
    ds_read_b64_tr_b16 v[112:113], v247 offset:36864
    ds_read_b64_tr_b16 v[114:115], v247 offset:37376
    ds_read_b64_tr_b16 v[116:117], v248 offset:36864
    ds_read_b64_tr_b16 v[118:119], v248 offset:37376
    s_waitcnt lgkmcnt(8)
    v_mfma_f32_16x16x32_bf16 v[12:15], v[96:99], v[120:123], v[12:15]
    s_add_u32 s45, s33, 7077888
    s_add_u32 m0, s30, 0
    s_nop 0
    buffer_load_dwordx4 v242, s[16:19], s45 offen lds
    v_mfma_f32_16x16x32_bf16 v[16:19], v[100:103], v[120:123], v[16:19]
    s_add_u32 m0, s30, 896
    s_nop 0
    buffer_load_dwordx4 v242, s[16:19], s45 offen offset:128 lds
    v_mfma_f32_16x16x32_bf16 v[20:23], v[104:107], v[120:123], v[20:23]
    s_add_u32 m0, s30, 1792
    s_nop 0
    buffer_load_dwordx4 v242, s[16:19], s45 offen offset:256 lds
    ds_read_b128 v[120:123], v244 offset:59392
    s_waitcnt lgkmcnt(8)
    v_mfma_f32_16x16x32_bf16 v[36:39], v[96:99], v[124:127], v[36:39]
    s_add_u32 s46, s34, 1024
    s_add_u32 m0, s31, 122880
    s_nop 0
    buffer_load_dwordx4 v243, s[20:23], s46 offen lds
    s_add_u32 s46, s34, 10240
    buffer_load_dwordx4 v243, s[20:23], s46 offen offset:1024 lds
    s_add_u32 s46, s34, 19456
    s_mov_b64 exec, 0xffff
    buffer_load_dwordx4 v243, s[20:23], s46 offen offset:2048 lds
    s_mov_b64 exec, -1
    v_mfma_f32_16x16x32_bf16 v[40:43], v[100:103], v[124:127], v[40:43]
    v_mfma_f32_16x16x32_bf16 v[44:47], v[104:107], v[124:127], v[44:47]
    ds_read_b128 v[124:127], v245 offset:53248
    s_waitcnt lgkmcnt(8)
    v_mfma_f32_16x16x32_bf16 v[60:63], v[96:99], v[128:131], v[60:63]
    v_mfma_f32_16x16x32_bf16 v[64:67], v[100:103], v[128:131], v[64:67]
    v_mfma_f32_16x16x32_bf16 v[68:71], v[104:107], v[128:131], v[68:71]
    ds_read_b128 v[128:131], v245 offset:55296
    s_waitcnt lgkmcnt(2)
    v_mfma_f32_16x16x32_bf16 v[84:87], v[96:99], v[120:123], v[84:87]
    v_mfma_f32_16x16x32_bf16 v[88:91], v[100:103], v[120:123], v[88:91]
    v_mfma_f32_16x16x32_bf16 v[92:95], v[104:107], v[120:123], v[92:95]
    ds_read_b128 v[120:123], v245 offset:57344
    s_waitcnt lgkmcnt(2)
    v_mfma_f32_16x16x32_bf16 v[12:15], v[108:111], v[124:127], v[12:15]
    v_mfma_f32_16x16x32_bf16 v[16:19], v[112:115], v[124:127], v[16:19]
    v_mfma_f32_16x16x32_bf16 v[20:23], v[116:119], v[124:127], v[20:23]
    ds_read_b128 v[124:127], v245 offset:59392
    s_waitcnt lgkmcnt(2)
    v_mfma_f32_16x16x32_bf16 v[36:39], v[108:111], v[128:131], v[36:39]
    v_mfma_f32_16x16x32_bf16 v[40:43], v[112:115], v[128:131], v[40:43]
    v_mfma_f32_16x16x32_bf16 v[44:47], v[116:119], v[128:131], v[44:47]
    s_waitcnt lgkmcnt(1)
    v_mfma_f32_16x16x32_bf16 v[60:63], v[108:111], v[120:123], v[60:63]
    v_mfma_f32_16x16x32_bf16 v[64:67], v[112:115], v[120:123], v[64:67]
    v_mfma_f32_16x16x32_bf16 v[68:71], v[116:119], v[120:123], v[68:71]
    s_waitcnt lgkmcnt(0)
    v_mfma_f32_16x16x32_bf16 v[84:87], v[108:111], v[124:127], v[84:87]
    v_mfma_f32_16x16x32_bf16 v[88:91], v[112:115], v[124:127], v[88:91]
    v_mfma_f32_16x16x32_bf16 v[92:95], v[116:119], v[124:127], v[92:95]
    s_waitcnt vmcnt(0)
    s_barrier
    ds_read_b64_tr_b16 v[96:97], v246 offset:49152
    ds_read_b64_tr_b16 v[98:99], v246 offset:49664
    ds_read_b64_tr_b16 v[100:101], v247 offset:49152
    ds_read_b64_tr_b16 v[102:103], v247 offset:49664
    ds_read_b64_tr_b16 v[104:105], v248 offset:49152
    ds_read_b64_tr_b16 v[106:107], v248 offset:49664
    ds_read_b128 v[120:123], v244 offset:34816
    ds_read_b128 v[124:127], v244 offset:36864
    ds_read_b128 v[128:131], v244 offset:38912
    ds_read_b64_tr_b16 v[108:109], v246 offset:61440
    ds_read_b64_tr_b16 v[110:111], v246 offset:61952
    ds_read_b64_tr_b16 v[112:113], v247 offset:61440
    ds_read_b64_tr_b16 v[114:115], v247 offset:61952
    ds_read_b64_tr_b16 v[116:117], v248 offset:61440
    ds_read_b64_tr_b16 v[118:119], v248 offset:61952
    s_waitcnt lgkmcnt(8)
    v_mfma_f32_16x16x32_bf16 v[12:15], v[96:99], v[120:123], v[12:15]
    s_add_u32 s46, s34, 1152
    s_add_u32 m0, s31, 141312
    s_nop 0
    buffer_load_dwordx4 v243, s[20:23], s46 offen lds
    s_add_u32 s46, s34, 10368
    buffer_load_dwordx4 v243, s[20:23], s46 offen offset:1024 lds
    s_add_u32 s46, s34, 19584
    s_mov_b64 exec, 0xffff
    buffer_load_dwordx4 v243, s[20:23], s46 offen offset:2048 lds
    s_mov_b64 exec, -1
    v_mfma_f32_16x16x32_bf16 v[16:19], v[100:103], v[120:123], v[16:19]
    s_add_u32 s45, s32, 24576
    s_add_u32 m0, s30, 98304
    s_nop 0
    buffer_load_dwordx4 v241, s[8:11], s45 offen nt lds
    v_mfma_f32_16x16x32_bf16 v[20:23], v[104:107], v[120:123], v[20:23]
    s_add_u32 m0, s30, 99200
    s_nop 0
    buffer_load_dwordx4 v241, s[8:11], s45 offen offset:128 nt lds
    ds_read_b128 v[120:123], v244 offset:40960
    s_waitcnt lgkmcnt(8)
    v_mfma_f32_16x16x32_bf16 v[36:39], v[96:99], v[124:127], v[36:39]
    s_add_u32 m0, s30, 100096
    s_nop 0
    buffer_load_dwordx4 v241, s[8:11], s45 offen offset:256 nt lds
    v_mfma_f32_16x16x32_bf16 v[40:43], v[100:103], v[124:127], v[40:43]
    s_add_u32 s45, s32, 0
    s_add_u32 m0, s30, 24576
    s_nop 0
    buffer_load_dwordx4 v241, s[12:15], s45 offen nt lds
    v_mfma_f32_16x16x32_bf16 v[44:47], v[104:107], v[124:127], v[44:47]
    s_add_u32 m0, s30, 25472
    s_nop 0
    buffer_load_dwordx4 v241, s[12:15], s45 offen offset:128 nt lds
    ds_read_b128 v[124:127], v245 offset:34816
    s_waitcnt lgkmcnt(8)
    v_mfma_f32_16x16x32_bf16 v[60:63], v[96:99], v[128:131], v[60:63]
    s_add_u32 m0, s30, 26368
    s_nop 0
    buffer_load_dwordx4 v241, s[12:15], s45 offen offset:256 nt lds
    v_mfma_f32_16x16x32_bf16 v[64:67], v[100:103], v[128:131], v[64:67]
    v_mfma_f32_16x16x32_bf16 v[68:71], v[104:107], v[128:131], v[68:71]
    ds_read_b128 v[128:131], v245 offset:36864
    s_waitcnt lgkmcnt(2)
    v_mfma_f32_16x16x32_bf16 v[84:87], v[96:99], v[120:123], v[84:87]
    v_mfma_f32_16x16x32_bf16 v[88:91], v[100:103], v[120:123], v[88:91]
    v_mfma_f32_16x16x32_bf16 v[92:95], v[104:107], v[120:123], v[92:95]
    ds_read_b128 v[120:123], v245 offset:38912
    s_waitcnt lgkmcnt(2)
    v_mfma_f32_16x16x32_bf16 v[12:15], v[108:111], v[124:127], v[12:15]
    v_mfma_f32_16x16x32_bf16 v[16:19], v[112:115], v[124:127], v[16:19]
    v_mfma_f32_16x16x32_bf16 v[20:23], v[116:119], v[124:127], v[20:23]
    ds_read_b128 v[124:127], v245 offset:40960
    s_waitcnt lgkmcnt(2)
    v_mfma_f32_16x16x32_bf16 v[36:39], v[108:111], v[128:131], v[36:39]
    v_mfma_f32_16x16x32_bf16 v[40:43], v[112:115], v[128:131], v[40:43]
    v_mfma_f32_16x16x32_bf16 v[44:47], v[116:119], v[128:131], v[44:47]
    s_waitcnt lgkmcnt(1)
    v_mfma_f32_16x16x32_bf16 v[60:63], v[108:111], v[120:123], v[60:63]
    v_mfma_f32_16x16x32_bf16 v[64:67], v[112:115], v[120:123], v[64:67]
    v_mfma_f32_16x16x32_bf16 v[68:71], v[116:119], v[120:123], v[68:71]
    s_waitcnt lgkmcnt(0)
    v_mfma_f32_16x16x32_bf16 v[84:87], v[108:111], v[124:127], v[84:87]
    v_mfma_f32_16x16x32_bf16 v[88:91], v[112:115], v[124:127], v[88:91]
    v_mfma_f32_16x16x32_bf16 v[92:95], v[116:119], v[124:127], v[92:95]
    s_waitcnt vmcnt(6)
    s_barrier
    ds_read_b64_tr_b16 v[96:97], v246
    ds_read_b64_tr_b16 v[98:99], v246 offset:512
    ds_read_b64_tr_b16 v[100:101], v247
    ds_read_b64_tr_b16 v[102:103], v247 offset:512
    ds_read_b64_tr_b16 v[104:105], v248
    ds_read_b64_tr_b16 v[106:107], v248 offset:512
    ds_read_b128 v[120:123], v244 offset:53248
    ds_read_b128 v[124:127], v244 offset:55296
    ds_read_b128 v[128:131], v244 offset:57344
    ds_read_b64_tr_b16 v[108:109], v246 offset:12288
    ds_read_b64_tr_b16 v[110:111], v246 offset:12800
    ds_read_b64_tr_b16 v[112:113], v247 offset:12288
    ds_read_b64_tr_b16 v[114:115], v247 offset:12800
    ds_read_b64_tr_b16 v[116:117], v248 offset:12288
    ds_read_b64_tr_b16 v[118:119], v248 offset:12800
    s_waitcnt lgkmcnt(8)
    v_mfma_f32_16x16x32_bf16 v[12:15], v[96:99], v[120:123], v[12:15]
    s_add_u32 s45, s32, 24576
    s_add_u32 m0, s30, 49152
    s_nop 0
    buffer_load_dwordx4 v241, s[12:15], s45 offen nt lds
    v_mfma_f32_16x16x32_bf16 v[16:19], v[100:103], v[120:123], v[16:19]
    s_add_u32 m0, s30, 50048
    s_nop 0
    buffer_load_dwordx4 v241, s[12:15], s45 offen offset:128 nt lds
    v_mfma_f32_16x16x32_bf16 v[20:23], v[104:107], v[120:123], v[20:23]
    s_add_u32 m0, s30, 50944
    s_nop 0
    buffer_load_dwordx4 v241, s[12:15], s45 offen offset:256 nt lds
    ds_read_b128 v[120:123], v244 offset:59392
    s_waitcnt lgkmcnt(8)
    v_mfma_f32_16x16x32_bf16 v[36:39], v[96:99], v[124:127], v[36:39]
    v_mfma_f32_16x16x32_bf16 v[40:43], v[100:103], v[124:127], v[40:43]
    v_mfma_f32_16x16x32_bf16 v[44:47], v[104:107], v[124:127], v[44:47]
    ds_read_b128 v[124:127], v245 offset:53248
    s_waitcnt lgkmcnt(8)
    v_mfma_f32_16x16x32_bf16 v[60:63], v[96:99], v[128:131], v[60:63]
    v_mfma_f32_16x16x32_bf16 v[64:67], v[100:103], v[128:131], v[64:67]
    v_mfma_f32_16x16x32_bf16 v[68:71], v[104:107], v[128:131], v[68:71]
    ds_read_b128 v[128:131], v245 offset:55296
    s_waitcnt lgkmcnt(2)
    v_mfma_f32_16x16x32_bf16 v[84:87], v[96:99], v[120:123], v[84:87]
    v_mfma_f32_16x16x32_bf16 v[88:91], v[100:103], v[120:123], v[88:91]
    v_mfma_f32_16x16x32_bf16 v[92:95], v[104:107], v[120:123], v[92:95]
    ds_read_b128 v[120:123], v245 offset:57344
    s_waitcnt lgkmcnt(2)
    v_mfma_f32_16x16x32_bf16 v[12:15], v[108:111], v[124:127], v[12:15]
    v_mfma_f32_16x16x32_bf16 v[16:19], v[112:115], v[124:127], v[16:19]
    v_mfma_f32_16x16x32_bf16 v[20:23], v[116:119], v[124:127], v[20:23]
    ds_read_b128 v[124:127], v245 offset:59392
    s_waitcnt lgkmcnt(2)
    v_mfma_f32_16x16x32_bf16 v[36:39], v[108:111], v[128:131], v[36:39]
    v_mfma_f32_16x16x32_bf16 v[40:43], v[112:115], v[128:131], v[40:43]
    v_mfma_f32_16x16x32_bf16 v[44:47], v[116:119], v[128:131], v[44:47]
    s_waitcnt lgkmcnt(1)
    v_mfma_f32_16x16x32_bf16 v[60:63], v[108:111], v[120:123], v[60:63]
    v_mfma_f32_16x16x32_bf16 v[64:67], v[112:115], v[120:123], v[64:67]
    v_mfma_f32_16x16x32_bf16 v[68:71], v[116:119], v[120:123], v[68:71]
    s_waitcnt lgkmcnt(0)
    v_mfma_f32_16x16x32_bf16 v[84:87], v[108:111], v[124:127], v[84:87]
    v_mfma_f32_16x16x32_bf16 v[88:91], v[112:115], v[124:127], v[88:91]
    v_mfma_f32_16x16x32_bf16 v[92:95], v[116:119], v[124:127], v[92:95]
    v_cvt_pk_bf16_f32 v12, v12, v13
    v_cvt_pk_bf16_f32 v13, v14, v15
    v_cvt_pk_bf16_f32 v16, v16, v17
    v_cvt_pk_bf16_f32 v17, v18, v19
    v_cvt_pk_bf16_f32 v20, v20, v21
    v_cvt_pk_bf16_f32 v21, v22, v23
    v_cvt_pk_bf16_f32 v36, v36, v37
    v_cvt_pk_bf16_f32 v37, v38, v39
    v_cvt_pk_bf16_f32 v40, v40, v41
    v_cvt_pk_bf16_f32 v41, v42, v43
    v_cvt_pk_bf16_f32 v44, v44, v45
    v_cvt_pk_bf16_f32 v45, v46, v47
    v_cvt_pk_bf16_f32 v60, v60, v61
    v_cvt_pk_bf16_f32 v61, v62, v63
    v_cvt_pk_bf16_f32 v64, v64, v65
    v_cvt_pk_bf16_f32 v65, v66, v67
    v_cvt_pk_bf16_f32 v68, v68, v69
    v_cvt_pk_bf16_f32 v69, v70, v71
    v_cvt_pk_bf16_f32 v84, v84, v85
    v_cvt_pk_bf16_f32 v85, v86, v87
    v_cvt_pk_bf16_f32 v88, v88, v89
    v_cvt_pk_bf16_f32 v89, v90, v91
    v_cvt_pk_bf16_f32 v92, v92, v93
    v_cvt_pk_bf16_f32 v93, v94, v95
    v_and_b32 v188, 15, v240
    v_lshrrev_b32 v189, 4, v240
    v_mul_u32_u24 v190, 208, v188
    v_add_u32 v190, 122880, v190
    v_lshl_add_u32 v194, v189, 4, v190
    v_lshl_add_u32 v190, v189, 3, v190
    s_sub_u32 s45, s38, 6
    s_cmp_ge_u32 s38, 6
    s_cselect_b32 s45, s45, s38
    s_lshl_b32 s45, s45, 5
    v_add_u32 v191, s45, v190
    s_sub_u32 s45, s39, 6
    s_cmp_ge_u32 s39, 6
    s_cselect_b32 s45, s45, s39
    s_lshl_b32 s45, s45, 5
    v_add_u32 v192, s45, v190
    s_sub_u32 s45, s40, 6
    s_cmp_ge_u32 s40, 6
    s_cselect_b32 s45, s45, s40
    s_lshl_b32 s45, s45, 5
    v_add_u32 v193, s45, v190
    s_barrier
    s_add_u32 s45, s32, 49152
    s_add_u32 m0, s30, 0
    s_nop 0
    buffer_load_dwordx4 v241, s[12:15], s45 offen nt lds
    s_add_u32 m0, s30, 896
    s_nop 0
    buffer_load_dwordx4 v241, s[12:15], s45 offen offset:128 nt lds
    s_add_u32 m0, s30, 1792
    s_nop 0
    buffer_load_dwordx4 v241, s[12:15], s45 offen offset:256 nt lds
    s_cmp_ge_u32 s29, 2
    s_cbranch_scc1 L_exA_1
    ds_write_b64 v191, v[12:13] offset:16640
    ds_write_b64 v192, v[16:17] offset:16640
    ds_write_b64 v193, v[20:21] offset:16640
    ds_write_b64 v191, v[36:37] offset:19968
    ds_write_b64 v192, v[40:41] offset:19968
    ds_write_b64 v193, v[44:45] offset:19968
    ds_write_b64 v191, v[60:61] offset:23296
    ds_write_b64 v192, v[64:65] offset:23296
    ds_write_b64 v193, v[68:69] offset:23296
    ds_write_b64 v191, v[84:85] offset:26624
    ds_write_b64 v192, v[88:89] offset:26624
    ds_write_b64 v193, v[92:93] offset:26624
    s_waitcnt lgkmcnt(0)
L_exA_1:
    s_nop 9
    s_barrier
    ds_read_b128 v[0:3], v194 offset:16640
    ds_read_b128 v[4:7], v194 offset:16704
    ds_read_b128 v[8:11], v194 offset:16768
    ds_read_b128 v[24:27], v194 offset:19968
    ds_read_b128 v[28:31], v194 offset:20032
    ds_read_b128 v[32:35], v194 offset:20096
    ds_read_b128 v[48:51], v194 offset:23296
    ds_read_b128 v[52:55], v194 offset:23360
    ds_read_b128 v[56:59], v194 offset:23424
    ds_read_b128 v[72:75], v194 offset:26624
    ds_read_b128 v[76:79], v194 offset:26688
    ds_read_b128 v[80:83], v194 offset:26752
    s_waitcnt lgkmcnt(0)
    s_barrier
    s_cmp_ge_u32 s29, 2
    s_cbranch_scc0 L_exB_1
    ds_write_b64 v191, v[12:13] offset:16640
    ds_write_b64 v192, v[16:17] offset:16640
    ds_write_b64 v193, v[20:21] offset:16640
    ds_write_b64 v191, v[36:37] offset:19968
    ds_write_b64 v192, v[40:41] offset:19968
    ds_write_b64 v193, v[44:45] offset:19968
    ds_write_b64 v191, v[60:61] offset:23296
    ds_write_b64 v192, v[64:65] offset:23296
    ds_write_b64 v193, v[68:69] offset:23296
    ds_write_b64 v191, v[84:85] offset:26624
    ds_write_b64 v192, v[88:89] offset:26624
    ds_write_b64 v193, v[92:93] offset:26624
    s_waitcnt lgkmcnt(0)
L_exB_1:
    s_nop 9
    s_barrier
    ds_read_b128 v[12:15], v194 offset:16640
    ds_read_b128 v[16:19], v194 offset:16704
    ds_read_b128 v[20:23], v194 offset:16768
    ds_read_b128 v[36:39], v194 offset:19968
    ds_read_b128 v[40:43], v194 offset:20032
    ds_read_b128 v[44:47], v194 offset:20096
    ds_read_b128 v[60:63], v194 offset:23296
    ds_read_b128 v[64:67], v194 offset:23360
    ds_read_b128 v[68:71], v194 offset:23424
    ds_read_b128 v[84:87], v194 offset:26624
    ds_read_b128 v[88:91], v194 offset:26688
    ds_read_b128 v[92:95], v194 offset:26752
    v_and_b32 v188, 15, v240
    v_lshrrev_b32 v189, 4, v240
    v_bfe_u32 v190, v240, 2, 2
    v_and_b32 v191, 3, v240
    v_lshrrev_b32 v192, 1, v190
    v_lshl_add_u32 v192, v189, 1, v192
    v_and_b32 v192, 3, v192
    v_lshlrev_b32 v192, 1, v192
    v_lshrrev_b32 v193, 1, v189
    v_mul_u32_u24 v195, 3072, v193
    v_and_b32 v193, 1, v189
    v_lshl_add_u32 v193, v193, 2, v190
    v_lshl_add_u32 v195, v193, 7, v195
    v_and_b32 v193, 1, v191
    v_lshl_add_u32 v195, v193, 3, v195
    v_lshrrev_b32 v191, 1, v191
    s_lshl_b32 s45, s38, 1
    v_add_u32 v193, s45, v191
    v_lshrrev_b32 v194, 3, v193
    v_and_b32 v193, 7, v193
    v_xor_b32 v193, v193, v192
    v_lshl_add_u32 v193, v193, 4, v195
    v_lshl_add_u32 v246, v194, 10, v193
    s_lshl_b32 s45, s39, 1
    v_add_u32 v193, s45, v191
    v_lshrrev_b32 v194, 3, v193
    v_and_b32 v193, 7, v193
    v_xor_b32 v193, v193, v192
    v_lshl_add_u32 v193, v193, 4, v195
    v_lshl_add_u32 v247, v194, 10, v193
    s_lshl_b32 s45, s40, 1
    v_add_u32 v193, s45, v191
    v_lshrrev_b32 v194, 3, v193
    v_and_b32 v193, 7, v193
    v_xor_b32 v193, v193, v192
    v_lshl_add_u32 v193, v193, 4, v195
    v_lshl_add_u32 v248, v194, 10, v193
    v_and_b32 v188, 15, v240
    v_lshrrev_b32 v189, 4, v240
    v_and_b32 v190, 6, v188
    v_xor_b32 v191, v189, v190
    v_lshlrev_b32 v191, 4, v191
    v_and_b32 v192, 7, v188
    v_lshl_add_u32 v191, v192, 7, v191
    v_lshrrev_b32 v192, 3, v188
    v_mul_u32_u24 v192, 3072, v192
    s_mul_i32 s45, s29, 6144
    s_add_u32 s45, s45, 73728
    v_add3_u32 v244, v191, v192, s45
    v_xor_b32 v245, 64, v244
    v_mov_b32 v229, 0xff800000
    v_mov_b32 v230, 0
    v_mov_b32 v224, 0xff800000
    v_mov_b32 v231, 0
    v_mov_b32 v225, 0xff800000
    v_mov_b32 v232, 0
    v_mov_b32 v226, 0xff800000
    v_mov_b32 v233, 0
    v_mov_b32 v227, 0xff800000
    v_mov_b32 v234, 0
    ds_read_b128 v[188:191], v244
    ds_read_b128 v[192:195], v245
    ds_read_b128 v[208:211], v244 offset:1024
    ds_read_b128 v[212:215], v245 offset:1024
    ds_read_b128 v[216:219], v244 offset:2048
    s_waitcnt lgkmcnt(4)
    v_mfma_f32_16x16x32_bf16 v[156:159], v[188:191], v[0:3], 0
    v_mfma_f32_16x16x32_bf16 v[160:163], v[188:191], v[24:27], 0
    v_mfma_f32_16x16x32_bf16 v[164:167], v[188:191], v[48:51], 0
    v_mfma_f32_16x16x32_bf16 v[168:171], v[188:191], v[72:75], 0
    ds_read_b128 v[188:191], v245 offset:2048
    s_waitcnt lgkmcnt(4)
    v_mfma_f32_16x16x32_bf16 v[156:159], v[192:195], v[4:7], v[156:159]
    v_mfma_f32_16x16x32_bf16 v[160:163], v[192:195], v[28:31], v[160:163]
    v_mfma_f32_16x16x32_bf16 v[164:167], v[192:195], v[52:55], v[164:167]
    v_mfma_f32_16x16x32_bf16 v[168:171], v[192:195], v[76:79], v[168:171]
    s_waitcnt lgkmcnt(3)
    v_mfma_f32_16x16x32_bf16 v[156:159], v[208:211], v[8:11], v[156:159]
    v_mfma_f32_16x16x32_bf16 v[160:163], v[208:211], v[32:35], v[160:163]
    v_mfma_f32_16x16x32_bf16 v[164:167], v[208:211], v[56:59], v[164:167]
    v_mfma_f32_16x16x32_bf16 v[168:171], v[208:211], v[80:83], v[168:171]
    s_waitcnt lgkmcnt(2)
    v_mfma_f32_16x16x32_bf16 v[156:159], v[212:215], v[12:15], v[156:159]
    v_mfma_f32_16x16x32_bf16 v[160:163], v[212:215], v[36:39], v[160:163]
    v_mfma_f32_16x16x32_bf16 v[164:167], v[212:215], v[60:63], v[164:167]
    v_mfma_f32_16x16x32_bf16 v[168:171], v[212:215], v[84:87], v[168:171]
    s_waitcnt lgkmcnt(1)
    v_mfma_f32_16x16x32_bf16 v[156:159], v[216:219], v[16:19], v[156:159]
    v_mfma_f32_16x16x32_bf16 v[160:163], v[216:219], v[40:43], v[160:163]
    v_mfma_f32_16x16x32_bf16 v[164:167], v[216:219], v[64:67], v[164:167]
    v_mfma_f32_16x16x32_bf16 v[168:171], v[216:219], v[88:91], v[168:171]
    s_waitcnt lgkmcnt(0)
    v_mfma_f32_16x16x32_bf16 v[156:159], v[188:191], v[20:23], v[156:159]
    v_mfma_f32_16x16x32_bf16 v[160:163], v[188:191], v[44:47], v[160:163]
    v_mfma_f32_16x16x32_bf16 v[164:167], v[188:191], v[68:71], v[164:167]
    v_mfma_f32_16x16x32_bf16 v[168:171], v[188:191], v[92:95], v[168:171]
    s_nop 4
    v_max3_f32 v253, v156, v157, v158
    v_max_f32 v253, v253, v159
    ds_max_f32 v251, v253 offset:32
    v_max3_f32 v254, v160, v161, v162
    v_max_f32 v254, v254, v163
    ds_max_f32 v251, v254 offset:36
    v_max3_f32 v253, v164, v165, v166
    v_max_f32 v253, v253, v167
    ds_max_f32 v251, v253 offset:40
    v_max3_f32 v254, v168, v169, v170
    v_max_f32 v254, v254, v171
    ds_max_f32 v251, v254 offset:44
    s_waitcnt vmcnt(9)
    s_waitcnt lgkmcnt(0)
    s_barrier
    ds_read_b32 v228, v251 offset:28
    ds_read_b128 v[220:223], v251 offset:32
    ds_read_b128 v[188:191], v244 offset:24576
    ds_read_b128 v[192:195], v245 offset:24576
    s_waitcnt lgkmcnt(3)
    v_mul_f32 v228, s37, v228
    s_waitcnt lgkmcnt(2)
    v_mul_f32 v220, s37, v220
    v_mul_f32 v221, s37, v221
    v_mul_f32 v222, s37, v222
    v_mul_f32 v223, s37, v223
    v_sub_f32 v235, v228, v229
    v_sub_f32 v236, v220, v224
    v_sub_f32 v237, v221, v225
    v_sub_f32 v238, v222, v226
    v_sub_f32 v239, v223, v227
    v_cmp_lt_f32 s[78:79], 4.0, v235
    v_cmp_lt_f32 s[80:81], 4.0, v236
    v_cmp_lt_f32 s[82:83], 4.0, v237
    v_cmp_lt_f32 s[84:85], 4.0, v238
    v_cmp_lt_f32 s[86:87], 4.0, v239
    v_cndmask_b32 v228, v229, v228, s[78:79]
    v_cndmask_b32 v220, v224, v220, s[80:81]
    v_cndmask_b32 v221, v225, v221, s[82:83]
    v_cndmask_b32 v222, v226, v222, s[84:85]
    v_cndmask_b32 v223, v227, v223, s[86:87]
    s_or_b64 s[76:77], s[78:79], s[80:81]
    s_or_b64 s[82:83], s[82:83], s[84:85]
    s_or_b64 s[76:77], s[76:77], s[86:87]
    s_or_b64 s[76:77], s[76:77], s[82:83]
    s_cbranch_scc0 L_nl_1_0
    v_sub_f32 v235, v229, v228
    v_sub_f32 v236, v224, v220
    v_sub_f32 v237, v225, v221
    v_sub_f32 v238, v226, v222
    v_sub_f32 v239, v227, v223
    v_exp_f32 v235, v235
    v_exp_f32 v236, v236
    v_exp_f32 v237, v237
    v_exp_f32 v238, v238
    v_exp_f32 v239, v239
    v_mul_f32 v231, v236, v231
    v_mul_f32 v232, v237, v232
    v_mul_f32 v233, v238, v233
    v_mul_f32 v234, v239, v234
L_nl_1_0:
    v_fma_f32 v156, v156, s37, -v220
    v_fma_f32 v157, v157, s37, -v220
    v_fma_f32 v158, v158, s37, -v220
    v_fma_f32 v159, v159, s37, -v220
    v_fma_f32 v160, v160, s37, -v221
    v_fma_f32 v161, v161, s37, -v221
    v_fma_f32 v162, v162, s37, -v221
    v_fma_f32 v163, v163, s37, -v221
    v_fma_f32 v164, v164, s37, -v222
    v_fma_f32 v165, v165, s37, -v222
    v_fma_f32 v166, v166, s37, -v222
    v_fma_f32 v167, v167, s37, -v222
    v_fma_f32 v168, v168, s37, -v223
    v_fma_f32 v169, v169, s37, -v223
    v_fma_f32 v170, v170, s37, -v223
    v_fma_f32 v171, v171, s37, -v223
    v_exp_f32 v156, v156
    v_exp_f32 v157, v157
    v_exp_f32 v158, v158
    v_exp_f32 v159, v159
    v_exp_f32 v160, v160
    v_exp_f32 v161, v161
    v_exp_f32 v162, v162
    v_exp_f32 v163, v163
    v_exp_f32 v164, v164
    v_exp_f32 v165, v165
    v_exp_f32 v166, v166
    v_exp_f32 v167, v167
    v_exp_f32 v168, v168
    v_exp_f32 v169, v169
    v_exp_f32 v170, v170
    v_exp_f32 v171, v171
    v_add_f32 v231, v231, v156
    v_add_f32 v252, v157, v158
    v_add_f32 v231, v231, v159
    v_cvt_pk_bf16_f32 v156, v156, v157
    v_add_f32 v231, v231, v252
    v_cvt_pk_bf16_f32 v157, v158, v159
    ds_write_b64 v250, v[156:157] offset:10240
    v_add_f32 v232, v232, v160
    v_add_f32 v252, v161, v162
    v_add_f32 v232, v232, v163
    v_cvt_pk_bf16_f32 v160, v160, v161
    v_add_f32 v232, v232, v252
    v_cvt_pk_bf16_f32 v161, v162, v163
    ds_write_b64 v250, v[160:161] offset:12288
    v_add_f32 v233, v233, v164
    v_add_f32 v252, v165, v166
    v_add_f32 v233, v233, v167
    v_cvt_pk_bf16_f32 v164, v164, v165
    v_add_f32 v233, v233, v252
    v_cvt_pk_bf16_f32 v165, v166, v167
    ds_write_b64 v250, v[164:165] offset:14336
    v_add_f32 v234, v234, v168
    v_add_f32 v252, v169, v170
    v_add_f32 v234, v234, v171
    v_cvt_pk_bf16_f32 v168, v168, v169
    v_add_f32 v234, v234, v252
    v_cvt_pk_bf16_f32 v169, v170, v171
    ds_write_b64 v250, v[168:169] offset:16384
    ds_read_b128 v[208:211], v244 offset:25600
    ds_read_b128 v[212:215], v245 offset:25600
    ds_read_b128 v[216:219], v244 offset:26624
    s_waitcnt lgkmcnt(8)
    v_mfma_f32_16x16x32_bf16 v[156:159], v[188:191], v[0:3], 0
    s_add_u32 s45, s32, 49152
    s_add_u32 m0, s30, 73728
    s_nop 0
    buffer_load_dwordx4 v241, s[8:11], s45 offen nt lds
    v_mfma_f32_16x16x32_bf16 v[160:163], v[188:191], v[24:27], 0
    s_add_u32 m0, s30, 74624
    s_nop 0
    buffer_load_dwordx4 v241, s[8:11], s45 offen offset:128 nt lds
    v_mfma_f32_16x16x32_bf16 v[164:167], v[188:191], v[48:51], 0
    s_add_u32 m0, s30, 75520
    s_nop 0
    buffer_load_dwordx4 v241, s[8:11], s45 offen offset:256 nt lds
    v_mfma_f32_16x16x32_bf16 v[168:171], v[188:191], v[72:75], 0
    ds_read_b128 v[188:191], v245 offset:26624
    s_waitcnt lgkmcnt(8)
    v_mfma_f32_16x16x32_bf16 v[156:159], v[192:195], v[4:7], v[156:159]
    v_mfma_f32_16x16x32_bf16 v[160:163], v[192:195], v[28:31], v[160:163]
    v_mfma_f32_16x16x32_bf16 v[164:167], v[192:195], v[52:55], v[164:167]
    v_mfma_f32_16x16x32_bf16 v[168:171], v[192:195], v[76:79], v[168:171]
    s_waitcnt lgkmcnt(3)
    v_mfma_f32_16x16x32_bf16 v[156:159], v[208:211], v[8:11], v[156:159]
    v_mfma_f32_16x16x32_bf16 v[160:163], v[208:211], v[32:35], v[160:163]
    v_mfma_f32_16x16x32_bf16 v[164:167], v[208:211], v[56:59], v[164:167]
    v_mfma_f32_16x16x32_bf16 v[168:171], v[208:211], v[80:83], v[168:171]
    s_waitcnt lgkmcnt(2)
    v_mfma_f32_16x16x32_bf16 v[156:159], v[212:215], v[12:15], v[156:159]
    v_mfma_f32_16x16x32_bf16 v[160:163], v[212:215], v[36:39], v[160:163]
    v_mfma_f32_16x16x32_bf16 v[164:167], v[212:215], v[60:63], v[164:167]
    v_mfma_f32_16x16x32_bf16 v[168:171], v[212:215], v[84:87], v[168:171]
    s_waitcnt lgkmcnt(1)
    v_mfma_f32_16x16x32_bf16 v[156:159], v[216:219], v[16:19], v[156:159]
    v_mfma_f32_16x16x32_bf16 v[160:163], v[216:219], v[40:43], v[160:163]
    v_mfma_f32_16x16x32_bf16 v[164:167], v[216:219], v[64:67], v[164:167]
    v_mfma_f32_16x16x32_bf16 v[168:171], v[216:219], v[88:91], v[168:171]
    s_waitcnt lgkmcnt(0)
    v_mfma_f32_16x16x32_bf16 v[156:159], v[188:191], v[20:23], v[156:159]
    v_mfma_f32_16x16x32_bf16 v[160:163], v[188:191], v[44:47], v[160:163]
    v_mfma_f32_16x16x32_bf16 v[164:167], v[188:191], v[68:71], v[164:167]
    v_mfma_f32_16x16x32_bf16 v[168:171], v[188:191], v[92:95], v[168:171]
    s_nop 4
    v_max3_f32 v253, v156, v157, v158
    v_max_f32 v253, v253, v159
    ds_max_f32 v251, v253 offset:800
    v_max3_f32 v254, v160, v161, v162
    v_max_f32 v254, v254, v163
    ds_max_f32 v251, v254 offset:804
    v_max3_f32 v253, v164, v165, v166
    v_max_f32 v253, v253, v167
    ds_max_f32 v251, v253 offset:808
    v_max3_f32 v254, v168, v169, v170
    v_max_f32 v254, v254, v171
    ds_max_f32 v251, v254 offset:812
    s_waitcnt vmcnt(9)
    s_waitcnt lgkmcnt(0)
    s_barrier
    ds_read_b32 v229, v251 offset:796
    ds_read_b128 v[224:227], v251 offset:800
    v_add_u32 v246, 24576, v246
    v_add_u32 v247, 24576, v247
    v_add_u32 v248, 24576, v248
    ds_read_b64_tr_b16 v[196:197], v246
    ds_read_b64_tr_b16 v[198:199], v246 offset:6144
    ds_read_b64_tr_b16 v[200:201], v247
    ds_read_b64_tr_b16 v[202:203], v247 offset:6144
    ds_read_b64_tr_b16 v[204:205], v248
    ds_read_b64_tr_b16 v[206:207], v248 offset:6144
    ds_read_b128 v[208:211], v249 offset:8192
    ds_read_b128 v[212:215], v249 offset:10240
    ds_read_b128 v[216:219], v249 offset:12288
    s_waitcnt lgkmcnt(2)
    v_mfma_f32_16x16x32_bf16 v[96:99], v[196:199], v[208:211], 0
    v_mul_f32 v229, s37, v229
    v_mul_f32 v224, s37, v224
    v_mul_f32 v225, s37, v225
    s_add_u32 s45, s32, 73728
    s_add_u32 m0, s30, 98304
    s_nop 0
    buffer_load_dwordx4 v241, s[8:11], s45 offen nt lds
    v_mfma_f32_16x16x32_bf16 v[100:103], v[200:203], v[208:211], 0
    v_mul_f32 v226, s37, v226
    v_mul_f32 v227, s37, v227
    v_sub_f32 v235, v229, v228
    s_add_u32 m0, s30, 99200
    s_nop 0
    buffer_load_dwordx4 v241, s[8:11], s45 offen offset:128 nt lds
    v_mfma_f32_16x16x32_bf16 v[104:107], v[204:207], v[208:211], 0
    v_sub_f32 v236, v224, v220
    v_sub_f32 v237, v225, v221
    v_sub_f32 v238, v226, v222
    s_add_u32 m0, s30, 100096
    s_nop 0
    buffer_load_dwordx4 v241, s[8:11], s45 offen offset:256 nt lds
    ds_read_b128 v[208:211], v249 offset:14336
    s_waitcnt lgkmcnt(2)
    v_mfma_f32_16x16x32_bf16 v[108:111], v[196:199], v[212:215], 0
    v_sub_f32 v239, v227, v223
    v_cmp_lt_f32 s[78:79], 4.0, v235
    v_cmp_lt_f32 s[80:81], 4.0, v236
    v_mfma_f32_16x16x32_bf16 v[112:115], v[200:203], v[212:215], 0
    v_cmp_lt_f32 s[82:83], 4.0, v237
    v_cmp_lt_f32 s[84:85], 4.0, v238
    v_mfma_f32_16x16x32_bf16 v[116:119], v[204:207], v[212:215], 0
    v_cmp_lt_f32 s[86:87], 4.0, v239
    v_cndmask_b32 v229, v228, v229, s[78:79]
    v_cndmask_b32 v224, v220, v224, s[80:81]
    ds_read_b128 v[212:215], v249 offset:16384
    s_waitcnt lgkmcnt(2)
    v_mfma_f32_16x16x32_bf16 v[120:123], v[196:199], v[216:219], 0
    v_cndmask_b32 v225, v221, v225, s[82:83]
    v_cndmask_b32 v226, v222, v226, s[84:85]
    v_cndmask_b32 v227, v223, v227, s[86:87]
    v_mfma_f32_16x16x32_bf16 v[124:127], v[200:203], v[216:219], 0
    s_or_b64 s[76:77], s[78:79], s[80:81]
    s_or_b64 s[82:83], s[82:83], s[84:85]
    s_or_b64 s[76:77], s[76:77], s[86:87]
    s_or_b64 s[76:77], s[76:77], s[82:83]
    s_cbranch_scc0 L_nl_1_1
    v_sub_f32 v235, v228, v229
    v_sub_f32 v236, v220, v224
    v_sub_f32 v237, v221, v225
    v_sub_f32 v238, v222, v226
    v_sub_f32 v239, v223, v227
    v_exp_f32 v235, v235
    v_exp_f32 v236, v236
    v_exp_f32 v237, v237
    v_exp_f32 v238, v238
    v_exp_f32 v239, v239
    v_mul_f32 v231, v236, v231
    v_mul_f32 v232, v237, v232
    v_mul_f32 v233, v238, v233
    v_mul_f32 v234, v239, v234
L_nl_1_1:
    v_fma_f32 v156, v156, s37, -v224
    v_fma_f32 v157, v157, s37, -v224
    v_mfma_f32_16x16x32_bf16 v[128:131], v[204:207], v[216:219], 0
    v_fma_f32 v158, v158, s37, -v224
    v_fma_f32 v159, v159, s37, -v224
    v_fma_f32 v160, v160, s37, -v225
    ds_read_b128 v[216:219], v249 offset:9216
    s_waitcnt lgkmcnt(2)
    v_mfma_f32_16x16x32_bf16 v[132:135], v[196:199], v[208:211], 0
    v_fma_f32 v161, v161, s37, -v225
    v_fma_f32 v162, v162, s37, -v225
    v_mfma_f32_16x16x32_bf16 v[136:139], v[200:203], v[208:211], 0
    v_fma_f32 v163, v163, s37, -v225
    v_fma_f32 v164, v164, s37, -v226
    v_fma_f32 v165, v165, s37, -v226
    v_mfma_f32_16x16x32_bf16 v[140:143], v[204:207], v[208:211], 0
    v_fma_f32 v166, v166, s37, -v226
    v_fma_f32 v167, v167, s37, -v226
    v_fma_f32 v168, v168, s37, -v227
    ds_read_b128 v[208:211], v249 offset:11264
    s_waitcnt lgkmcnt(2)
    v_mfma_f32_16x16x32_bf16 v[144:147], v[196:199], v[212:215], 0
    v_fma_f32 v169, v169, s37, -v227
    v_fma_f32 v170, v170, s37, -v227
    v_fma_f32 v171, v171, s37, -v227
    ds_read_b64_tr_b16 v[196:197], v246 offset:12288
    ds_read_b64_tr_b16 v[198:199], v246 offset:18432
    v_mfma_f32_16x16x32_bf16 v[148:151], v[200:203], v[212:215], 0
    v_exp_f32 v156, v156
    v_exp_f32 v157, v157
    v_exp_f32 v158, v158
    ds_read_b64_tr_b16 v[200:201], v247 offset:12288
    ds_read_b64_tr_b16 v[202:203], v247 offset:18432
    v_mfma_f32_16x16x32_bf16 v[152:155], v[204:207], v[212:215], 0
    v_exp_f32 v159, v159
    v_exp_f32 v160, v160
    ds_read_b64_tr_b16 v[204:205], v248 offset:12288
    ds_read_b64_tr_b16 v[206:207], v248 offset:18432
    ds_read_b128 v[212:215], v249 offset:13312
    s_waitcnt lgkmcnt(5)
    v_mfma_f32_16x16x32_bf16 v[96:99], v[196:199], v[216:219], v[96:99]
    v_exp_f32 v161, v161
    v_exp_f32 v162, v162
    v_exp_f32 v163, v163
    s_waitcnt lgkmcnt(3)
    v_mfma_f32_16x16x32_bf16 v[100:103], v[200:203], v[216:219], v[100:103]
    v_exp_f32 v164, v164
    v_exp_f32 v165, v165
    v_exp_f32 v166, v166
    s_waitcnt lgkmcnt(1)
    v_mfma_f32_16x16x32_bf16 v[104:107], v[204:207], v[216:219], v[104:107]
    v_exp_f32 v167, v167
    v_exp_f32 v168, v168
    v_exp_f32 v169, v169
    ds_read_b128 v[216:219], v249 offset:15360
    v_mfma_f32_16x16x32_bf16 v[108:111], v[196:199], v[208:211], v[108:111]
    v_exp_f32 v170, v170
    v_exp_f32 v171, v171
    v_add_f32 v231, v231, v156
    v_mfma_f32_16x16x32_bf16 v[112:115], v[200:203], v[208:211], v[112:115]
    v_add_f32 v252, v157, v158
    v_add_f32 v231, v231, v159
    v_mfma_f32_16x16x32_bf16 v[116:119], v[204:207], v[208:211], v[116:119]
    v_cvt_pk_bf16_f32 v156, v156, v157
    v_add_f32 v231, v231, v252
    v_cvt_pk_bf16_f32 v157, v158, v159
    ds_read_b128 v[208:211], v249 offset:17408
    s_waitcnt lgkmcnt(2)
    v_mfma_f32_16x16x32_bf16 v[120:123], v[196:199], v[212:215], v[120:123]
    ds_write_b64 v250, v[156:157] offset:28672
    v_add_f32 v232, v232, v160
    v_add_f32 v252, v161, v162
    v_mfma_f32_16x16x32_bf16 v[124:127], v[200:203], v[212:215], v[124:127]
    v_add_f32 v232, v232, v163
    v_cvt_pk_bf16_f32 v160, v160, v161
    v_add_f32 v232, v232, v252
    v_mfma_f32_16x16x32_bf16 v[128:131], v[204:207], v[212:215], v[128:131]
    v_cvt_pk_bf16_f32 v161, v162, v163
    ds_write_b64 v250, v[160:161] offset:30720
    v_add_f32 v233, v233, v164
    s_waitcnt lgkmcnt(3)
    v_mfma_f32_16x16x32_bf16 v[132:135], v[196:199], v[216:219], v[132:135]
    v_add_f32 v252, v165, v166
    v_add_f32 v233, v233, v167
    v_mfma_f32_16x16x32_bf16 v[136:139], v[200:203], v[216:219], v[136:139]
    v_cvt_pk_bf16_f32 v164, v164, v165
    v_add_f32 v233, v233, v252
    v_cvt_pk_bf16_f32 v165, v166, v167
    v_mfma_f32_16x16x32_bf16 v[140:143], v[204:207], v[216:219], v[140:143]
    ds_write_b64 v250, v[164:165] offset:32768
    v_add_f32 v234, v234, v168
    v_add_f32 v252, v169, v170
    s_waitcnt lgkmcnt(3)
    v_mfma_f32_16x16x32_bf16 v[144:147], v[196:199], v[208:211], v[144:147]
    v_add_f32 v234, v234, v171
    v_cvt_pk_bf16_f32 v168, v168, v169
    v_add_f32 v234, v234, v252
    v_mfma_f32_16x16x32_bf16 v[148:151], v[200:203], v[208:211], v[148:151]
    v_cvt_pk_bf16_f32 v169, v170, v171
    ds_write_b64 v250, v[168:169] offset:34816
    v_mfma_f32_16x16x32_bf16 v[152:155], v[204:207], v[208:211], v[152:155]
    s_waitcnt vmcnt(3)
    s_waitcnt lgkmcnt(0)
    s_barrier
    ds_read_b128 v[188:191], v244
    ds_read_b128 v[192:195], v245
    ds_read_b128 v[208:211], v244 offset:1024
    ds_read_b128 v[212:215], v245 offset:1024
    ds_read_b128 v[216:219], v244 offset:2048
    s_cmp_eq_u64 s[76:77], 0
    s_cbranch_scc1 L_nr_1_1
    v_mul_f32 v96, v235, v96
    v_mul_f32 v97, v235, v97
    v_mul_f32 v98, v235, v98
    v_mul_f32 v99, v235, v99
    v_mul_f32 v100, v235, v100
    v_mul_f32 v101, v235, v101
    v_mul_f32 v102, v235, v102
    v_mul_f32 v103, v235, v103
    v_mul_f32 v104, v235, v104
    v_mul_f32 v105, v235, v105
    v_mul_f32 v106, v235, v106
    v_mul_f32 v107, v235, v107
    v_mul_f32 v108, v236, v108
    v_mul_f32 v109, v236, v109
    v_mul_f32 v110, v236, v110
    v_mul_f32 v111, v236, v111
    v_mul_f32 v112, v236, v112
    v_mul_f32 v113, v236, v113
    v_mul_f32 v114, v236, v114
    v_mul_f32 v115, v236, v115
    v_mul_f32 v116, v236, v116
    v_mul_f32 v117, v236, v117
    v_mul_f32 v118, v236, v118
    v_mul_f32 v119, v236, v119
    v_mul_f32 v120, v237, v120
    v_mul_f32 v121, v237, v121
    v_mul_f32 v122, v237, v122
    v_mul_f32 v123, v237, v123
    v_mul_f32 v124, v237, v124
    v_mul_f32 v125, v237, v125
    v_mul_f32 v126, v237, v126
    v_mul_f32 v127, v237, v127
    v_mul_f32 v128, v237, v128
    v_mul_f32 v129, v237, v129
    v_mul_f32 v130, v237, v130
    v_mul_f32 v131, v237, v131
    v_mul_f32 v132, v238, v132
    v_mul_f32 v133, v238, v133
    v_mul_f32 v134, v238, v134
    v_mul_f32 v135, v238, v135
    v_mul_f32 v136, v238, v136
    v_mul_f32 v137, v238, v137
    v_mul_f32 v138, v238, v138
    v_mul_f32 v139, v238, v139
    v_mul_f32 v140, v238, v140
    v_mul_f32 v141, v238, v141
    v_mul_f32 v142, v238, v142
    v_mul_f32 v143, v238, v143
    v_mul_f32 v144, v239, v144
    v_mul_f32 v145, v239, v145
    v_mul_f32 v146, v239, v146
    v_mul_f32 v147, v239, v147
    v_mul_f32 v148, v239, v148
    v_mul_f32 v149, v239, v149
    v_mul_f32 v150, v239, v150
    v_mul_f32 v151, v239, v151
    v_mul_f32 v152, v239, v152
    v_mul_f32 v153, v239, v153
    v_mul_f32 v154, v239, v154
    v_mul_f32 v155, v239, v155
L_nr_1_1:
    s_waitcnt lgkmcnt(4)
    v_mfma_f32_16x16x32_bf16 v[156:159], v[188:191], v[0:3], 0
    s_add_u32 s45, s32, 73728
    s_add_u32 m0, s30, 24576
    s_nop 0
    buffer_load_dwordx4 v241, s[12:15], s45 offen nt lds
    v_mfma_f32_16x16x32_bf16 v[160:163], v[188:191], v[24:27], 0
    s_add_u32 m0, s30, 25472
    s_nop 0
    buffer_load_dwordx4 v241, s[12:15], s45 offen offset:128 nt lds
    v_mfma_f32_16x16x32_bf16 v[164:167], v[188:191], v[48:51], 0
    s_add_u32 m0, s30, 26368
    s_nop 0
    buffer_load_dwordx4 v241, s[12:15], s45 offen offset:256 nt lds
    v_mfma_f32_16x16x32_bf16 v[168:171], v[188:191], v[72:75], 0
    ds_read_b128 v[188:191], v245 offset:2048
    s_waitcnt lgkmcnt(4)
    v_mfma_f32_16x16x32_bf16 v[156:159], v[192:195], v[4:7], v[156:159]
    v_mfma_f32_16x16x32_bf16 v[160:163], v[192:195], v[28:31], v[160:163]
    v_mfma_f32_16x16x32_bf16 v[164:167], v[192:195], v[52:55], v[164:167]
    v_mfma_f32_16x16x32_bf16 v[168:171], v[192:195], v[76:79], v[168:171]
    s_waitcnt lgkmcnt(3)
    v_mfma_f32_16x16x32_bf16 v[156:159], v[208:211], v[8:11], v[156:159]
    v_mfma_f32_16x16x32_bf16 v[160:163], v[208:211], v[32:35], v[160:163]
    v_mfma_f32_16x16x32_bf16 v[164:167], v[208:211], v[56:59], v[164:167]
    v_mfma_f32_16x16x32_bf16 v[168:171], v[208:211], v[80:83], v[168:171]
    s_waitcnt lgkmcnt(2)
    v_mfma_f32_16x16x32_bf16 v[156:159], v[212:215], v[12:15], v[156:159]
    v_mfma_f32_16x16x32_bf16 v[160:163], v[212:215], v[36:39], v[160:163]
    v_mfma_f32_16x16x32_bf16 v[164:167], v[212:215], v[60:63], v[164:167]
    v_mfma_f32_16x16x32_bf16 v[168:171], v[212:215], v[84:87], v[168:171]
    s_waitcnt lgkmcnt(1)
    v_mfma_f32_16x16x32_bf16 v[156:159], v[216:219], v[16:19], v[156:159]
    v_mfma_f32_16x16x32_bf16 v[160:163], v[216:219], v[40:43], v[160:163]
    v_mfma_f32_16x16x32_bf16 v[164:167], v[216:219], v[64:67], v[164:167]
    v_mfma_f32_16x16x32_bf16 v[168:171], v[216:219], v[88:91], v[168:171]
    s_waitcnt lgkmcnt(0)
    v_mfma_f32_16x16x32_bf16 v[156:159], v[188:191], v[20:23], v[156:159]
    v_mfma_f32_16x16x32_bf16 v[160:163], v[188:191], v[44:47], v[160:163]
    v_mfma_f32_16x16x32_bf16 v[164:167], v[188:191], v[68:71], v[164:167]
    v_mfma_f32_16x16x32_bf16 v[168:171], v[188:191], v[92:95], v[168:171]
    s_nop 4
    v_max3_f32 v253, v156, v157, v158
    v_max_f32 v253, v253, v159
    ds_max_f32 v251, v253 offset:32
    v_max3_f32 v254, v160, v161, v162
    v_max_f32 v254, v254, v163
    ds_max_f32 v251, v254 offset:36
    v_max3_f32 v253, v164, v165, v166
    v_max_f32 v253, v253, v167
    ds_max_f32 v251, v253 offset:40
    v_max3_f32 v254, v168, v169, v170
    v_max_f32 v254, v254, v171
    ds_max_f32 v251, v254 offset:44
    s_waitcnt lgkmcnt(0)
    s_barrier
    ds_read_b32 v228, v251 offset:28
    ds_read_b128 v[220:223], v251 offset:32
    v_add_u32 v246, 24576, v246
    v_add_u32 v247, 24576, v247
    v_add_u32 v248, 24576, v248
    ds_read_b64_tr_b16 v[196:197], v246
    ds_read_b64_tr_b16 v[198:199], v246 offset:6144
    ds_read_b64_tr_b16 v[200:201], v247
    ds_read_b64_tr_b16 v[202:203], v247 offset:6144
    ds_read_b64_tr_b16 v[204:205], v248
    ds_read_b64_tr_b16 v[206:207], v248 offset:6144
    ds_read_b128 v[208:211], v249 offset:26624
    ds_read_b128 v[212:215], v249 offset:28672
    ds_read_b128 v[216:219], v249 offset:30720
    s_waitcnt lgkmcnt(2)
    v_mfma_f32_16x16x32_bf16 v[96:99], v[196:199], v[208:211], v[96:99]
    v_mul_f32 v228, s37, v228
    v_mul_f32 v220, s37, v220
    v_mul_f32 v221, s37, v221
    s_add_u32 s45, s32, 98304
    s_add_u32 m0, s30, 73728
    s_nop 0
    buffer_load_dwordx4 v241, s[8:11], s45 offen nt lds
    v_mfma_f32_16x16x32_bf16 v[100:103], v[200:203], v[208:211], v[100:103]
    v_mul_f32 v222, s37, v222
    v_mul_f32 v223, s37, v223
    v_sub_f32 v235, v228, v229
    s_add_u32 m0, s30, 74624
    s_nop 0
    buffer_load_dwordx4 v241, s[8:11], s45 offen offset:128 nt lds
    v_mfma_f32_16x16x32_bf16 v[104:107], v[204:207], v[208:211], v[104:107]
    v_sub_f32 v236, v220, v224
    v_sub_f32 v237, v221, v225
    v_sub_f32 v238, v222, v226
    s_add_u32 m0, s30, 75520
    s_nop 0
    buffer_load_dwordx4 v241, s[8:11], s45 offen offset:256 nt lds
    ds_read_b128 v[208:211], v249 offset:32768
    s_waitcnt lgkmcnt(2)
    v_mfma_f32_16x16x32_bf16 v[108:111], v[196:199], v[212:215], v[108:111]
    v_sub_f32 v239, v223, v227
    v_cmp_lt_f32 s[78:79], 4.0, v235
    v_cmp_lt_f32 s[80:81], 4.0, v236
    v_mfma_f32_16x16x32_bf16 v[112:115], v[200:203], v[212:215], v[112:115]
    v_cmp_lt_f32 s[82:83], 4.0, v237
    v_cmp_lt_f32 s[84:85], 4.0, v238
    v_mfma_f32_16x16x32_bf16 v[116:119], v[204:207], v[212:215], v[116:119]
    v_cmp_lt_f32 s[86:87], 4.0, v239
    v_cndmask_b32 v228, v229, v228, s[78:79]
    v_cndmask_b32 v220, v224, v220, s[80:81]
    ds_read_b128 v[212:215], v249 offset:34816
    s_waitcnt lgkmcnt(2)
    v_mfma_f32_16x16x32_bf16 v[120:123], v[196:199], v[216:219], v[120:123]
    v_cndmask_b32 v221, v225, v221, s[82:83]
    v_cndmask_b32 v222, v226, v222, s[84:85]
    v_cndmask_b32 v223, v227, v223, s[86:87]
    v_mfma_f32_16x16x32_bf16 v[124:127], v[200:203], v[216:219], v[124:127]
    s_or_b64 s[76:77], s[78:79], s[80:81]
    s_or_b64 s[82:83], s[82:83], s[84:85]
    s_or_b64 s[76:77], s[76:77], s[86:87]
    s_or_b64 s[76:77], s[76:77], s[82:83]
    s_cbranch_scc0 L_nl_1_2
    v_sub_f32 v235, v229, v228
    v_sub_f32 v236, v224, v220
    v_sub_f32 v237, v225, v221
    v_sub_f32 v238, v226, v222
    v_sub_f32 v239, v227, v223
    v_exp_f32 v235, v235
    v_exp_f32 v236, v236
    v_exp_f32 v237, v237
    v_exp_f32 v238, v238
    v_exp_f32 v239, v239
    v_mul_f32 v231, v236, v231
    v_mul_f32 v232, v237, v232
    v_mul_f32 v233, v238, v233
    v_mul_f32 v234, v239, v234
L_nl_1_2:
    v_fma_f32 v156, v156, s37, -v220
    v_fma_f32 v157, v157, s37, -v220
    v_mfma_f32_16x16x32_bf16 v[128:131], v[204:207], v[216:219], v[128:131]
    v_fma_f32 v158, v158, s37, -v220
    v_fma_f32 v159, v159, s37, -v220
    v_fma_f32 v160, v160, s37, -v221
    ds_read_b128 v[216:219], v249 offset:27648
    s_waitcnt lgkmcnt(2)
    v_mfma_f32_16x16x32_bf16 v[132:135], v[196:199], v[208:211], v[132:135]
    v_fma_f32 v161, v161, s37, -v221
    v_fma_f32 v162, v162, s37, -v221
    v_mfma_f32_16x16x32_bf16 v[136:139], v[200:203], v[208:211], v[136:139]
    v_fma_f32 v163, v163, s37, -v221
    v_fma_f32 v164, v164, s37, -v222
    v_fma_f32 v165, v165, s37, -v222
    v_mfma_f32_16x16x32_bf16 v[140:143], v[204:207], v[208:211], v[140:143]
    v_fma_f32 v166, v166, s37, -v222
    v_fma_f32 v167, v167, s37, -v222
    v_fma_f32 v168, v168, s37, -v223
    ds_read_b128 v[208:211], v249 offset:29696
    s_waitcnt lgkmcnt(2)
    v_mfma_f32_16x16x32_bf16 v[144:147], v[196:199], v[212:215], v[144:147]
    v_fma_f32 v169, v169, s37, -v223
    v_fma_f32 v170, v170, s37, -v223
    v_fma_f32 v171, v171, s37, -v223
    ds_read_b64_tr_b16 v[196:197], v246 offset:12288
    ds_read_b64_tr_b16 v[198:199], v246 offset:18432
    v_mfma_f32_16x16x32_bf16 v[148:151], v[200:203], v[212:215], v[148:151]
    v_exp_f32 v156, v156
    v_exp_f32 v157, v157
    v_exp_f32 v158, v158
    ds_read_b64_tr_b16 v[200:201], v247 offset:12288
    ds_read_b64_tr_b16 v[202:203], v247 offset:18432
    v_mfma_f32_16x16x32_bf16 v[152:155], v[204:207], v[212:215], v[152:155]
    v_exp_f32 v159, v159
    v_exp_f32 v160, v160
    ds_read_b64_tr_b16 v[204:205], v248 offset:12288
    ds_read_b64_tr_b16 v[206:207], v248 offset:18432
    ds_read_b128 v[212:215], v249 offset:31744
    s_waitcnt lgkmcnt(5)
    v_mfma_f32_16x16x32_bf16 v[96:99], v[196:199], v[216:219], v[96:99]
    v_exp_f32 v161, v161
    v_exp_f32 v162, v162
    v_exp_f32 v163, v163
    s_waitcnt lgkmcnt(3)
    v_mfma_f32_16x16x32_bf16 v[100:103], v[200:203], v[216:219], v[100:103]
    v_exp_f32 v164, v164
    v_exp_f32 v165, v165
    v_exp_f32 v166, v166
    s_waitcnt lgkmcnt(1)
    v_mfma_f32_16x16x32_bf16 v[104:107], v[204:207], v[216:219], v[104:107]
    v_exp_f32 v167, v167
    v_exp_f32 v168, v168
    v_exp_f32 v169, v169
    ds_read_b128 v[216:219], v249 offset:33792
    v_mfma_f32_16x16x32_bf16 v[108:111], v[196:199], v[208:211], v[108:111]
    v_exp_f32 v170, v170
    v_exp_f32 v171, v171
    v_add_f32 v231, v231, v156
    v_mfma_f32_16x16x32_bf16 v[112:115], v[200:203], v[208:211], v[112:115]
    v_add_f32 v252, v157, v158
    v_add_f32 v231, v231, v159
    v_mfma_f32_16x16x32_bf16 v[116:119], v[204:207], v[208:211], v[116:119]
    v_cvt_pk_bf16_f32 v156, v156, v157
    v_add_f32 v231, v231, v252
    v_cvt_pk_bf16_f32 v157, v158, v159
    ds_read_b128 v[208:211], v249 offset:35840
    s_waitcnt lgkmcnt(2)
    v_mfma_f32_16x16x32_bf16 v[120:123], v[196:199], v[212:215], v[120:123]
    ds_write_b64 v250, v[156:157] offset:10240
    v_add_f32 v232, v232, v160
    v_add_f32 v252, v161, v162
    v_mfma_f32_16x16x32_bf16 v[124:127], v[200:203], v[212:215], v[124:127]
    v_add_f32 v232, v232, v163
    v_cvt_pk_bf16_f32 v160, v160, v161
    v_add_f32 v232, v232, v252
    v_mfma_f32_16x16x32_bf16 v[128:131], v[204:207], v[212:215], v[128:131]
    v_cvt_pk_bf16_f32 v161, v162, v163
    ds_write_b64 v250, v[160:161] offset:12288
    v_add_f32 v233, v233, v164
    s_waitcnt lgkmcnt(3)
    v_mfma_f32_16x16x32_bf16 v[132:135], v[196:199], v[216:219], v[132:135]
    v_add_f32 v252, v165, v166
    v_add_f32 v233, v233, v167
    v_mfma_f32_16x16x32_bf16 v[136:139], v[200:203], v[216:219], v[136:139]
    v_cvt_pk_bf16_f32 v164, v164, v165
    v_add_f32 v233, v233, v252
    v_cvt_pk_bf16_f32 v165, v166, v167
    v_mfma_f32_16x16x32_bf16 v[140:143], v[204:207], v[216:219], v[140:143]
    ds_write_b64 v250, v[164:165] offset:14336
    v_add_f32 v234, v234, v168
    v_add_f32 v252, v169, v170
    s_waitcnt lgkmcnt(3)
    v_mfma_f32_16x16x32_bf16 v[144:147], v[196:199], v[208:211], v[144:147]
    v_add_f32 v234, v234, v171
    v_cvt_pk_bf16_f32 v168, v168, v169
    v_add_f32 v234, v234, v252
    v_mfma_f32_16x16x32_bf16 v[148:151], v[200:203], v[208:211], v[148:151]
    v_cvt_pk_bf16_f32 v169, v170, v171
    ds_write_b64 v250, v[168:169] offset:16384
    v_mfma_f32_16x16x32_bf16 v[152:155], v[204:207], v[208:211], v[152:155]
    s_waitcnt vmcnt(6)
    s_waitcnt lgkmcnt(0)
    s_barrier
    ds_read_b128 v[188:191], v244 offset:24576
    ds_read_b128 v[192:195], v245 offset:24576
    ds_read_b128 v[208:211], v244 offset:25600
    ds_read_b128 v[212:215], v245 offset:25600
    ds_read_b128 v[216:219], v244 offset:26624
    s_cmp_eq_u64 s[76:77], 0
    s_cbranch_scc1 L_nr_1_2
    v_mul_f32 v96, v235, v96
    v_mul_f32 v97, v235, v97
    v_mul_f32 v98, v235, v98
    v_mul_f32 v99, v235, v99
    v_mul_f32 v100, v235, v100
    v_mul_f32 v101, v235, v101
    v_mul_f32 v102, v235, v102
    v_mul_f32 v103, v235, v103
    v_mul_f32 v104, v235, v104
    v_mul_f32 v105, v235, v105
    v_mul_f32 v106, v235, v106
    v_mul_f32 v107, v235, v107
    v_mul_f32 v108, v236, v108
    v_mul_f32 v109, v236, v109
    v_mul_f32 v110, v236, v110
    v_mul_f32 v111, v236, v111
    v_mul_f32 v112, v236, v112
    v_mul_f32 v113, v236, v113
    v_mul_f32 v114, v236, v114
    v_mul_f32 v115, v236, v115
    v_mul_f32 v116, v236, v116
    v_mul_f32 v117, v236, v117
    v_mul_f32 v118, v236, v118
    v_mul_f32 v119, v236, v119
    v_mul_f32 v120, v237, v120
    v_mul_f32 v121, v237, v121
    v_mul_f32 v122, v237, v122
    v_mul_f32 v123, v237, v123
    v_mul_f32 v124, v237, v124
    v_mul_f32 v125, v237, v125
    v_mul_f32 v126, v237, v126
    v_mul_f32 v127, v237, v127
    v_mul_f32 v128, v237, v128
    v_mul_f32 v129, v237, v129
    v_mul_f32 v130, v237, v130
    v_mul_f32 v131, v237, v131
    v_mul_f32 v132, v238, v132
    v_mul_f32 v133, v238, v133
    v_mul_f32 v134, v238, v134
    v_mul_f32 v135, v238, v135
    v_mul_f32 v136, v238, v136
    v_mul_f32 v137, v238, v137
    v_mul_f32 v138, v238, v138
    v_mul_f32 v139, v238, v139
    v_mul_f32 v140, v238, v140
    v_mul_f32 v141, v238, v141
    v_mul_f32 v142, v238, v142
    v_mul_f32 v143, v238, v143
    v_mul_f32 v144, v239, v144
    v_mul_f32 v145, v239, v145
    v_mul_f32 v146, v239, v146
    v_mul_f32 v147, v239, v147
    v_mul_f32 v148, v239, v148
    v_mul_f32 v149, v239, v149
    v_mul_f32 v150, v239, v150
    v_mul_f32 v151, v239, v151
    v_mul_f32 v152, v239, v152
    v_mul_f32 v153, v239, v153
    v_mul_f32 v154, v239, v154
    v_mul_f32 v155, v239, v155
L_nr_1_2:
    s_waitcnt lgkmcnt(4)
    v_mfma_f32_16x16x32_bf16 v[156:159], v[188:191], v[0:3], 0
    s_add_u32 s45, s32, 98304
    s_add_u32 m0, s30, 49152
    s_nop 0
    buffer_load_dwordx4 v241, s[12:15], s45 offen nt lds
    v_mfma_f32_16x16x32_bf16 v[160:163], v[188:191], v[24:27], 0
    s_add_u32 m0, s30, 50048
    s_nop 0
    buffer_load_dwordx4 v241, s[12:15], s45 offen offset:128 nt lds
    v_mfma_f32_16x16x32_bf16 v[164:167], v[188:191], v[48:51], 0
    s_add_u32 m0, s30, 50944
    s_nop 0
    buffer_load_dwordx4 v241, s[12:15], s45 offen offset:256 nt lds
    v_mfma_f32_16x16x32_bf16 v[168:171], v[188:191], v[72:75], 0
    ds_read_b128 v[188:191], v245 offset:26624
    s_waitcnt lgkmcnt(4)
    v_mfma_f32_16x16x32_bf16 v[156:159], v[192:195], v[4:7], v[156:159]
    v_mfma_f32_16x16x32_bf16 v[160:163], v[192:195], v[28:31], v[160:163]
    v_mfma_f32_16x16x32_bf16 v[164:167], v[192:195], v[52:55], v[164:167]
    v_mfma_f32_16x16x32_bf16 v[168:171], v[192:195], v[76:79], v[168:171]
    s_waitcnt lgkmcnt(3)
    v_mfma_f32_16x16x32_bf16 v[156:159], v[208:211], v[8:11], v[156:159]
    v_mfma_f32_16x16x32_bf16 v[160:163], v[208:211], v[32:35], v[160:163]
    v_mfma_f32_16x16x32_bf16 v[164:167], v[208:211], v[56:59], v[164:167]
    v_mfma_f32_16x16x32_bf16 v[168:171], v[208:211], v[80:83], v[168:171]
    s_waitcnt lgkmcnt(2)
    v_mfma_f32_16x16x32_bf16 v[156:159], v[212:215], v[12:15], v[156:159]
    v_mfma_f32_16x16x32_bf16 v[160:163], v[212:215], v[36:39], v[160:163]
    v_mfma_f32_16x16x32_bf16 v[164:167], v[212:215], v[60:63], v[164:167]
    v_mfma_f32_16x16x32_bf16 v[168:171], v[212:215], v[84:87], v[168:171]
    s_waitcnt lgkmcnt(1)
    v_mfma_f32_16x16x32_bf16 v[156:159], v[216:219], v[16:19], v[156:159]
    v_mfma_f32_16x16x32_bf16 v[160:163], v[216:219], v[40:43], v[160:163]
    v_mfma_f32_16x16x32_bf16 v[164:167], v[216:219], v[64:67], v[164:167]
    v_mfma_f32_16x16x32_bf16 v[168:171], v[216:219], v[88:91], v[168:171]
    s_waitcnt lgkmcnt(0)
    v_mfma_f32_16x16x32_bf16 v[156:159], v[188:191], v[20:23], v[156:159]
    v_mfma_f32_16x16x32_bf16 v[160:163], v[188:191], v[44:47], v[160:163]
    v_mfma_f32_16x16x32_bf16 v[164:167], v[188:191], v[68:71], v[164:167]
    v_mfma_f32_16x16x32_bf16 v[168:171], v[188:191], v[92:95], v[168:171]
    s_nop 4
    v_max3_f32 v253, v156, v157, v158
    v_max_f32 v253, v253, v159
    ds_max_f32 v251, v253 offset:800
    v_max3_f32 v254, v160, v161, v162
    v_max_f32 v254, v254, v163
    ds_max_f32 v251, v254 offset:804
    v_max3_f32 v253, v164, v165, v166
    v_max_f32 v253, v253, v167
    ds_max_f32 v251, v253 offset:808
    v_max3_f32 v254, v168, v169, v170
    v_max_f32 v254, v254, v171
    ds_max_f32 v251, v254 offset:812
    s_waitcnt lgkmcnt(0)
    s_barrier
    ds_read_b32 v229, v251 offset:796
    ds_read_b128 v[224:227], v251 offset:800
    v_subrev_u32 v246, 49152, v246
    v_subrev_u32 v247, 49152, v247
    v_subrev_u32 v248, 49152, v248
    ds_read_b64_tr_b16 v[196:197], v246
    ds_read_b64_tr_b16 v[198:199], v246 offset:6144
    ds_read_b64_tr_b16 v[200:201], v247
    ds_read_b64_tr_b16 v[202:203], v247 offset:6144
    ds_read_b64_tr_b16 v[204:205], v248
    ds_read_b64_tr_b16 v[206:207], v248 offset:6144
    ds_read_b128 v[208:211], v249 offset:8192
    ds_read_b128 v[212:215], v249 offset:10240
    ds_read_b128 v[216:219], v249 offset:12288
    s_waitcnt lgkmcnt(2)
    v_mfma_f32_16x16x32_bf16 v[96:99], v[196:199], v[208:211], v[96:99]
    v_mul_f32 v229, s37, v229
    v_mul_f32 v224, s37, v224
    v_mul_f32 v225, s37, v225
    s_add_u32 s45, s32, 122880
    s_add_u32 m0, s30, 98304
    s_nop 0
    buffer_load_dwordx4 v241, s[8:11], s45 offen nt lds
    v_mfma_f32_16x16x32_bf16 v[100:103], v[200:203], v[208:211], v[100:103]
    v_mul_f32 v226, s37, v226
    v_mul_f32 v227, s37, v227
    v_sub_f32 v235, v229, v228
    s_add_u32 m0, s30, 99200
    s_nop 0
    buffer_load_dwordx4 v241, s[8:11], s45 offen offset:128 nt lds
    v_mfma_f32_16x16x32_bf16 v[104:107], v[204:207], v[208:211], v[104:107]
    v_sub_f32 v236, v224, v220
    v_sub_f32 v237, v225, v221
    v_sub_f32 v238, v226, v222
    s_add_u32 m0, s30, 100096
    s_nop 0
    buffer_load_dwordx4 v241, s[8:11], s45 offen offset:256 nt lds
    ds_read_b128 v[208:211], v249 offset:14336
    s_waitcnt lgkmcnt(2)
    v_mfma_f32_16x16x32_bf16 v[108:111], v[196:199], v[212:215], v[108:111]
    v_sub_f32 v239, v227, v223
    v_cmp_lt_f32 s[78:79], 4.0, v235
    v_cmp_lt_f32 s[80:81], 4.0, v236
    v_mfma_f32_16x16x32_bf16 v[112:115], v[200:203], v[212:215], v[112:115]
    v_cmp_lt_f32 s[82:83], 4.0, v237
    v_cmp_lt_f32 s[84:85], 4.0, v238
    v_mfma_f32_16x16x32_bf16 v[116:119], v[204:207], v[212:215], v[116:119]
    v_cmp_lt_f32 s[86:87], 4.0, v239
    v_cndmask_b32 v229, v228, v229, s[78:79]
    v_cndmask_b32 v224, v220, v224, s[80:81]
    ds_read_b128 v[212:215], v249 offset:16384
    s_waitcnt lgkmcnt(2)
    v_mfma_f32_16x16x32_bf16 v[120:123], v[196:199], v[216:219], v[120:123]
    v_cndmask_b32 v225, v221, v225, s[82:83]
    v_cndmask_b32 v226, v222, v226, s[84:85]
    v_cndmask_b32 v227, v223, v227, s[86:87]
    v_mfma_f32_16x16x32_bf16 v[124:127], v[200:203], v[216:219], v[124:127]
    s_or_b64 s[76:77], s[78:79], s[80:81]
    s_or_b64 s[82:83], s[82:83], s[84:85]
    s_or_b64 s[76:77], s[76:77], s[86:87]
    s_or_b64 s[76:77], s[76:77], s[82:83]
    s_cbranch_scc0 L_nl_1_3
    v_sub_f32 v235, v228, v229
    v_sub_f32 v236, v220, v224
    v_sub_f32 v237, v221, v225
    v_sub_f32 v238, v222, v226
    v_sub_f32 v239, v223, v227
    v_exp_f32 v235, v235
    v_exp_f32 v236, v236
    v_exp_f32 v237, v237
    v_exp_f32 v238, v238
    v_exp_f32 v239, v239
    v_mul_f32 v231, v236, v231
    v_mul_f32 v232, v237, v232
    v_mul_f32 v233, v238, v233
    v_mul_f32 v234, v239, v234
L_nl_1_3:
    v_fma_f32 v156, v156, s37, -v224
    v_fma_f32 v157, v157, s37, -v224
    v_mfma_f32_16x16x32_bf16 v[128:131], v[204:207], v[216:219], v[128:131]
    v_fma_f32 v158, v158, s37, -v224
    v_fma_f32 v159, v159, s37, -v224
    v_fma_f32 v160, v160, s37, -v225
    ds_read_b128 v[216:219], v249 offset:9216
    s_waitcnt lgkmcnt(2)
    v_mfma_f32_16x16x32_bf16 v[132:135], v[196:199], v[208:211], v[132:135]
    v_fma_f32 v161, v161, s37, -v225
    v_fma_f32 v162, v162, s37, -v225
    v_mfma_f32_16x16x32_bf16 v[136:139], v[200:203], v[208:211], v[136:139]
    v_fma_f32 v163, v163, s37, -v225
    v_fma_f32 v164, v164, s37, -v226
    v_fma_f32 v165, v165, s37, -v226
    v_mfma_f32_16x16x32_bf16 v[140:143], v[204:207], v[208:211], v[140:143]
    v_fma_f32 v166, v166, s37, -v226
    v_fma_f32 v167, v167, s37, -v226
    v_fma_f32 v168, v168, s37, -v227
    ds_read_b128 v[208:211], v249 offset:11264
    s_waitcnt lgkmcnt(2)
    v_mfma_f32_16x16x32_bf16 v[144:147], v[196:199], v[212:215], v[144:147]
    v_fma_f32 v169, v169, s37, -v227
    v_fma_f32 v170, v170, s37, -v227
    v_fma_f32 v171, v171, s37, -v227
    ds_read_b64_tr_b16 v[196:197], v246 offset:12288
    ds_read_b64_tr_b16 v[198:199], v246 offset:18432
    v_mfma_f32_16x16x32_bf16 v[148:151], v[200:203], v[212:215], v[148:151]
    v_exp_f32 v156, v156
    v_exp_f32 v157, v157
    v_exp_f32 v158, v158
    ds_read_b64_tr_b16 v[200:201], v247 offset:12288
    ds_read_b64_tr_b16 v[202:203], v247 offset:18432
    v_mfma_f32_16x16x32_bf16 v[152:155], v[204:207], v[212:215], v[152:155]
    v_exp_f32 v159, v159
    v_exp_f32 v160, v160
    ds_read_b64_tr_b16 v[204:205], v248 offset:12288
    ds_read_b64_tr_b16 v[206:207], v248 offset:18432
    ds_read_b128 v[212:215], v249 offset:13312
    s_waitcnt lgkmcnt(5)
    v_mfma_f32_16x16x32_bf16 v[96:99], v[196:199], v[216:219], v[96:99]
    v_exp_f32 v161, v161
    v_exp_f32 v162, v162
    v_exp_f32 v163, v163
    s_waitcnt lgkmcnt(3)
    v_mfma_f32_16x16x32_bf16 v[100:103], v[200:203], v[216:219], v[100:103]
    v_exp_f32 v164, v164
    v_exp_f32 v165, v165
    v_exp_f32 v166, v166
    s_waitcnt lgkmcnt(1)
    v_mfma_f32_16x16x32_bf16 v[104:107], v[204:207], v[216:219], v[104:107]
    v_exp_f32 v167, v167
    v_exp_f32 v168, v168
    v_exp_f32 v169, v169
    ds_read_b128 v[216:219], v249 offset:15360
    v_mfma_f32_16x16x32_bf16 v[108:111], v[196:199], v[208:211], v[108:111]
    v_exp_f32 v170, v170
    v_exp_f32 v171, v171
    v_add_f32 v231, v231, v156
    v_mfma_f32_16x16x32_bf16 v[112:115], v[200:203], v[208:211], v[112:115]
    v_add_f32 v252, v157, v158
    v_add_f32 v231, v231, v159
    v_mfma_f32_16x16x32_bf16 v[116:119], v[204:207], v[208:211], v[116:119]
    v_cvt_pk_bf16_f32 v156, v156, v157
    v_add_f32 v231, v231, v252
    v_cvt_pk_bf16_f32 v157, v158, v159
    ds_read_b128 v[208:211], v249 offset:17408
    s_waitcnt lgkmcnt(2)
    v_mfma_f32_16x16x32_bf16 v[120:123], v[196:199], v[212:215], v[120:123]
    ds_write_b64 v250, v[156:157] offset:28672
    v_add_f32 v232, v232, v160
    v_add_f32 v252, v161, v162
    v_mfma_f32_16x16x32_bf16 v[124:127], v[200:203], v[212:215], v[124:127]
    v_add_f32 v232, v232, v163
    v_cvt_pk_bf16_f32 v160, v160, v161
    v_add_f32 v232, v232, v252
    v_mfma_f32_16x16x32_bf16 v[128:131], v[204:207], v[212:215], v[128:131]
    v_cvt_pk_bf16_f32 v161, v162, v163
    ds_write_b64 v250, v[160:161] offset:30720
    v_add_f32 v233, v233, v164
    s_waitcnt lgkmcnt(3)
    v_mfma_f32_16x16x32_bf16 v[132:135], v[196:199], v[216:219], v[132:135]
    v_add_f32 v252, v165, v166
    v_add_f32 v233, v233, v167
    v_mfma_f32_16x16x32_bf16 v[136:139], v[200:203], v[216:219], v[136:139]
    v_cvt_pk_bf16_f32 v164, v164, v165
    v_add_f32 v233, v233, v252
    v_cvt_pk_bf16_f32 v165, v166, v167
    v_mfma_f32_16x16x32_bf16 v[140:143], v[204:207], v[216:219], v[140:143]
    ds_write_b64 v250, v[164:165] offset:32768
    v_add_f32 v234, v234, v168
    v_add_f32 v252, v169, v170
    s_waitcnt lgkmcnt(3)
    v_mfma_f32_16x16x32_bf16 v[144:147], v[196:199], v[208:211], v[144:147]
    v_add_f32 v234, v234, v171
    v_cvt_pk_bf16_f32 v168, v168, v169
    v_add_f32 v234, v234, v252
    v_mfma_f32_16x16x32_bf16 v[148:151], v[200:203], v[208:211], v[148:151]
    v_cvt_pk_bf16_f32 v169, v170, v171
    ds_write_b64 v250, v[168:169] offset:34816
    v_mfma_f32_16x16x32_bf16 v[152:155], v[204:207], v[208:211], v[152:155]
    s_waitcnt vmcnt(6)
    s_waitcnt lgkmcnt(0)
    s_barrier
    ds_read_b128 v[188:191], v244
    ds_read_b128 v[192:195], v245
    ds_read_b128 v[208:211], v244 offset:1024
    ds_read_b128 v[212:215], v245 offset:1024
    ds_read_b128 v[216:219], v244 offset:2048
    s_cmp_eq_u64 s[76:77], 0
    s_cbranch_scc1 L_nr_1_3
    v_mul_f32 v96, v235, v96
    v_mul_f32 v97, v235, v97
    v_mul_f32 v98, v235, v98
    v_mul_f32 v99, v235, v99
    v_mul_f32 v100, v235, v100
    v_mul_f32 v101, v235, v101
    v_mul_f32 v102, v235, v102
    v_mul_f32 v103, v235, v103
    v_mul_f32 v104, v235, v104
    v_mul_f32 v105, v235, v105
    v_mul_f32 v106, v235, v106
    v_mul_f32 v107, v235, v107
    v_mul_f32 v108, v236, v108
    v_mul_f32 v109, v236, v109
    v_mul_f32 v110, v236, v110
    v_mul_f32 v111, v236, v111
    v_mul_f32 v112, v236, v112
    v_mul_f32 v113, v236, v113
    v_mul_f32 v114, v236, v114
    v_mul_f32 v115, v236, v115
    v_mul_f32 v116, v236, v116
    v_mul_f32 v117, v236, v117
    v_mul_f32 v118, v236, v118
    v_mul_f32 v119, v236, v119
    v_mul_f32 v120, v237, v120
    v_mul_f32 v121, v237, v121
    v_mul_f32 v122, v237, v122
    v_mul_f32 v123, v237, v123
    v_mul_f32 v124, v237, v124
    v_mul_f32 v125, v237, v125
    v_mul_f32 v126, v237, v126
    v_mul_f32 v127, v237, v127
    v_mul_f32 v128, v237, v128
    v_mul_f32 v129, v237, v129
    v_mul_f32 v130, v237, v130
    v_mul_f32 v131, v237, v131
    v_mul_f32 v132, v238, v132
    v_mul_f32 v133, v238, v133
    v_mul_f32 v134, v238, v134
    v_mul_f32 v135, v238, v135
    v_mul_f32 v136, v238, v136
    v_mul_f32 v137, v238, v137
    v_mul_f32 v138, v238, v138
    v_mul_f32 v139, v238, v139
    v_mul_f32 v140, v238, v140
    v_mul_f32 v141, v238, v141
    v_mul_f32 v142, v238, v142
    v_mul_f32 v143, v238, v143
    v_mul_f32 v144, v239, v144
    v_mul_f32 v145, v239, v145
    v_mul_f32 v146, v239, v146
    v_mul_f32 v147, v239, v147
    v_mul_f32 v148, v239, v148
    v_mul_f32 v149, v239, v149
    v_mul_f32 v150, v239, v150
    v_mul_f32 v151, v239, v151
    v_mul_f32 v152, v239, v152
    v_mul_f32 v153, v239, v153
    v_mul_f32 v154, v239, v154
    v_mul_f32 v155, v239, v155
L_nr_1_3:
    s_waitcnt lgkmcnt(4)
    v_mfma_f32_16x16x32_bf16 v[156:159], v[188:191], v[0:3], 0
    s_add_u32 s45, s32, 122880
    s_add_u32 m0, s30, 0
    s_nop 0
    buffer_load_dwordx4 v241, s[12:15], s45 offen nt lds
    v_mfma_f32_16x16x32_bf16 v[160:163], v[188:191], v[24:27], 0
    s_add_u32 m0, s30, 896
    s_nop 0
    buffer_load_dwordx4 v241, s[12:15], s45 offen offset:128 nt lds
    v_mfma_f32_16x16x32_bf16 v[164:167], v[188:191], v[48:51], 0
    s_add_u32 m0, s30, 1792
    s_nop 0
    buffer_load_dwordx4 v241, s[12:15], s45 offen offset:256 nt lds
    v_mfma_f32_16x16x32_bf16 v[168:171], v[188:191], v[72:75], 0
    ds_read_b128 v[188:191], v245 offset:2048
    s_waitcnt lgkmcnt(4)
    v_mfma_f32_16x16x32_bf16 v[156:159], v[192:195], v[4:7], v[156:159]
    v_mfma_f32_16x16x32_bf16 v[160:163], v[192:195], v[28:31], v[160:163]
    v_mfma_f32_16x16x32_bf16 v[164:167], v[192:195], v[52:55], v[164:167]
    v_mfma_f32_16x16x32_bf16 v[168:171], v[192:195], v[76:79], v[168:171]
    s_waitcnt lgkmcnt(3)
    v_mfma_f32_16x16x32_bf16 v[156:159], v[208:211], v[8:11], v[156:159]
    v_mfma_f32_16x16x32_bf16 v[160:163], v[208:211], v[32:35], v[160:163]
    v_mfma_f32_16x16x32_bf16 v[164:167], v[208:211], v[56:59], v[164:167]
    v_mfma_f32_16x16x32_bf16 v[168:171], v[208:211], v[80:83], v[168:171]
    s_waitcnt lgkmcnt(2)
    v_mfma_f32_16x16x32_bf16 v[156:159], v[212:215], v[12:15], v[156:159]
    v_mfma_f32_16x16x32_bf16 v[160:163], v[212:215], v[36:39], v[160:163]
    v_mfma_f32_16x16x32_bf16 v[164:167], v[212:215], v[60:63], v[164:167]
    v_mfma_f32_16x16x32_bf16 v[168:171], v[212:215], v[84:87], v[168:171]
    s_waitcnt lgkmcnt(1)
    v_mfma_f32_16x16x32_bf16 v[156:159], v[216:219], v[16:19], v[156:159]
    v_mfma_f32_16x16x32_bf16 v[160:163], v[216:219], v[40:43], v[160:163]
    v_mfma_f32_16x16x32_bf16 v[164:167], v[216:219], v[64:67], v[164:167]
    v_mfma_f32_16x16x32_bf16 v[168:171], v[216:219], v[88:91], v[168:171]
    s_waitcnt lgkmcnt(0)
    v_mfma_f32_16x16x32_bf16 v[156:159], v[188:191], v[20:23], v[156:159]
    v_mfma_f32_16x16x32_bf16 v[160:163], v[188:191], v[44:47], v[160:163]
    v_mfma_f32_16x16x32_bf16 v[164:167], v[188:191], v[68:71], v[164:167]
    v_mfma_f32_16x16x32_bf16 v[168:171], v[188:191], v[92:95], v[168:171]
    s_nop 4
    v_max3_f32 v253, v156, v157, v158
    v_max_f32 v253, v253, v159
    ds_max_f32 v251, v253 offset:32
    v_max3_f32 v254, v160, v161, v162
    v_max_f32 v254, v254, v163
    ds_max_f32 v251, v254 offset:36
    v_max3_f32 v253, v164, v165, v166
    v_max_f32 v253, v253, v167
    ds_max_f32 v251, v253 offset:40
    v_max3_f32 v254, v168, v169, v170
    v_max_f32 v254, v254, v171
    ds_max_f32 v251, v254 offset:44
    s_waitcnt lgkmcnt(0)
    s_barrier
    ds_read_b32 v228, v251 offset:28
    ds_read_b128 v[220:223], v251 offset:32
    v_add_u32 v246, 24576, v246
    v_add_u32 v247, 24576, v247
    v_add_u32 v248, 24576, v248
    ds_read_b64_tr_b16 v[196:197], v246
    ds_read_b64_tr_b16 v[198:199], v246 offset:6144
    ds_read_b64_tr_b16 v[200:201], v247
    ds_read_b64_tr_b16 v[202:203], v247 offset:6144
    ds_read_b64_tr_b16 v[204:205], v248
    ds_read_b64_tr_b16 v[206:207], v248 offset:6144
    ds_read_b128 v[208:211], v249 offset:26624
    ds_read_b128 v[212:215], v249 offset:28672
    ds_read_b128 v[216:219], v249 offset:30720
    s_waitcnt lgkmcnt(2)
    v_mfma_f32_16x16x32_bf16 v[96:99], v[196:199], v[208:211], v[96:99]
    v_mul_f32 v228, s37, v228
    v_mul_f32 v220, s37, v220
    v_mul_f32 v221, s37, v221
    s_add_u32 s45, s32, 147456
    s_add_u32 m0, s30, 73728
    s_nop 0
    buffer_load_dwordx4 v241, s[8:11], s45 offen nt lds
    v_mfma_f32_16x16x32_bf16 v[100:103], v[200:203], v[208:211], v[100:103]
    v_mul_f32 v222, s37, v222
    v_mul_f32 v223, s37, v223
    v_sub_f32 v235, v228, v229
    s_add_u32 m0, s30, 74624
    s_nop 0
    buffer_load_dwordx4 v241, s[8:11], s45 offen offset:128 nt lds
    v_mfma_f32_16x16x32_bf16 v[104:107], v[204:207], v[208:211], v[104:107]
    v_sub_f32 v236, v220, v224
    v_sub_f32 v237, v221, v225
    v_sub_f32 v238, v222, v226
    s_add_u32 m0, s30, 75520
    s_nop 0
    buffer_load_dwordx4 v241, s[8:11], s45 offen offset:256 nt lds
    ds_read_b128 v[208:211], v249 offset:32768
    s_waitcnt lgkmcnt(2)
    v_mfma_f32_16x16x32_bf16 v[108:111], v[196:199], v[212:215], v[108:111]
    v_sub_f32 v239, v223, v227
    v_cmp_lt_f32 s[78:79], 4.0, v235
    v_cmp_lt_f32 s[80:81], 4.0, v236
    v_mfma_f32_16x16x32_bf16 v[112:115], v[200:203], v[212:215], v[112:115]
    v_cmp_lt_f32 s[82:83], 4.0, v237
    v_cmp_lt_f32 s[84:85], 4.0, v238
    v_mfma_f32_16x16x32_bf16 v[116:119], v[204:207], v[212:215], v[116:119]
    v_cmp_lt_f32 s[86:87], 4.0, v239
    v_cndmask_b32 v228, v229, v228, s[78:79]
    v_cndmask_b32 v220, v224, v220, s[80:81]
    ds_read_b128 v[212:215], v249 offset:34816
    s_waitcnt lgkmcnt(2)
    v_mfma_f32_16x16x32_bf16 v[120:123], v[196:199], v[216:219], v[120:123]
    v_cndmask_b32 v221, v225, v221, s[82:83]
    v_cndmask_b32 v222, v226, v222, s[84:85]
    v_cndmask_b32 v223, v227, v223, s[86:87]
    v_mfma_f32_16x16x32_bf16 v[124:127], v[200:203], v[216:219], v[124:127]
    s_or_b64 s[76:77], s[78:79], s[80:81]
    s_or_b64 s[82:83], s[82:83], s[84:85]
    s_or_b64 s[76:77], s[76:77], s[86:87]
    s_or_b64 s[76:77], s[76:77], s[82:83]
    s_cbranch_scc0 L_nl_1_4
    v_sub_f32 v235, v229, v228
    v_sub_f32 v236, v224, v220
    v_sub_f32 v237, v225, v221
    v_sub_f32 v238, v226, v222
    v_sub_f32 v239, v227, v223
    v_exp_f32 v235, v235
    v_exp_f32 v236, v236
    v_exp_f32 v237, v237
    v_exp_f32 v238, v238
    v_exp_f32 v239, v239
    v_mul_f32 v231, v236, v231
    v_mul_f32 v232, v237, v232
    v_mul_f32 v233, v238, v233
    v_mul_f32 v234, v239, v234
L_nl_1_4:
    v_fma_f32 v156, v156, s37, -v220
    v_fma_f32 v157, v157, s37, -v220
    v_mfma_f32_16x16x32_bf16 v[128:131], v[204:207], v[216:219], v[128:131]
    v_fma_f32 v158, v158, s37, -v220
    v_fma_f32 v159, v159, s37, -v220
    v_fma_f32 v160, v160, s37, -v221
    ds_read_b128 v[216:219], v249 offset:27648
    s_waitcnt lgkmcnt(2)
    v_mfma_f32_16x16x32_bf16 v[132:135], v[196:199], v[208:211], v[132:135]
    v_fma_f32 v161, v161, s37, -v221
    v_fma_f32 v162, v162, s37, -v221
    v_mfma_f32_16x16x32_bf16 v[136:139], v[200:203], v[208:211], v[136:139]
    v_fma_f32 v163, v163, s37, -v221
    v_fma_f32 v164, v164, s37, -v222
    v_fma_f32 v165, v165, s37, -v222
    v_mfma_f32_16x16x32_bf16 v[140:143], v[204:207], v[208:211], v[140:143]
    v_fma_f32 v166, v166, s37, -v222
    v_fma_f32 v167, v167, s37, -v222
    v_fma_f32 v168, v168, s37, -v223
    ds_read_b128 v[208:211], v249 offset:29696
    s_waitcnt lgkmcnt(2)
    v_mfma_f32_16x16x32_bf16 v[144:147], v[196:199], v[212:215], v[144:147]
    v_fma_f32 v169, v169, s37, -v223
    v_fma_f32 v170, v170, s37, -v223
    v_fma_f32 v171, v171, s37, -v223
    ds_read_b64_tr_b16 v[196:197], v246 offset:12288
    ds_read_b64_tr_b16 v[198:199], v246 offset:18432
    v_mfma_f32_16x16x32_bf16 v[148:151], v[200:203], v[212:215], v[148:151]
    v_exp_f32 v156, v156
    v_exp_f32 v157, v157
    v_exp_f32 v158, v158
    ds_read_b64_tr_b16 v[200:201], v247 offset:12288
    ds_read_b64_tr_b16 v[202:203], v247 offset:18432
    v_mfma_f32_16x16x32_bf16 v[152:155], v[204:207], v[212:215], v[152:155]
    v_exp_f32 v159, v159
    v_exp_f32 v160, v160
    ds_read_b64_tr_b16 v[204:205], v248 offset:12288
    ds_read_b64_tr_b16 v[206:207], v248 offset:18432
    ds_read_b128 v[212:215], v249 offset:31744
    s_waitcnt lgkmcnt(5)
    v_mfma_f32_16x16x32_bf16 v[96:99], v[196:199], v[216:219], v[96:99]
    v_exp_f32 v161, v161
    v_exp_f32 v162, v162
    v_exp_f32 v163, v163
    s_waitcnt lgkmcnt(3)
    v_mfma_f32_16x16x32_bf16 v[100:103], v[200:203], v[216:219], v[100:103]
    v_exp_f32 v164, v164
    v_exp_f32 v165, v165
    v_exp_f32 v166, v166
    s_waitcnt lgkmcnt(1)
    v_mfma_f32_16x16x32_bf16 v[104:107], v[204:207], v[216:219], v[104:107]
    v_exp_f32 v167, v167
    v_exp_f32 v168, v168
    v_exp_f32 v169, v169
    ds_read_b128 v[216:219], v249 offset:33792
    v_mfma_f32_16x16x32_bf16 v[108:111], v[196:199], v[208:211], v[108:111]
    v_exp_f32 v170, v170
    v_exp_f32 v171, v171
    v_add_f32 v231, v231, v156
    v_mfma_f32_16x16x32_bf16 v[112:115], v[200:203], v[208:211], v[112:115]
    v_add_f32 v252, v157, v158
    v_add_f32 v231, v231, v159
    v_mfma_f32_16x16x32_bf16 v[116:119], v[204:207], v[208:211], v[116:119]
    v_cvt_pk_bf16_f32 v156, v156, v157
    v_add_f32 v231, v231, v252
    v_cvt_pk_bf16_f32 v157, v158, v159
    ds_read_b128 v[208:211], v249 offset:35840
    s_waitcnt lgkmcnt(2)
    v_mfma_f32_16x16x32_bf16 v[120:123], v[196:199], v[212:215], v[120:123]
    ds_write_b64 v250, v[156:157] offset:10240
    v_add_f32 v232, v232, v160
    v_add_f32 v252, v161, v162
    v_mfma_f32_16x16x32_bf16 v[124:127], v[200:203], v[212:215], v[124:127]
    v_add_f32 v232, v232, v163
    v_cvt_pk_bf16_f32 v160, v160, v161
    v_add_f32 v232, v232, v252
    v_mfma_f32_16x16x32_bf16 v[128:131], v[204:207], v[212:215], v[128:131]
    v_cvt_pk_bf16_f32 v161, v162, v163
    ds_write_b64 v250, v[160:161] offset:12288
    v_add_f32 v233, v233, v164
    s_waitcnt lgkmcnt(3)
    v_mfma_f32_16x16x32_bf16 v[132:135], v[196:199], v[216:219], v[132:135]
    v_add_f32 v252, v165, v166
    v_add_f32 v233, v233, v167
    v_mfma_f32_16x16x32_bf16 v[136:139], v[200:203], v[216:219], v[136:139]
    v_cvt_pk_bf16_f32 v164, v164, v165
    v_add_f32 v233, v233, v252
    v_cvt_pk_bf16_f32 v165, v166, v167
    v_mfma_f32_16x16x32_bf16 v[140:143], v[204:207], v[216:219], v[140:143]
    ds_write_b64 v250, v[164:165] offset:14336
    v_add_f32 v234, v234, v168
    v_add_f32 v252, v169, v170
    s_waitcnt lgkmcnt(3)
    v_mfma_f32_16x16x32_bf16 v[144:147], v[196:199], v[208:211], v[144:147]
    v_add_f32 v234, v234, v171
    v_cvt_pk_bf16_f32 v168, v168, v169
    v_add_f32 v234, v234, v252
    v_mfma_f32_16x16x32_bf16 v[148:151], v[200:203], v[208:211], v[148:151]
    v_cvt_pk_bf16_f32 v169, v170, v171
    ds_write_b64 v250, v[168:169] offset:16384
    v_mfma_f32_16x16x32_bf16 v[152:155], v[204:207], v[208:211], v[152:155]
    s_waitcnt vmcnt(6)
    s_waitcnt lgkmcnt(0)
    s_barrier
    ds_read_b128 v[188:191], v244 offset:24576
    ds_read_b128 v[192:195], v245 offset:24576
    ds_read_b128 v[208:211], v244 offset:25600
    ds_read_b128 v[212:215], v245 offset:25600
    ds_read_b128 v[216:219], v244 offset:26624
    s_cmp_eq_u64 s[76:77], 0
    s_cbranch_scc1 L_nr_1_4
    v_mul_f32 v96, v235, v96
    v_mul_f32 v97, v235, v97
    v_mul_f32 v98, v235, v98
    v_mul_f32 v99, v235, v99
    v_mul_f32 v100, v235, v100
    v_mul_f32 v101, v235, v101
    v_mul_f32 v102, v235, v102
    v_mul_f32 v103, v235, v103
    v_mul_f32 v104, v235, v104
    v_mul_f32 v105, v235, v105
    v_mul_f32 v106, v235, v106
    v_mul_f32 v107, v235, v107
    v_mul_f32 v108, v236, v108
    v_mul_f32 v109, v236, v109
    v_mul_f32 v110, v236, v110
    v_mul_f32 v111, v236, v111
    v_mul_f32 v112, v236, v112
    v_mul_f32 v113, v236, v113
    v_mul_f32 v114, v236, v114
    v_mul_f32 v115, v236, v115
    v_mul_f32 v116, v236, v116
    v_mul_f32 v117, v236, v117
    v_mul_f32 v118, v236, v118
    v_mul_f32 v119, v236, v119
    v_mul_f32 v120, v237, v120
    v_mul_f32 v121, v237, v121
    v_mul_f32 v122, v237, v122
    v_mul_f32 v123, v237, v123
    v_mul_f32 v124, v237, v124
    v_mul_f32 v125, v237, v125
    v_mul_f32 v126, v237, v126
    v_mul_f32 v127, v237, v127
    v_mul_f32 v128, v237, v128
    v_mul_f32 v129, v237, v129
    v_mul_f32 v130, v237, v130
    v_mul_f32 v131, v237, v131
    v_mul_f32 v132, v238, v132
    v_mul_f32 v133, v238, v133
    v_mul_f32 v134, v238, v134
    v_mul_f32 v135, v238, v135
    v_mul_f32 v136, v238, v136
    v_mul_f32 v137, v238, v137
    v_mul_f32 v138, v238, v138
    v_mul_f32 v139, v238, v139
    v_mul_f32 v140, v238, v140
    v_mul_f32 v141, v238, v141
    v_mul_f32 v142, v238, v142
    v_mul_f32 v143, v238, v143
    v_mul_f32 v144, v239, v144
    v_mul_f32 v145, v239, v145
    v_mul_f32 v146, v239, v146
    v_mul_f32 v147, v239, v147
    v_mul_f32 v148, v239, v148
    v_mul_f32 v149, v239, v149
    v_mul_f32 v150, v239, v150
    v_mul_f32 v151, v239, v151
    v_mul_f32 v152, v239, v152
    v_mul_f32 v153, v239, v153
    v_mul_f32 v154, v239, v154
    v_mul_f32 v155, v239, v155
L_nr_1_4:
    s_waitcnt lgkmcnt(4)
    v_mfma_f32_16x16x32_bf16 v[156:159], v[188:191], v[0:3], 0
    s_add_u32 s45, s32, 147456
    s_add_u32 m0, s30, 24576
    s_nop 0
    buffer_load_dwordx4 v241, s[12:15], s45 offen nt lds
    v_mfma_f32_16x16x32_bf16 v[160:163], v[188:191], v[24:27], 0
    s_add_u32 m0, s30, 25472
    s_nop 0
    buffer_load_dwordx4 v241, s[12:15], s45 offen offset:128 nt lds
    v_mfma_f32_16x16x32_bf16 v[164:167], v[188:191], v[48:51], 0
    s_add_u32 m0, s30, 26368
    s_nop 0
    buffer_load_dwordx4 v241, s[12:15], s45 offen offset:256 nt lds
    v_mfma_f32_16x16x32_bf16 v[168:171], v[188:191], v[72:75], 0
    ds_read_b128 v[188:191], v245 offset:26624
    s_waitcnt lgkmcnt(4)
    v_mfma_f32_16x16x32_bf16 v[156:159], v[192:195], v[4:7], v[156:159]
    v_mfma_f32_16x16x32_bf16 v[160:163], v[192:195], v[28:31], v[160:163]
    v_mfma_f32_16x16x32_bf16 v[164:167], v[192:195], v[52:55], v[164:167]
    v_mfma_f32_16x16x32_bf16 v[168:171], v[192:195], v[76:79], v[168:171]
    s_waitcnt lgkmcnt(3)
    v_mfma_f32_16x16x32_bf16 v[156:159], v[208:211], v[8:11], v[156:159]
    v_mfma_f32_16x16x32_bf16 v[160:163], v[208:211], v[32:35], v[160:163]
    v_mfma_f32_16x16x32_bf16 v[164:167], v[208:211], v[56:59], v[164:167]
    v_mfma_f32_16x16x32_bf16 v[168:171], v[208:211], v[80:83], v[168:171]
    s_waitcnt lgkmcnt(2)
    v_mfma_f32_16x16x32_bf16 v[156:159], v[212:215], v[12:15], v[156:159]
    v_mfma_f32_16x16x32_bf16 v[160:163], v[212:215], v[36:39], v[160:163]
    v_mfma_f32_16x16x32_bf16 v[164:167], v[212:215], v[60:63], v[164:167]
    v_mfma_f32_16x16x32_bf16 v[168:171], v[212:215], v[84:87], v[168:171]
    s_waitcnt lgkmcnt(1)
    v_mfma_f32_16x16x32_bf16 v[156:159], v[216:219], v[16:19], v[156:159]
    v_mfma_f32_16x16x32_bf16 v[160:163], v[216:219], v[40:43], v[160:163]
    v_mfma_f32_16x16x32_bf16 v[164:167], v[216:219], v[64:67], v[164:167]
    v_mfma_f32_16x16x32_bf16 v[168:171], v[216:219], v[88:91], v[168:171]
    s_waitcnt lgkmcnt(0)
    v_mfma_f32_16x16x32_bf16 v[156:159], v[188:191], v[20:23], v[156:159]
    v_mfma_f32_16x16x32_bf16 v[160:163], v[188:191], v[44:47], v[160:163]
    v_mfma_f32_16x16x32_bf16 v[164:167], v[188:191], v[68:71], v[164:167]
    v_mfma_f32_16x16x32_bf16 v[168:171], v[188:191], v[92:95], v[168:171]
    s_nop 4
    v_max3_f32 v253, v156, v157, v158
    v_max_f32 v253, v253, v159
    ds_max_f32 v251, v253 offset:800
    v_max3_f32 v254, v160, v161, v162
    v_max_f32 v254, v254, v163
    ds_max_f32 v251, v254 offset:804
    v_max3_f32 v253, v164, v165, v166
    v_max_f32 v253, v253, v167
    ds_max_f32 v251, v253 offset:808
    v_max3_f32 v254, v168, v169, v170
    v_max_f32 v254, v254, v171
    ds_max_f32 v251, v254 offset:812
    s_waitcnt lgkmcnt(0)
    s_barrier
    ds_read_b32 v229, v251 offset:796
    ds_read_b128 v[224:227], v251 offset:800
    v_add_u32 v246, 24576, v246
    v_add_u32 v247, 24576, v247
    v_add_u32 v248, 24576, v248
    ds_read_b64_tr_b16 v[196:197], v246
    ds_read_b64_tr_b16 v[198:199], v246 offset:6144
    ds_read_b64_tr_b16 v[200:201], v247
    ds_read_b64_tr_b16 v[202:203], v247 offset:6144
    ds_read_b64_tr_b16 v[204:205], v248
    ds_read_b64_tr_b16 v[206:207], v248 offset:6144
    ds_read_b128 v[208:211], v249 offset:8192
    ds_read_b128 v[212:215], v249 offset:10240
    ds_read_b128 v[216:219], v249 offset:12288
    s_waitcnt lgkmcnt(2)
    v_mfma_f32_16x16x32_bf16 v[96:99], v[196:199], v[208:211], v[96:99]
    v_mul_f32 v229, s37, v229
    v_mul_f32 v224, s37, v224
    v_mul_f32 v225, s37, v225
    s_add_u32 s45, s32, 172032
    s_add_u32 m0, s30, 98304
    s_nop 0
    buffer_load_dwordx4 v241, s[8:11], s45 offen nt lds
    v_mfma_f32_16x16x32_bf16 v[100:103], v[200:203], v[208:211], v[100:103]
    v_mul_f32 v226, s37, v226
    v_mul_f32 v227, s37, v227
    v_sub_f32 v235, v229, v228
    s_add_u32 m0, s30, 99200
    s_nop 0
    buffer_load_dwordx4 v241, s[8:11], s45 offen offset:128 nt lds
    v_mfma_f32_16x16x32_bf16 v[104:107], v[204:207], v[208:211], v[104:107]
    v_sub_f32 v236, v224, v220
    v_sub_f32 v237, v225, v221
    v_sub_f32 v238, v226, v222
    s_add_u32 m0, s30, 100096
    s_nop 0
    buffer_load_dwordx4 v241, s[8:11], s45 offen offset:256 nt lds
    ds_read_b128 v[208:211], v249 offset:14336
    s_waitcnt lgkmcnt(2)
    v_mfma_f32_16x16x32_bf16 v[108:111], v[196:199], v[212:215], v[108:111]
    v_sub_f32 v239, v227, v223
    v_cmp_lt_f32 s[78:79], 4.0, v235
    v_cmp_lt_f32 s[80:81], 4.0, v236
    v_mfma_f32_16x16x32_bf16 v[112:115], v[200:203], v[212:215], v[112:115]
    v_cmp_lt_f32 s[82:83], 4.0, v237
    v_cmp_lt_f32 s[84:85], 4.0, v238
    v_mfma_f32_16x16x32_bf16 v[116:119], v[204:207], v[212:215], v[116:119]
    v_cmp_lt_f32 s[86:87], 4.0, v239
    v_cndmask_b32 v229, v228, v229, s[78:79]
    v_cndmask_b32 v224, v220, v224, s[80:81]
    ds_read_b128 v[212:215], v249 offset:16384
    s_waitcnt lgkmcnt(2)
    v_mfma_f32_16x16x32_bf16 v[120:123], v[196:199], v[216:219], v[120:123]
    v_cndmask_b32 v225, v221, v225, s[82:83]
    v_cndmask_b32 v226, v222, v226, s[84:85]
    v_cndmask_b32 v227, v223, v227, s[86:87]
    v_mfma_f32_16x16x32_bf16 v[124:127], v[200:203], v[216:219], v[124:127]
    s_or_b64 s[76:77], s[78:79], s[80:81]
    s_or_b64 s[82:83], s[82:83], s[84:85]
    s_or_b64 s[76:77], s[76:77], s[86:87]
    s_or_b64 s[76:77], s[76:77], s[82:83]
    s_cbranch_scc0 L_nl_1_5
    v_sub_f32 v235, v228, v229
    v_sub_f32 v236, v220, v224
    v_sub_f32 v237, v221, v225
    v_sub_f32 v238, v222, v226
    v_sub_f32 v239, v223, v227
    v_exp_f32 v235, v235
    v_exp_f32 v236, v236
    v_exp_f32 v237, v237
    v_exp_f32 v238, v238
    v_exp_f32 v239, v239
    v_mul_f32 v231, v236, v231
    v_mul_f32 v232, v237, v232
    v_mul_f32 v233, v238, v233
    v_mul_f32 v234, v239, v234
L_nl_1_5:
    v_fma_f32 v156, v156, s37, -v224
    v_fma_f32 v157, v157, s37, -v224
    v_mfma_f32_16x16x32_bf16 v[128:131], v[204:207], v[216:219], v[128:131]
    v_fma_f32 v158, v158, s37, -v224
    v_fma_f32 v159, v159, s37, -v224
    v_fma_f32 v160, v160, s37, -v225
    ds_read_b128 v[216:219], v249 offset:9216
    s_waitcnt lgkmcnt(2)
    v_mfma_f32_16x16x32_bf16 v[132:135], v[196:199], v[208:211], v[132:135]
    v_fma_f32 v161, v161, s37, -v225
    v_fma_f32 v162, v162, s37, -v225
    v_mfma_f32_16x16x32_bf16 v[136:139], v[200:203], v[208:211], v[136:139]
    v_fma_f32 v163, v163, s37, -v225
    v_fma_f32 v164, v164, s37, -v226
    v_fma_f32 v165, v165, s37, -v226
    v_mfma_f32_16x16x32_bf16 v[140:143], v[204:207], v[208:211], v[140:143]
    v_fma_f32 v166, v166, s37, -v226
    v_fma_f32 v167, v167, s37, -v226
    v_fma_f32 v168, v168, s37, -v227
    ds_read_b128 v[208:211], v249 offset:11264
    s_waitcnt lgkmcnt(2)
    v_mfma_f32_16x16x32_bf16 v[144:147], v[196:199], v[212:215], v[144:147]
    v_fma_f32 v169, v169, s37, -v227
    v_fma_f32 v170, v170, s37, -v227
    v_fma_f32 v171, v171, s37, -v227
    ds_read_b64_tr_b16 v[196:197], v246 offset:12288
    ds_read_b64_tr_b16 v[198:199], v246 offset:18432
    v_mfma_f32_16x16x32_bf16 v[148:151], v[200:203], v[212:215], v[148:151]
    v_exp_f32 v156, v156
    v_exp_f32 v157, v157
    v_exp_f32 v158, v158
    ds_read_b64_tr_b16 v[200:201], v247 offset:12288
    ds_read_b64_tr_b16 v[202:203], v247 offset:18432
    v_mfma_f32_16x16x32_bf16 v[152:155], v[204:207], v[212:215], v[152:155]
    v_exp_f32 v159, v159
    v_exp_f32 v160, v160
    ds_read_b64_tr_b16 v[204:205], v248 offset:12288
    ds_read_b64_tr_b16 v[206:207], v248 offset:18432
    ds_read_b128 v[212:215], v249 offset:13312
    s_waitcnt lgkmcnt(5)
    v_mfma_f32_16x16x32_bf16 v[96:99], v[196:199], v[216:219], v[96:99]
    v_exp_f32 v161, v161
    v_exp_f32 v162, v162
    v_exp_f32 v163, v163
    s_waitcnt lgkmcnt(3)
    v_mfma_f32_16x16x32_bf16 v[100:103], v[200:203], v[216:219], v[100:103]
    v_exp_f32 v164, v164
    v_exp_f32 v165, v165
    v_exp_f32 v166, v166
    s_waitcnt lgkmcnt(1)
    v_mfma_f32_16x16x32_bf16 v[104:107], v[204:207], v[216:219], v[104:107]
    v_exp_f32 v167, v167
    v_exp_f32 v168, v168
    v_exp_f32 v169, v169
    ds_read_b128 v[216:219], v249 offset:15360
    v_mfma_f32_16x16x32_bf16 v[108:111], v[196:199], v[208:211], v[108:111]
    v_exp_f32 v170, v170
    v_exp_f32 v171, v171
    v_add_f32 v231, v231, v156
    v_mfma_f32_16x16x32_bf16 v[112:115], v[200:203], v[208:211], v[112:115]
    v_add_f32 v252, v157, v158
    v_add_f32 v231, v231, v159
    v_mfma_f32_16x16x32_bf16 v[116:119], v[204:207], v[208:211], v[116:119]
    v_cvt_pk_bf16_f32 v156, v156, v157
    v_add_f32 v231, v231, v252
    v_cvt_pk_bf16_f32 v157, v158, v159
    ds_read_b128 v[208:211], v249 offset:17408
    s_waitcnt lgkmcnt(2)
    v_mfma_f32_16x16x32_bf16 v[120:123], v[196:199], v[212:215], v[120:123]
    ds_write_b64 v250, v[156:157] offset:28672
    v_add_f32 v232, v232, v160
    v_add_f32 v252, v161, v162
    v_mfma_f32_16x16x32_bf16 v[124:127], v[200:203], v[212:215], v[124:127]
    v_add_f32 v232, v232, v163
    v_cvt_pk_bf16_f32 v160, v160, v161
    v_add_f32 v232, v232, v252
    v_mfma_f32_16x16x32_bf16 v[128:131], v[204:207], v[212:215], v[128:131]
    v_cvt_pk_bf16_f32 v161, v162, v163
    ds_write_b64 v250, v[160:161] offset:30720
    v_add_f32 v233, v233, v164
    s_waitcnt lgkmcnt(3)
    v_mfma_f32_16x16x32_bf16 v[132:135], v[196:199], v[216:219], v[132:135]
    v_add_f32 v252, v165, v166
    v_add_f32 v233, v233, v167
    v_mfma_f32_16x16x32_bf16 v[136:139], v[200:203], v[216:219], v[136:139]
    v_cvt_pk_bf16_f32 v164, v164, v165
    v_add_f32 v233, v233, v252
    v_cvt_pk_bf16_f32 v165, v166, v167
    v_mfma_f32_16x16x32_bf16 v[140:143], v[204:207], v[216:219], v[140:143]
    ds_write_b64 v250, v[164:165] offset:32768
    v_add_f32 v234, v234, v168
    v_add_f32 v252, v169, v170
    s_waitcnt lgkmcnt(3)
    v_mfma_f32_16x16x32_bf16 v[144:147], v[196:199], v[208:211], v[144:147]
    v_add_f32 v234, v234, v171
    v_cvt_pk_bf16_f32 v168, v168, v169
    v_add_f32 v234, v234, v252
    v_mfma_f32_16x16x32_bf16 v[148:151], v[200:203], v[208:211], v[148:151]
    v_cvt_pk_bf16_f32 v169, v170, v171
    ds_write_b64 v250, v[168:169] offset:34816
    v_mfma_f32_16x16x32_bf16 v[152:155], v[204:207], v[208:211], v[152:155]
    s_waitcnt vmcnt(6)
    s_waitcnt lgkmcnt(0)
    s_barrier
    ds_read_b128 v[188:191], v244
    ds_read_b128 v[192:195], v245
    ds_read_b128 v[208:211], v244 offset:1024
    ds_read_b128 v[212:215], v245 offset:1024
    ds_read_b128 v[216:219], v244 offset:2048
    s_cmp_eq_u64 s[76:77], 0
    s_cbranch_scc1 L_nr_1_5
    v_mul_f32 v96, v235, v96
    v_mul_f32 v97, v235, v97
    v_mul_f32 v98, v235, v98
    v_mul_f32 v99, v235, v99
    v_mul_f32 v100, v235, v100
    v_mul_f32 v101, v235, v101
    v_mul_f32 v102, v235, v102
    v_mul_f32 v103, v235, v103
    v_mul_f32 v104, v235, v104
    v_mul_f32 v105, v235, v105
    v_mul_f32 v106, v235, v106
    v_mul_f32 v107, v235, v107
    v_mul_f32 v108, v236, v108
    v_mul_f32 v109, v236, v109
    v_mul_f32 v110, v236, v110
    v_mul_f32 v111, v236, v111
    v_mul_f32 v112, v236, v112
    v_mul_f32 v113, v236, v113
    v_mul_f32 v114, v236, v114
    v_mul_f32 v115, v236, v115
    v_mul_f32 v116, v236, v116
    v_mul_f32 v117, v236, v117
    v_mul_f32 v118, v236, v118
    v_mul_f32 v119, v236, v119
    v_mul_f32 v120, v237, v120
    v_mul_f32 v121, v237, v121
    v_mul_f32 v122, v237, v122
    v_mul_f32 v123, v237, v123
    v_mul_f32 v124, v237, v124
    v_mul_f32 v125, v237, v125
    v_mul_f32 v126, v237, v126
    v_mul_f32 v127, v237, v127
    v_mul_f32 v128, v237, v128
    v_mul_f32 v129, v237, v129
    v_mul_f32 v130, v237, v130
    v_mul_f32 v131, v237, v131
    v_mul_f32 v132, v238, v132
    v_mul_f32 v133, v238, v133
    v_mul_f32 v134, v238, v134
    v_mul_f32 v135, v238, v135
    v_mul_f32 v136, v238, v136
    v_mul_f32 v137, v238, v137
    v_mul_f32 v138, v238, v138
    v_mul_f32 v139, v238, v139
    v_mul_f32 v140, v238, v140
    v_mul_f32 v141, v238, v141
    v_mul_f32 v142, v238, v142
    v_mul_f32 v143, v238, v143
    v_mul_f32 v144, v239, v144
    v_mul_f32 v145, v239, v145
    v_mul_f32 v146, v239, v146
    v_mul_f32 v147, v239, v147
    v_mul_f32 v148, v239, v148
    v_mul_f32 v149, v239, v149
    v_mul_f32 v150, v239, v150
    v_mul_f32 v151, v239, v151
    v_mul_f32 v152, v239, v152
    v_mul_f32 v153, v239, v153
    v_mul_f32 v154, v239, v154
    v_mul_f32 v155, v239, v155
L_nr_1_5:
    s_waitcnt lgkmcnt(4)
    v_mfma_f32_16x16x32_bf16 v[156:159], v[188:191], v[0:3], 0
    s_add_u32 s45, s32, 172032
    s_add_u32 m0, s30, 49152
    s_nop 0
    buffer_load_dwordx4 v241, s[12:15], s45 offen nt lds
    v_mfma_f32_16x16x32_bf16 v[160:163], v[188:191], v[24:27], 0
    s_add_u32 m0, s30, 50048
    s_nop 0
    buffer_load_dwordx4 v241, s[12:15], s45 offen offset:128 nt lds
    v_mfma_f32_16x16x32_bf16 v[164:167], v[188:191], v[48:51], 0
    s_add_u32 m0, s30, 50944
    s_nop 0
    buffer_load_dwordx4 v241, s[12:15], s45 offen offset:256 nt lds
    v_mfma_f32_16x16x32_bf16 v[168:171], v[188:191], v[72:75], 0
    ds_read_b128 v[188:191], v245 offset:2048
    s_waitcnt lgkmcnt(4)
    v_mfma_f32_16x16x32_bf16 v[156:159], v[192:195], v[4:7], v[156:159]
    v_mfma_f32_16x16x32_bf16 v[160:163], v[192:195], v[28:31], v[160:163]
    v_mfma_f32_16x16x32_bf16 v[164:167], v[192:195], v[52:55], v[164:167]
    v_mfma_f32_16x16x32_bf16 v[168:171], v[192:195], v[76:79], v[168:171]
    s_waitcnt lgkmcnt(3)
    v_mfma_f32_16x16x32_bf16 v[156:159], v[208:211], v[8:11], v[156:159]
    v_mfma_f32_16x16x32_bf16 v[160:163], v[208:211], v[32:35], v[160:163]
    v_mfma_f32_16x16x32_bf16 v[164:167], v[208:211], v[56:59], v[164:167]
    v_mfma_f32_16x16x32_bf16 v[168:171], v[208:211], v[80:83], v[168:171]
    s_waitcnt lgkmcnt(2)
    v_mfma_f32_16x16x32_bf16 v[156:159], v[212:215], v[12:15], v[156:159]
    v_mfma_f32_16x16x32_bf16 v[160:163], v[212:215], v[36:39], v[160:163]
    v_mfma_f32_16x16x32_bf16 v[164:167], v[212:215], v[60:63], v[164:167]
    v_mfma_f32_16x16x32_bf16 v[168:171], v[212:215], v[84:87], v[168:171]
    s_waitcnt lgkmcnt(1)
    v_mfma_f32_16x16x32_bf16 v[156:159], v[216:219], v[16:19], v[156:159]
    v_mfma_f32_16x16x32_bf16 v[160:163], v[216:219], v[40:43], v[160:163]
    v_mfma_f32_16x16x32_bf16 v[164:167], v[216:219], v[64:67], v[164:167]
    v_mfma_f32_16x16x32_bf16 v[168:171], v[216:219], v[88:91], v[168:171]
    s_waitcnt lgkmcnt(0)
    v_mfma_f32_16x16x32_bf16 v[156:159], v[188:191], v[20:23], v[156:159]
    v_mfma_f32_16x16x32_bf16 v[160:163], v[188:191], v[44:47], v[160:163]
    v_mfma_f32_16x16x32_bf16 v[164:167], v[188:191], v[68:71], v[164:167]
    v_mfma_f32_16x16x32_bf16 v[168:171], v[188:191], v[92:95], v[168:171]
    s_nop 4
    v_max3_f32 v253, v156, v157, v158
    v_max_f32 v253, v253, v159
    ds_max_f32 v251, v253 offset:32
    v_max3_f32 v254, v160, v161, v162
    v_max_f32 v254, v254, v163
    ds_max_f32 v251, v254 offset:36
    v_max3_f32 v253, v164, v165, v166
    v_max_f32 v253, v253, v167
    ds_max_f32 v251, v253 offset:40
    v_max3_f32 v254, v168, v169, v170
    v_max_f32 v254, v254, v171
    ds_max_f32 v251, v254 offset:44
    s_waitcnt lgkmcnt(0)
    s_barrier
    ds_read_b32 v228, v251 offset:28
    ds_read_b128 v[220:223], v251 offset:32
    v_subrev_u32 v246, 49152, v246
    v_subrev_u32 v247, 49152, v247
    v_subrev_u32 v248, 49152, v248
    ds_read_b64_tr_b16 v[196:197], v246
    ds_read_b64_tr_b16 v[198:199], v246 offset:6144
    ds_read_b64_tr_b16 v[200:201], v247
    ds_read_b64_tr_b16 v[202:203], v247 offset:6144
    ds_read_b64_tr_b16 v[204:205], v248
    ds_read_b64_tr_b16 v[206:207], v248 offset:6144
    ds_read_b128 v[208:211], v249 offset:26624
    ds_read_b128 v[212:215], v249 offset:28672
    ds_read_b128 v[216:219], v249 offset:30720
    s_waitcnt lgkmcnt(2)
    v_mfma_f32_16x16x32_bf16 v[96:99], v[196:199], v[208:211], v[96:99]
    v_mul_f32 v228, s37, v228
    v_mul_f32 v220, s37, v220
    v_mul_f32 v221, s37, v221
    v_mfma_f32_16x16x32_bf16 v[100:103], v[200:203], v[208:211], v[100:103]
    v_mul_f32 v222, s37, v222
    v_mul_f32 v223, s37, v223
    v_sub_f32 v235, v228, v229
    v_mfma_f32_16x16x32_bf16 v[104:107], v[204:207], v[208:211], v[104:107]
    v_sub_f32 v236, v220, v224
    v_sub_f32 v237, v221, v225
    v_sub_f32 v238, v222, v226
    ds_read_b128 v[208:211], v249 offset:32768
    s_waitcnt lgkmcnt(2)
    v_mfma_f32_16x16x32_bf16 v[108:111], v[196:199], v[212:215], v[108:111]
    v_sub_f32 v239, v223, v227
    v_cmp_lt_f32 s[78:79], 4.0, v235
    v_cmp_lt_f32 s[80:81], 4.0, v236
    v_mfma_f32_16x16x32_bf16 v[112:115], v[200:203], v[212:215], v[112:115]
    v_cmp_lt_f32 s[82:83], 4.0, v237
    v_cmp_lt_f32 s[84:85], 4.0, v238
    v_mfma_f32_16x16x32_bf16 v[116:119], v[204:207], v[212:215], v[116:119]
    v_cmp_lt_f32 s[86:87], 4.0, v239
    v_cndmask_b32 v228, v229, v228, s[78:79]
    v_cndmask_b32 v220, v224, v220, s[80:81]
    ds_read_b128 v[212:215], v249 offset:34816
    s_waitcnt lgkmcnt(2)
    v_mfma_f32_16x16x32_bf16 v[120:123], v[196:199], v[216:219], v[120:123]
    v_cndmask_b32 v221, v225, v221, s[82:83]
    v_cndmask_b32 v222, v226, v222, s[84:85]
    v_cndmask_b32 v223, v227, v223, s[86:87]
    v_mfma_f32_16x16x32_bf16 v[124:127], v[200:203], v[216:219], v[124:127]
    s_or_b64 s[76:77], s[78:79], s[80:81]
    s_or_b64 s[82:83], s[82:83], s[84:85]
    s_or_b64 s[76:77], s[76:77], s[86:87]
    s_or_b64 s[76:77], s[76:77], s[82:83]
    s_cbranch_scc0 L_nl_1_6
    v_sub_f32 v235, v229, v228
    v_sub_f32 v236, v224, v220
    v_sub_f32 v237, v225, v221
    v_sub_f32 v238, v226, v222
    v_sub_f32 v239, v227, v223
    v_exp_f32 v235, v235
    v_exp_f32 v236, v236
    v_exp_f32 v237, v237
    v_exp_f32 v238, v238
    v_exp_f32 v239, v239
    v_mul_f32 v231, v236, v231
    v_mul_f32 v232, v237, v232
    v_mul_f32 v233, v238, v233
    v_mul_f32 v234, v239, v234
L_nl_1_6:
    v_fma_f32 v156, v156, s37, -v220
    v_fma_f32 v157, v157, s37, -v220
    v_mfma_f32_16x16x32_bf16 v[128:131], v[204:207], v[216:219], v[128:131]
    v_fma_f32 v158, v158, s37, -v220
    v_fma_f32 v159, v159, s37, -v220
    v_fma_f32 v160, v160, s37, -v221
    ds_read_b128 v[216:219], v249 offset:27648
    s_waitcnt lgkmcnt(2)
    v_mfma_f32_16x16x32_bf16 v[132:135], v[196:199], v[208:211], v[132:135]
    v_fma_f32 v161, v161, s37, -v221
    v_fma_f32 v162, v162, s37, -v221
    v_mfma_f32_16x16x32_bf16 v[136:139], v[200:203], v[208:211], v[136:139]
    v_fma_f32 v163, v163, s37, -v221
    v_fma_f32 v164, v164, s37, -v222
    v_fma_f32 v165, v165, s37, -v222
    v_mfma_f32_16x16x32_bf16 v[140:143], v[204:207], v[208:211], v[140:143]
    v_fma_f32 v166, v166, s37, -v222
    v_fma_f32 v167, v167, s37, -v222
    v_fma_f32 v168, v168, s37, -v223
    ds_read_b128 v[208:211], v249 offset:29696
    s_waitcnt lgkmcnt(2)
    v_mfma_f32_16x16x32_bf16 v[144:147], v[196:199], v[212:215], v[144:147]
    v_fma_f32 v169, v169, s37, -v223
    v_fma_f32 v170, v170, s37, -v223
    v_fma_f32 v171, v171, s37, -v223
    ds_read_b64_tr_b16 v[196:197], v246 offset:12288
    ds_read_b64_tr_b16 v[198:199], v246 offset:18432
    v_mfma_f32_16x16x32_bf16 v[148:151], v[200:203], v[212:215], v[148:151]
    v_exp_f32 v156, v156
    v_exp_f32 v157, v157
    v_exp_f32 v158, v158
    ds_read_b64_tr_b16 v[200:201], v247 offset:12288
    ds_read_b64_tr_b16 v[202:203], v247 offset:18432
    v_mfma_f32_16x16x32_bf16 v[152:155], v[204:207], v[212:215], v[152:155]
    v_exp_f32 v159, v159
    v_exp_f32 v160, v160
    ds_read_b64_tr_b16 v[204:205], v248 offset:12288
    ds_read_b64_tr_b16 v[206:207], v248 offset:18432
    ds_read_b128 v[212:215], v249 offset:31744
    s_waitcnt lgkmcnt(5)
    v_mfma_f32_16x16x32_bf16 v[96:99], v[196:199], v[216:219], v[96:99]
    v_exp_f32 v161, v161
    v_exp_f32 v162, v162
    v_exp_f32 v163, v163
    s_waitcnt lgkmcnt(3)
    v_mfma_f32_16x16x32_bf16 v[100:103], v[200:203], v[216:219], v[100:103]
    v_exp_f32 v164, v164
    v_exp_f32 v165, v165
    v_exp_f32 v166, v166
    s_waitcnt lgkmcnt(1)
    v_mfma_f32_16x16x32_bf16 v[104:107], v[204:207], v[216:219], v[104:107]
    v_exp_f32 v167, v167
    v_exp_f32 v168, v168
    v_exp_f32 v169, v169
    ds_read_b128 v[216:219], v249 offset:33792
    v_mfma_f32_16x16x32_bf16 v[108:111], v[196:199], v[208:211], v[108:111]
    v_exp_f32 v170, v170
    v_exp_f32 v171, v171
    v_add_f32 v231, v231, v156
    v_mfma_f32_16x16x32_bf16 v[112:115], v[200:203], v[208:211], v[112:115]
    v_add_f32 v252, v157, v158
    v_add_f32 v231, v231, v159
    v_mfma_f32_16x16x32_bf16 v[116:119], v[204:207], v[208:211], v[116:119]
    v_cvt_pk_bf16_f32 v156, v156, v157
    v_add_f32 v231, v231, v252
    v_cvt_pk_bf16_f32 v157, v158, v159
    ds_read_b128 v[208:211], v249 offset:35840
    s_waitcnt lgkmcnt(2)
    v_mfma_f32_16x16x32_bf16 v[120:123], v[196:199], v[212:215], v[120:123]
    ds_write_b64 v250, v[156:157] offset:10240
    v_add_f32 v232, v232, v160
    v_add_f32 v252, v161, v162
    v_mfma_f32_16x16x32_bf16 v[124:127], v[200:203], v[212:215], v[124:127]
    v_add_f32 v232, v232, v163
    v_cvt_pk_bf16_f32 v160, v160, v161
    v_add_f32 v232, v232, v252
    v_mfma_f32_16x16x32_bf16 v[128:131], v[204:207], v[212:215], v[128:131]
    v_cvt_pk_bf16_f32 v161, v162, v163
    ds_write_b64 v250, v[160:161] offset:12288
    v_add_f32 v233, v233, v164
    s_waitcnt lgkmcnt(3)
    v_mfma_f32_16x16x32_bf16 v[132:135], v[196:199], v[216:219], v[132:135]
    v_add_f32 v252, v165, v166
    v_add_f32 v233, v233, v167
    v_mfma_f32_16x16x32_bf16 v[136:139], v[200:203], v[216:219], v[136:139]
    v_cvt_pk_bf16_f32 v164, v164, v165
    v_add_f32 v233, v233, v252
    v_cvt_pk_bf16_f32 v165, v166, v167
    v_mfma_f32_16x16x32_bf16 v[140:143], v[204:207], v[216:219], v[140:143]
    ds_write_b64 v250, v[164:165] offset:14336
    v_add_f32 v234, v234, v168
    v_add_f32 v252, v169, v170
    s_waitcnt lgkmcnt(3)
    v_mfma_f32_16x16x32_bf16 v[144:147], v[196:199], v[208:211], v[144:147]
    v_add_f32 v234, v234, v171
    v_cvt_pk_bf16_f32 v168, v168, v169
    v_add_f32 v234, v234, v252
    v_mfma_f32_16x16x32_bf16 v[148:151], v[200:203], v[208:211], v[148:151]
    v_cvt_pk_bf16_f32 v169, v170, v171
    ds_write_b64 v250, v[168:169] offset:16384
    v_mfma_f32_16x16x32_bf16 v[152:155], v[204:207], v[208:211], v[152:155]
    s_waitcnt vmcnt(3)
    s_waitcnt lgkmcnt(0)
    s_barrier
    ds_read_b128 v[188:191], v244 offset:24576
    ds_read_b128 v[192:195], v245 offset:24576
    ds_read_b128 v[208:211], v244 offset:25600
    ds_read_b128 v[212:215], v245 offset:25600
    ds_read_b128 v[216:219], v244 offset:26624
    s_cmp_eq_u64 s[76:77], 0
    s_cbranch_scc1 L_nr_1_6
    v_mul_f32 v96, v235, v96
    v_mul_f32 v97, v235, v97
    v_mul_f32 v98, v235, v98
    v_mul_f32 v99, v235, v99
    v_mul_f32 v100, v235, v100
    v_mul_f32 v101, v235, v101
    v_mul_f32 v102, v235, v102
    v_mul_f32 v103, v235, v103
    v_mul_f32 v104, v235, v104
    v_mul_f32 v105, v235, v105
    v_mul_f32 v106, v235, v106
    v_mul_f32 v107, v235, v107
    v_mul_f32 v108, v236, v108
    v_mul_f32 v109, v236, v109
    v_mul_f32 v110, v236, v110
    v_mul_f32 v111, v236, v111
    v_mul_f32 v112, v236, v112
    v_mul_f32 v113, v236, v113
    v_mul_f32 v114, v236, v114
    v_mul_f32 v115, v236, v115
    v_mul_f32 v116, v236, v116
    v_mul_f32 v117, v236, v117
    v_mul_f32 v118, v236, v118
    v_mul_f32 v119, v236, v119
    v_mul_f32 v120, v237, v120
    v_mul_f32 v121, v237, v121
    v_mul_f32 v122, v237, v122
    v_mul_f32 v123, v237, v123
    v_mul_f32 v124, v237, v124
    v_mul_f32 v125, v237, v125
    v_mul_f32 v126, v237, v126
    v_mul_f32 v127, v237, v127
    v_mul_f32 v128, v237, v128
    v_mul_f32 v129, v237, v129
    v_mul_f32 v130, v237, v130
    v_mul_f32 v131, v237, v131
    v_mul_f32 v132, v238, v132
    v_mul_f32 v133, v238, v133
    v_mul_f32 v134, v238, v134
    v_mul_f32 v135, v238, v135
    v_mul_f32 v136, v238, v136
    v_mul_f32 v137, v238, v137
    v_mul_f32 v138, v238, v138
    v_mul_f32 v139, v238, v139
    v_mul_f32 v140, v238, v140
    v_mul_f32 v141, v238, v141
    v_mul_f32 v142, v238, v142
    v_mul_f32 v143, v238, v143
    v_mul_f32 v144, v239, v144
    v_mul_f32 v145, v239, v145
    v_mul_f32 v146, v239, v146
    v_mul_f32 v147, v239, v147
    v_mul_f32 v148, v239, v148
    v_mul_f32 v149, v239, v149
    v_mul_f32 v150, v239, v150
    v_mul_f32 v151, v239, v151
    v_mul_f32 v152, v239, v152
    v_mul_f32 v153, v239, v153
    v_mul_f32 v154, v239, v154
    v_mul_f32 v155, v239, v155
L_nr_1_6:
    s_waitcnt lgkmcnt(4)
    v_mfma_f32_16x16x32_bf16 v[156:159], v[188:191], v[0:3], 0
    v_min_u32 v254, 29, v240
    v_mul_u32_u24 v255, 43, v254
    v_lshrrev_b32 v255, 7, v255
    v_mul_u32_u24 v253, 3, v255
    v_sub_u32 v254, v254, v253
    v_lshlrev_b32 v254, 7, v254
    v_mul_u32_u24 v255, 12288, v255
    v_add_u32 v254, v254, v255
    s_add_u32 s47, s74, s42
    buffer_load_dword v255, v254, s[16:19], s47 offen
    v_mfma_f32_16x16x32_bf16 v[160:163], v[188:191], v[24:27], 0
    v_min_u32 v254, 44, v240
    v_lshlrev_b32 v254, 7, v254
    buffer_load_dword v255, v254, s[20:23], s75 offen
    v_mfma_f32_16x16x32_bf16 v[164:167], v[188:191], v[48:51], 0
    s_add_u32 s45, s42, 0
    s_add_u32 m0, s30, 0
    s_nop 0
    buffer_load_dwordx4 v242, s[16:19], s45 offen lds
    v_mfma_f32_16x16x32_bf16 v[168:171], v[188:191], v[72:75], 0
    s_add_u32 m0, s30, 896
    s_nop 0
    buffer_load_dwordx4 v242, s[16:19], s45 offen offset:128 lds
    ds_read_b128 v[188:191], v245 offset:26624
    s_waitcnt lgkmcnt(4)
    v_mfma_f32_16x16x32_bf16 v[156:159], v[192:195], v[4:7], v[156:159]
    s_add_u32 m0, s30, 1792
    s_nop 0
    buffer_load_dwordx4 v242, s[16:19], s45 offen offset:256 lds
    v_mfma_f32_16x16x32_bf16 v[160:163], v[192:195], v[28:31], v[160:163]
    v_mfma_f32_16x16x32_bf16 v[164:167], v[192:195], v[52:55], v[164:167]
    v_mfma_f32_16x16x32_bf16 v[168:171], v[192:195], v[76:79], v[168:171]
    s_waitcnt lgkmcnt(3)
    v_mfma_f32_16x16x32_bf16 v[156:159], v[208:211], v[8:11], v[156:159]
    v_mfma_f32_16x16x32_bf16 v[160:163], v[208:211], v[32:35], v[160:163]
    v_mfma_f32_16x16x32_bf16 v[164:167], v[208:211], v[56:59], v[164:167]
    v_mfma_f32_16x16x32_bf16 v[168:171], v[208:211], v[80:83], v[168:171]
    s_waitcnt lgkmcnt(2)
    v_mfma_f32_16x16x32_bf16 v[156:159], v[212:215], v[12:15], v[156:159]
    v_mfma_f32_16x16x32_bf16 v[160:163], v[212:215], v[36:39], v[160:163]
    v_mfma_f32_16x16x32_bf16 v[164:167], v[212:215], v[60:63], v[164:167]
    v_mfma_f32_16x16x32_bf16 v[168:171], v[212:215], v[84:87], v[168:171]
    s_waitcnt lgkmcnt(1)
    v_mfma_f32_16x16x32_bf16 v[156:159], v[216:219], v[16:19], v[156:159]
    v_mfma_f32_16x16x32_bf16 v[160:163], v[216:219], v[40:43], v[160:163]
    v_mfma_f32_16x16x32_bf16 v[164:167], v[216:219], v[64:67], v[164:167]
    v_mfma_f32_16x16x32_bf16 v[168:171], v[216:219], v[88:91], v[168:171]
    s_waitcnt lgkmcnt(0)
    v_mfma_f32_16x16x32_bf16 v[156:159], v[188:191], v[20:23], v[156:159]
    v_mfma_f32_16x16x32_bf16 v[160:163], v[188:191], v[44:47], v[160:163]
    v_mfma_f32_16x16x32_bf16 v[164:167], v[188:191], v[68:71], v[164:167]
    v_mfma_f32_16x16x32_bf16 v[168:171], v[188:191], v[92:95], v[168:171]
    s_nop 4
    v_max3_f32 v253, v156, v157, v158
    v_max_f32 v253, v253, v159
    ds_max_f32 v251, v253 offset:800
    v_max3_f32 v254, v160, v161, v162
    v_max_f32 v254, v254, v163
    ds_max_f32 v251, v254 offset:804
    v_max3_f32 v253, v164, v165, v166
    v_max_f32 v253, v253, v167
    ds_max_f32 v251, v253 offset:808
    v_max3_f32 v254, v168, v169, v170
    v_max_f32 v254, v254, v171
    ds_max_f32 v251, v254 offset:812
    s_waitcnt lgkmcnt(0)
    s_barrier
    ds_read_b32 v229, v251 offset:796
    ds_read_b128 v[224:227], v251 offset:800
    v_add_u32 v246, 24576, v246
    v_add_u32 v247, 24576, v247
    v_add_u32 v248, 24576, v248
    ds_read_b64_tr_b16 v[196:197], v246
    ds_read_b64_tr_b16 v[198:199], v246 offset:6144
    ds_read_b64_tr_b16 v[200:201], v247
    ds_read_b64_tr_b16 v[202:203], v247 offset:6144
    ds_read_b64_tr_b16 v[204:205], v248
    ds_read_b64_tr_b16 v[206:207], v248 offset:6144
    ds_read_b128 v[208:211], v249 offset:8192
    ds_read_b128 v[212:215], v249 offset:10240
    ds_read_b128 v[216:219], v249 offset:12288
    s_waitcnt lgkmcnt(2)
    v_mfma_f32_16x16x32_bf16 v[96:99], v[196:199], v[208:211], v[96:99]
    v_mul_f32 v229, s37, v229
    v_mul_f32 v224, s37, v224
    v_mul_f32 v225, s37, v225
    s_add_u32 s45, s41, 0
    s_add_u32 m0, s30, 73728
    s_nop 0
    buffer_load_dwordx4 v241, s[8:11], s45 offen nt lds
    v_mfma_f32_16x16x32_bf16 v[100:103], v[200:203], v[208:211], v[100:103]
    v_mul_f32 v226, s37, v226
    v_mul_f32 v227, s37, v227
    v_sub_f32 v235, v229, v228
    s_add_u32 m0, s30, 74624
    s_nop 0
    buffer_load_dwordx4 v241, s[8:11], s45 offen offset:128 nt lds
    v_mfma_f32_16x16x32_bf16 v[104:107], v[204:207], v[208:211], v[104:107]
    v_sub_f32 v236, v224, v220
    v_sub_f32 v237, v225, v221
    v_sub_f32 v238, v226, v222
    s_add_u32 m0, s30, 75520
    s_nop 0
    buffer_load_dwordx4 v241, s[8:11], s45 offen offset:256 nt lds
    ds_read_b128 v[208:211], v249 offset:14336
    s_waitcnt lgkmcnt(2)
    v_mfma_f32_16x16x32_bf16 v[108:111], v[196:199], v[212:215], v[108:111]
    v_sub_f32 v239, v227, v223
    v_cmp_lt_f32 s[78:79], 4.0, v235
    v_cmp_lt_f32 s[80:81], 4.0, v236
    v_mfma_f32_16x16x32_bf16 v[112:115], v[200:203], v[212:215], v[112:115]
    v_cmp_lt_f32 s[82:83], 4.0, v237
    v_cmp_lt_f32 s[84:85], 4.0, v238
    v_mfma_f32_16x16x32_bf16 v[116:119], v[204:207], v[212:215], v[116:119]
    v_cmp_lt_f32 s[86:87], 4.0, v239
    v_cndmask_b32 v229, v228, v229, s[78:79]
    v_cndmask_b32 v224, v220, v224, s[80:81]
    ds_read_b128 v[212:215], v249 offset:16384
    s_waitcnt lgkmcnt(2)
    v_mfma_f32_16x16x32_bf16 v[120:123], v[196:199], v[216:219], v[120:123]
    v_cndmask_b32 v225, v221, v225, s[82:83]
    v_cndmask_b32 v226, v222, v226, s[84:85]
    v_cndmask_b32 v227, v223, v227, s[86:87]
    v_mfma_f32_16x16x32_bf16 v[124:127], v[200:203], v[216:219], v[124:127]
    s_or_b64 s[76:77], s[78:79], s[80:81]
    s_or_b64 s[82:83], s[82:83], s[84:85]
    s_or_b64 s[76:77], s[76:77], s[86:87]
    s_or_b64 s[76:77], s[76:77], s[82:83]
    s_cbranch_scc0 L_nl_1_7
    v_sub_f32 v235, v228, v229
    v_sub_f32 v236, v220, v224
    v_sub_f32 v237, v221, v225
    v_sub_f32 v238, v222, v226
    v_sub_f32 v239, v223, v227
    v_exp_f32 v235, v235
    v_exp_f32 v236, v236
    v_exp_f32 v237, v237
    v_exp_f32 v238, v238
    v_exp_f32 v239, v239
    v_mul_f32 v231, v236, v231
    v_mul_f32 v232, v237, v232
    v_mul_f32 v233, v238, v233
    v_mul_f32 v234, v239, v234
L_nl_1_7:
    v_fma_f32 v156, v156, s37, -v224
    v_fma_f32 v157, v157, s37, -v224
    v_mfma_f32_16x16x32_bf16 v[128:131], v[204:207], v[216:219], v[128:131]
    v_fma_f32 v158, v158, s37, -v224
    v_fma_f32 v159, v159, s37, -v224
    v_fma_f32 v160, v160, s37, -v225
    ds_read_b128 v[216:219], v249 offset:9216
    s_waitcnt lgkmcnt(2)
    v_mfma_f32_16x16x32_bf16 v[132:135], v[196:199], v[208:211], v[132:135]
    v_fma_f32 v161, v161, s37, -v225
    v_fma_f32 v162, v162, s37, -v225
    v_mfma_f32_16x16x32_bf16 v[136:139], v[200:203], v[208:211], v[136:139]
    v_fma_f32 v163, v163, s37, -v225
    v_fma_f32 v164, v164, s37, -v226
    v_fma_f32 v165, v165, s37, -v226
    v_mfma_f32_16x16x32_bf16 v[140:143], v[204:207], v[208:211], v[140:143]
    v_fma_f32 v166, v166, s37, -v226
    v_fma_f32 v167, v167, s37, -v226
    v_fma_f32 v168, v168, s37, -v227
    ds_read_b128 v[208:211], v249 offset:11264
    s_waitcnt lgkmcnt(2)
    v_mfma_f32_16x16x32_bf16 v[144:147], v[196:199], v[212:215], v[144:147]
    v_fma_f32 v169, v169, s37, -v227
    v_fma_f32 v170, v170, s37, -v227
    v_fma_f32 v171, v171, s37, -v227
    ds_read_b64_tr_b16 v[196:197], v246 offset:12288
    ds_read_b64_tr_b16 v[198:199], v246 offset:18432
    v_mfma_f32_16x16x32_bf16 v[148:151], v[200:203], v[212:215], v[148:151]
    v_exp_f32 v156, v156
    v_exp_f32 v157, v157
    v_exp_f32 v158, v158
    ds_read_b64_tr_b16 v[200:201], v247 offset:12288
    ds_read_b64_tr_b16 v[202:203], v247 offset:18432
    v_mfma_f32_16x16x32_bf16 v[152:155], v[204:207], v[212:215], v[152:155]
    v_exp_f32 v159, v159
    v_exp_f32 v160, v160
    ds_read_b64_tr_b16 v[204:205], v248 offset:12288
    ds_read_b64_tr_b16 v[206:207], v248 offset:18432
    ds_read_b128 v[212:215], v249 offset:13312
    s_waitcnt lgkmcnt(5)
    v_mfma_f32_16x16x32_bf16 v[96:99], v[196:199], v[216:219], v[96:99]
    v_exp_f32 v161, v161
    v_exp_f32 v162, v162
    v_exp_f32 v163, v163
    s_waitcnt lgkmcnt(3)
    v_mfma_f32_16x16x32_bf16 v[100:103], v[200:203], v[216:219], v[100:103]
    v_exp_f32 v164, v164
    v_exp_f32 v165, v165
    v_exp_f32 v166, v166
    s_waitcnt lgkmcnt(1)
    v_mfma_f32_16x16x32_bf16 v[104:107], v[204:207], v[216:219], v[104:107]
    v_exp_f32 v167, v167
    v_exp_f32 v168, v168
    v_exp_f32 v169, v169
    ds_read_b128 v[216:219], v249 offset:15360
    v_mfma_f32_16x16x32_bf16 v[108:111], v[196:199], v[208:211], v[108:111]
    v_exp_f32 v170, v170
    v_exp_f32 v171, v171
    v_add_f32 v231, v231, v156
    v_mfma_f32_16x16x32_bf16 v[112:115], v[200:203], v[208:211], v[112:115]
    v_add_f32 v252, v157, v158
    v_add_f32 v231, v231, v159
    v_mfma_f32_16x16x32_bf16 v[116:119], v[204:207], v[208:211], v[116:119]
    v_cvt_pk_bf16_f32 v156, v156, v157
    v_add_f32 v231, v231, v252
    v_cvt_pk_bf16_f32 v157, v158, v159
    ds_read_b128 v[208:211], v249 offset:17408
    s_waitcnt lgkmcnt(2)
    v_mfma_f32_16x16x32_bf16 v[120:123], v[196:199], v[212:215], v[120:123]
    ds_write_b64 v250, v[156:157] offset:28672
    v_add_f32 v232, v232, v160
    v_add_f32 v252, v161, v162
    v_mfma_f32_16x16x32_bf16 v[124:127], v[200:203], v[212:215], v[124:127]
    v_add_f32 v232, v232, v163
    v_cvt_pk_bf16_f32 v160, v160, v161
    v_add_f32 v232, v232, v252
    v_mfma_f32_16x16x32_bf16 v[128:131], v[204:207], v[212:215], v[128:131]
    v_cvt_pk_bf16_f32 v161, v162, v163
    ds_write_b64 v250, v[160:161] offset:30720
    v_add_f32 v233, v233, v164
    s_waitcnt lgkmcnt(3)
    v_mfma_f32_16x16x32_bf16 v[132:135], v[196:199], v[216:219], v[132:135]
    v_add_f32 v252, v165, v166
    v_add_f32 v233, v233, v167
    v_mfma_f32_16x16x32_bf16 v[136:139], v[200:203], v[216:219], v[136:139]
    v_cvt_pk_bf16_f32 v164, v164, v165
    v_add_f32 v233, v233, v252
    v_cvt_pk_bf16_f32 v165, v166, v167
    v_mfma_f32_16x16x32_bf16 v[140:143], v[204:207], v[216:219], v[140:143]
    ds_write_b64 v250, v[164:165] offset:32768
    v_add_f32 v234, v234, v168
    v_add_f32 v252, v169, v170
    s_waitcnt lgkmcnt(3)
    v_mfma_f32_16x16x32_bf16 v[144:147], v[196:199], v[208:211], v[144:147]
    v_add_f32 v234, v234, v171
    v_cvt_pk_bf16_f32 v168, v168, v169
    v_add_f32 v234, v234, v252
    v_mfma_f32_16x16x32_bf16 v[148:151], v[200:203], v[208:211], v[148:151]
    v_cvt_pk_bf16_f32 v169, v170, v171
    ds_write_b64 v250, v[168:169] offset:34816
    v_mfma_f32_16x16x32_bf16 v[152:155], v[204:207], v[208:211], v[152:155]
    v_and_b32 v0, 15, v240
    v_lshrrev_b32 v1, 4, v240
    v_permlane16_swap_b32 v231, v232
    v_permlane16_swap_b32 v233, v234
    v_add_f32 v231, v231, v232
    v_add_f32 v233, v233, v234
    s_nop 1
    v_permlane32_swap_b32 v231, v233
    v_add_f32 v231, v231, v233
    s_lshl_b32 s45, s29, 2
    s_add_u32 s45, s45, 159744
    v_lshlrev_b32 v2, 4, v0
    v_add_u32 v2, s45, v2
    v_lshl_add_u32 v3, v1, 8, v2
    ds_write_b32 v3, v231 offset:1280
    s_waitcnt lgkmcnt(0)
    s_barrier
    s_cmp_eq_u64 s[76:77], 0
    s_cbranch_scc1 L_nr_1_7
    v_mul_f32 v96, v235, v96
    v_mul_f32 v97, v235, v97
    v_mul_f32 v98, v235, v98
    v_mul_f32 v99, v235, v99
    v_mul_f32 v100, v235, v100
    v_mul_f32 v101, v235, v101
    v_mul_f32 v102, v235, v102
    v_mul_f32 v103, v235, v103
    v_mul_f32 v104, v235, v104
    v_mul_f32 v105, v235, v105
    v_mul_f32 v106, v235, v106
    v_mul_f32 v107, v235, v107
    v_mul_f32 v108, v236, v108
    v_mul_f32 v109, v236, v109
    v_mul_f32 v110, v236, v110
    v_mul_f32 v111, v236, v111
    v_mul_f32 v112, v236, v112
    v_mul_f32 v113, v236, v113
    v_mul_f32 v114, v236, v114
    v_mul_f32 v115, v236, v115
    v_mul_f32 v116, v236, v116
    v_mul_f32 v117, v236, v117
    v_mul_f32 v118, v236, v118
    v_mul_f32 v119, v236, v119
    v_mul_f32 v120, v237, v120
    v_mul_f32 v121, v237, v121
    v_mul_f32 v122, v237, v122
    v_mul_f32 v123, v237, v123
    v_mul_f32 v124, v237, v124
    v_mul_f32 v125, v237, v125
    v_mul_f32 v126, v237, v126
    v_mul_f32 v127, v237, v127
    v_mul_f32 v128, v237, v128
    v_mul_f32 v129, v237, v129
    v_mul_f32 v130, v237, v130
    v_mul_f32 v131, v237, v131
    v_mul_f32 v132, v238, v132
    v_mul_f32 v133, v238, v133
    v_mul_f32 v134, v238, v134
    v_mul_f32 v135, v238, v135
    v_mul_f32 v136, v238, v136
    v_mul_f32 v137, v238, v137
    v_mul_f32 v138, v238, v138
    v_mul_f32 v139, v238, v139
    v_mul_f32 v140, v238, v140
    v_mul_f32 v141, v238, v141
    v_mul_f32 v142, v238, v142
    v_mul_f32 v143, v238, v143
    v_mul_f32 v144, v239, v144
    v_mul_f32 v145, v239, v145
    v_mul_f32 v146, v239, v146
    v_mul_f32 v147, v239, v147
    v_mul_f32 v148, v239, v148
    v_mul_f32 v149, v239, v149
    v_mul_f32 v150, v239, v150
    v_mul_f32 v151, v239, v151
    v_mul_f32 v152, v239, v152
    v_mul_f32 v153, v239, v153
    v_mul_f32 v154, v239, v154
    v_mul_f32 v155, v239, v155
L_nr_1_7:
    s_add_u32 s45, s42, 786432
    s_add_u32 m0, s30, 24576
    s_nop 0
    buffer_load_dwordx4 v242, s[16:19], s45 offen lds
    s_add_u32 m0, s30, 25472
    s_nop 0
    buffer_load_dwordx4 v242, s[16:19], s45 offen offset:128 lds
    s_add_u32 m0, s30, 26368
    s_nop 0
    buffer_load_dwordx4 v242, s[16:19], s45 offen offset:256 lds
    s_waitcnt vmcnt(11)
    s_barrier
    v_add_u32 v246, 24576, v246
    v_add_u32 v247, 24576, v247
    v_add_u32 v248, 24576, v248
    ds_read_b64_tr_b16 v[196:197], v246
    ds_read_b64_tr_b16 v[198:199], v246 offset:6144
    ds_read_b64_tr_b16 v[200:201], v247
    ds_read_b64_tr_b16 v[202:203], v247 offset:6144
    ds_read_b64_tr_b16 v[204:205], v248
    ds_read_b64_tr_b16 v[206:207], v248 offset:6144
    ds_read_b128 v[208:211], v249 offset:26624
    ds_read_b128 v[212:215], v249 offset:28672
    ds_read_b128 v[216:219], v249 offset:30720
    s_waitcnt lgkmcnt(2)
    v_mfma_f32_16x16x32_bf16 v[96:99], v[196:199], v[208:211], v[96:99]
    s_add_u32 s46, s34, 0
    s_add_u32 m0, s31, 122880
    s_nop 0
    buffer_load_dwordx4 v243, s[20:23], s46 offen lds
    s_add_u32 s46, s34, 9216
    buffer_load_dwordx4 v243, s[20:23], s46 offen offset:1024 lds
    s_add_u32 s46, s34, 18432
    s_mov_b64 exec, 0xffff
    buffer_load_dwordx4 v243, s[20:23], s46 offen offset:2048 lds
    s_mov_b64 exec, -1
    v_mfma_f32_16x16x32_bf16 v[100:103], v[200:203], v[208:211], v[100:103]
    s_add_u32 s46, s34, 256
    s_add_u32 m0, s31, 98304
    s_nop 0
    buffer_load_dwordx4 v243, s[20:23], s46 offen lds
    s_add_u32 s46, s34, 9472
    buffer_load_dwordx4 v243, s[20:23], s46 offen offset:1024 lds
    s_add_u32 s46, s34, 18688
    s_mov_b64 exec, 0xffff
    buffer_load_dwordx4 v243, s[20:23], s46 offen offset:2048 lds
    s_mov_b64 exec, -1
    v_mfma_f32_16x16x32_bf16 v[104:107], v[204:207], v[208:211], v[104:107]
    ds_read_b128 v[208:211], v249 offset:32768
    s_waitcnt lgkmcnt(2)
    v_mfma_f32_16x16x32_bf16 v[108:111], v[196:199], v[212:215], v[108:111]
    v_mfma_f32_16x16x32_bf16 v[112:115], v[200:203], v[212:215], v[112:115]
    v_mfma_f32_16x16x32_bf16 v[116:119], v[204:207], v[212:215], v[116:119]
    ds_read_b128 v[212:215], v249 offset:34816
    s_waitcnt lgkmcnt(2)
    v_mfma_f32_16x16x32_bf16 v[120:123], v[196:199], v[216:219], v[120:123]
    v_mfma_f32_16x16x32_bf16 v[124:127], v[200:203], v[216:219], v[124:127]
    v_mfma_f32_16x16x32_bf16 v[128:131], v[204:207], v[216:219], v[128:131]
    ds_read_b128 v[216:219], v249 offset:27648
    s_waitcnt lgkmcnt(2)
    v_mfma_f32_16x16x32_bf16 v[132:135], v[196:199], v[208:211], v[132:135]
    v_mfma_f32_16x16x32_bf16 v[136:139], v[200:203], v[208:211], v[136:139]
    v_mfma_f32_16x16x32_bf16 v[140:143], v[204:207], v[208:211], v[140:143]
    ds_read_b128 v[208:211], v249 offset:29696
    s_waitcnt lgkmcnt(2)
    v_mfma_f32_16x16x32_bf16 v[144:147], v[196:199], v[212:215], v[144:147]
    ds_read_b64_tr_b16 v[196:197], v246 offset:12288
    ds_read_b64_tr_b16 v[198:199], v246 offset:18432
    v_mfma_f32_16x16x32_bf16 v[148:151], v[200:203], v[212:215], v[148:151]
    ds_read_b64_tr_b16 v[200:201], v247 offset:12288
    ds_read_b64_tr_b16 v[202:203], v247 offset:18432
    v_mfma_f32_16x16x32_bf16 v[152:155], v[204:207], v[212:215], v[152:155]
    ds_read_b64_tr_b16 v[204:205], v248 offset:12288
    ds_read_b64_tr_b16 v[206:207], v248 offset:18432
    ds_read_b128 v[212:215], v249 offset:31744
    s_waitcnt lgkmcnt(5)
    v_mfma_f32_16x16x32_bf16 v[96:99], v[196:199], v[216:219], v[96:99]
    s_waitcnt lgkmcnt(3)
    v_mfma_f32_16x16x32_bf16 v[100:103], v[200:203], v[216:219], v[100:103]
    s_waitcnt lgkmcnt(1)
    v_mfma_f32_16x16x32_bf16 v[104:107], v[204:207], v[216:219], v[104:107]
    ds_read_b128 v[216:219], v249 offset:33792
    v_mfma_f32_16x16x32_bf16 v[108:111], v[196:199], v[208:211], v[108:111]
    v_mfma_f32_16x16x32_bf16 v[112:115], v[200:203], v[208:211], v[112:115]
    v_mfma_f32_16x16x32_bf16 v[116:119], v[204:207], v[208:211], v[116:119]
    ds_read_b128 v[208:211], v249 offset:35840
    s_waitcnt lgkmcnt(2)
    v_mfma_f32_16x16x32_bf16 v[120:123], v[196:199], v[212:215], v[120:123]
    v_mfma_f32_16x16x32_bf16 v[124:127], v[200:203], v[212:215], v[124:127]
    v_mfma_f32_16x16x32_bf16 v[128:131], v[204:207], v[212:215], v[128:131]
    s_waitcnt lgkmcnt(1)
    v_mfma_f32_16x16x32_bf16 v[132:135], v[196:199], v[216:219], v[132:135]
    v_mfma_f32_16x16x32_bf16 v[136:139], v[200:203], v[216:219], v[136:139]
    v_mfma_f32_16x16x32_bf16 v[140:143], v[204:207], v[216:219], v[140:143]
    s_waitcnt lgkmcnt(0)
    v_mfma_f32_16x16x32_bf16 v[144:147], v[196:199], v[208:211], v[144:147]
    v_mfma_f32_16x16x32_bf16 v[148:151], v[200:203], v[208:211], v[148:151]
    v_mfma_f32_16x16x32_bf16 v[152:155], v[204:207], v[208:211], v[152:155]
    v_and_b32 v0, 15, v240
    v_lshlrev_b32 v1, 4, v0
    v_add_u32 v1, 159744, v1
    v_lshlrev_b32 v2, 4, v240
    ds_read_b128 v[4:7], v1 offset:1024
    ds_read_b128 v[8:11], v1 offset:1280
    ds_read_b128 v[12:15], v1 offset:1536
    ds_read_b128 v[16:19], v1 offset:1792
    ds_read_b128 v[20:23], v1 offset:2048
    s_waitcnt lgkmcnt(4)
    v_add_f32 v4, v4, v5
    v_add_f32 v6, v6, v7
    v_add_f32 v4, v4, v6
    v_rcp_f32 v4, v4
    s_waitcnt lgkmcnt(3)
    v_add_f32 v8, v8, v9
    v_add_f32 v10, v10, v11
    v_add_f32 v8, v8, v10
    v_rcp_f32 v8, v8
    s_waitcnt lgkmcnt(2)
    v_add_f32 v12, v12, v13
    v_add_f32 v14, v14, v15
    v_add_f32 v12, v12, v14
    v_rcp_f32 v12, v12
    s_waitcnt lgkmcnt(1)
    v_add_f32 v16, v16, v17
    v_add_f32 v18, v18, v19
    v_add_f32 v16, v16, v18
    v_rcp_f32 v16, v16
    s_waitcnt lgkmcnt(0)
    v_add_f32 v20, v20, v21
    v_add_f32 v22, v22, v23
    v_add_f32 v20, v20, v22
    v_rcp_f32 v20, v20
    v_mul_f32 v96, v4, v96
    v_mul_f32 v97, v4, v97
    v_mul_f32 v98, v4, v98
    v_mul_f32 v99, v4, v99
    v_mul_f32 v100, v4, v100
    v_mul_f32 v101, v4, v101
    v_mul_f32 v102, v4, v102
    v_mul_f32 v103, v4, v103
    v_mul_f32 v104, v4, v104
    v_mul_f32 v105, v4, v105
    v_mul_f32 v106, v4, v106
    v_mul_f32 v107, v4, v107
    v_cvt_pk_bf16_f32 v96, v96, v97
    v_cvt_pk_bf16_f32 v97, v98, v99
    v_cvt_pk_bf16_f32 v98, v100, v101
    v_cvt_pk_bf16_f32 v99, v102, v103
    v_cvt_pk_bf16_f32 v100, v104, v105
    v_cvt_pk_bf16_f32 v101, v106, v107
    s_add_u32 s45, s35, s43
    s_add_u32 s46, s35, s44
    s_add_u32 s45, s45, 4096
    s_add_u32 s46, s46, 4096
    buffer_store_dwordx4 v[96:99], v2, s[24:27], s45 offen
    buffer_store_dwordx2 v[100:101], v2, s[24:27], s46 offen
    v_mul_f32 v108, v8, v108
    v_mul_f32 v109, v8, v109
    v_mul_f32 v110, v8, v110
    v_mul_f32 v111, v8, v111
    v_mul_f32 v112, v8, v112
    v_mul_f32 v113, v8, v113
    v_mul_f32 v114, v8, v114
    v_mul_f32 v115, v8, v115
    v_mul_f32 v116, v8, v116
    v_mul_f32 v117, v8, v117
    v_mul_f32 v118, v8, v118
    v_mul_f32 v119, v8, v119
    v_cvt_pk_bf16_f32 v108, v108, v109
    v_cvt_pk_bf16_f32 v109, v110, v111
    v_cvt_pk_bf16_f32 v110, v112, v113
    v_cvt_pk_bf16_f32 v111, v114, v115
    v_cvt_pk_bf16_f32 v112, v116, v117
    v_cvt_pk_bf16_f32 v113, v118, v119
    s_add_u32 s45, s35, s43
    s_add_u32 s46, s35, s44
    s_add_u32 s45, s45, 4096
    s_add_u32 s46, s46, 4096
    buffer_store_dwordx4 v[108:111], v2, s[24:27], s45 offen offset:1024
    buffer_store_dwordx2 v[112:113], v2, s[24:27], s46 offen offset:1024
    v_mul_f32 v120, v12, v120
    v_mul_f32 v121, v12, v121
    v_mul_f32 v122, v12, v122
    v_mul_f32 v123, v12, v123
    v_mul_f32 v124, v12, v124
    v_mul_f32 v125, v12, v125
    v_mul_f32 v126, v12, v126
    v_mul_f32 v127, v12, v127
    v_mul_f32 v128, v12, v128
    v_mul_f32 v129, v12, v129
    v_mul_f32 v130, v12, v130
    v_mul_f32 v131, v12, v131
    v_cvt_pk_bf16_f32 v120, v120, v121
    v_cvt_pk_bf16_f32 v121, v122, v123
    v_cvt_pk_bf16_f32 v122, v124, v125
    v_cvt_pk_bf16_f32 v123, v126, v127
    v_cvt_pk_bf16_f32 v124, v128, v129
    v_cvt_pk_bf16_f32 v125, v130, v131
    s_add_u32 s45, s35, s43
    s_add_u32 s46, s35, s44
    s_add_u32 s45, s45, 4096
    s_add_u32 s46, s46, 4096
    buffer_store_dwordx4 v[120:123], v2, s[24:27], s45 offen offset:2048
    buffer_store_dwordx2 v[124:125], v2, s[24:27], s46 offen offset:2048
    v_mul_f32 v132, v16, v132
    v_mul_f32 v133, v16, v133
    v_mul_f32 v134, v16, v134
    v_mul_f32 v135, v16, v135
    v_mul_f32 v136, v16, v136
    v_mul_f32 v137, v16, v137
    v_mul_f32 v138, v16, v138
    v_mul_f32 v139, v16, v139
    v_mul_f32 v140, v16, v140
    v_mul_f32 v141, v16, v141
    v_mul_f32 v142, v16, v142
    v_mul_f32 v143, v16, v143
    v_cvt_pk_bf16_f32 v132, v132, v133
    v_cvt_pk_bf16_f32 v133, v134, v135
    v_cvt_pk_bf16_f32 v134, v136, v137
    v_cvt_pk_bf16_f32 v135, v138, v139
    v_cvt_pk_bf16_f32 v136, v140, v141
    v_cvt_pk_bf16_f32 v137, v142, v143
    s_add_u32 s45, s35, s43
    s_add_u32 s46, s35, s44
    s_add_u32 s45, s45, 4096
    s_add_u32 s46, s46, 4096
    buffer_store_dwordx4 v[132:135], v2, s[24:27], s45 offen offset:3072
    buffer_store_dwordx2 v[136:137], v2, s[24:27], s46 offen offset:3072
    v_mul_f32 v144, v20, v144
    v_mul_f32 v145, v20, v145
    v_mul_f32 v146, v20, v146
    v_mul_f32 v147, v20, v147
    v_mul_f32 v148, v20, v148
    v_mul_f32 v149, v20, v149
    v_mul_f32 v150, v20, v150
    v_mul_f32 v151, v20, v151
    v_mul_f32 v152, v20, v152
    v_mul_f32 v153, v20, v153
    v_mul_f32 v154, v20, v154
    v_mul_f32 v155, v20, v155
    v_cvt_pk_bf16_f32 v144, v144, v145
    v_cvt_pk_bf16_f32 v145, v146, v147
    v_cvt_pk_bf16_f32 v146, v148, v149
    v_cvt_pk_bf16_f32 v147, v150, v151
    v_cvt_pk_bf16_f32 v148, v152, v153
    v_cvt_pk_bf16_f32 v149, v154, v155
    s_add_u32 s45, s35, s43
    s_add_u32 s46, s35, s44
    s_add_u32 s45, s45, 8192
    s_add_u32 s46, s46, 8192
    buffer_store_dwordx4 v[144:147], v2, s[24:27], s45 offen
    buffer_store_dwordx2 v[148:149], v2, s[24:27], s46 offen
    s_waitcnt vmcnt(13)
    s_barrier
    s_mov_b32 s32, s41
    s_mov_b32 s33, s42
    s_add_u32 s41, s41, 196608
    s_add_u32 s42, s42, 384
    s_add_u32 s35, s35, 884736
    s_add_u32 s36, s36, 1
    s_nop 9
    s_cmp_lt_u32 s36, 4
    s_cbranch_scc1 L_head_1
    s_endpgm
L_k1_exit:
    s_endpgm
.p2align 8
oproj_kernel:
    s_cmp_ge_u32 s2, 240
    s_cbranch_scc1 L_k2_exit
    s_load_dwordx2 s[4:5], s[0:1], 32
    s_load_dwordx2 s[6:7], s[0:1], 72
    s_load_dwordx2 s[8:9], s[0:1], 80
    s_load_dwordx2 s[10:11], s[0:1], 96
    s_and_b32 s3, s2, 7
    s_lshr_b32 s36, s2, 3
    s_lshr_b32 s25, s3, 2
    s_and_b32 s3, s3, 3
    s_mul_i32 s3, s3, 6
    s_mul_i32 s37, s36, 13108
    s_lshr_b32 s37, s37, 16
    s_add_u32 s26, s3, s37
    s_mul_i32 s37, s37, 5
    s_sub_u32 s27, s36, s37
    s_waitcnt lgkmcnt(0)
    s_cmp_eq_u32 s25, 0
    s_cselect_b32 s4, s4, s6
    s_cselect_b32 s5, s5, s7
    s_mov_b32 s12, s4
    s_and_b32 s13, s5, 0xffff
    s_mov_b32 s14, 7864320
    s_mov_b32 s15, 0x00020000
    s_mov_b32 s16, s10
    s_and_b32 s17, s11, 0xffff
    s_mov_b32 s18, 56623104
    s_mov_b32 s19, 0x00020000
    s_mov_b32 s20, s8
    s_and_b32 s21, s9, 0xffff
    s_mov_b32 s22, 5898240
    s_mov_b32 s23, 0x00020000
    v_lshrrev_b32 v1, 6, v0
    s_nop 0
    v_readfirstlane_b32 s24, v1
    v_and_b32 v171, 63, v0
    v_lshlrev_b32 v170, 4, v171
    v_lshrrev_b32 v172, 4, v171
    v_and_b32 v173, 15, v171
    v_add_u32 v174, 0, v172
    v_lshlrev_b32 v174, 1, v174
    v_xor_b32 v174, v174, v173
    v_lshlrev_b32 v174, 4, v174
    v_mul_u32_u24 v175, 1280, v172
    v_add_u32 v160, v174, v175
    v_add_u32 v174, 4, v172
    v_lshlrev_b32 v174, 1, v174
    v_xor_b32 v174, v174, v173
    v_lshlrev_b32 v174, 4, v174
    v_mul_u32_u24 v175, 1280, v172
    v_add_u32 v161, v174, v175
    s_lshl_b32 s33, s24, 15
    v_lshrrev_b32 v172, 2, v171
    v_and_b32 v173, 7, v172
    v_lshlrev_b32 v172, 8, v172
    v_and_b32 v174, 3, v171
    v_lshl_add_u32 v172, v174, 3, v172
    v_add_u32 v172, s33, v172
    v_xor_b32 v174, 0, v173
    v_lshl_add_u32 v162, v174, 5, v172
    v_xor_b32 v174, 1, v173
    v_lshl_add_u32 v163, v174, 5, v172
    v_xor_b32 v174, 2, v173
    v_lshl_add_u32 v164, v174, 5, v172
    v_xor_b32 v174, 3, v173
    v_lshl_add_u32 v165, v174, 5, v172
    v_xor_b32 v174, 4, v173
    v_lshl_add_u32 v166, v174, 5, v172
    v_xor_b32 v174, 5, v173
    v_lshl_add_u32 v167, v174, 5, v172
    v_xor_b32 v174, 6, v173
    v_lshl_add_u32 v168, v174, 5, v172
    v_xor_b32 v174, 7, v173
    v_lshl_add_u32 v169, v174, 5, v172
    s_mul_i32 s35, s25, 192
    s_mul_i32 s36, s24, 48
    s_add_u32 s35, s35, s36
    s_mul_i32 s35, s35, 144
    s_mul_i32 s37, s26, 6
    s_add_u32 s35, s35, s37
    s_lshl_b32 s28, s35, 10
    s_add_u32 s29, s28, 4096
    s_mul_i32 s31, s36, 40960
    s_lshl_b32 s35, s27, 8
    s_add_u32 s31, s31, s35
    s_mul_i32 s34, s26, 245760
    s_mul_i32 s37, s25, 1280
    s_add_u32 s34, s34, s37
    s_add_u32 s34, s34, s35
    s_mov_b32 s32, 0
    v_add_u32 v179, s33, v170
    buffer_load_dwordx4 v[0:3], v170, s[16:19], s28 offen
    buffer_load_dwordx4 v[4:7], v170, s[16:19], s28 offen offset:1024
    buffer_load_dwordx4 v[8:11], v170, s[16:19], s28 offen offset:2048
    buffer_load_dwordx4 v[12:15], v170, s[16:19], s28 offen offset:3072
    buffer_load_dwordx4 v[16:19], v170, s[16:19], s29 offen
    buffer_load_dwordx4 v[20:23], v170, s[16:19], s29 offen offset:1024
    s_add_u32 s28, s28, 147456
    s_add_u32 s29, s29, 147456
    buffer_load_dwordx4 a[192:195], v160, s[12:15], s31 offen
    s_add_u32 s35, s31, 5120
    buffer_load_dwordx4 a[196:199], v161, s[12:15], s35 offen
    s_add_u32 s35, s31, 10240
    buffer_load_dwordx4 a[200:203], v160, s[12:15], s35 offen
    s_add_u32 s35, s31, 15360
    buffer_load_dwordx4 a[204:207], v161, s[12:15], s35 offen
    s_add_u32 s35, s31, 20480
    buffer_load_dwordx4 a[208:211], v160, s[12:15], s35 offen
    s_add_u32 s35, s31, 25600
    buffer_load_dwordx4 a[212:215], v161, s[12:15], s35 offen
    s_add_u32 s35, s31, 30720
    buffer_load_dwordx4 a[216:219], v160, s[12:15], s35 offen
    s_add_u32 s35, s31, 35840
    buffer_load_dwordx4 a[220:223], v161, s[12:15], s35 offen
    s_add_u32 s31, s31, 40960
    buffer_load_dwordx4 v[24:27], v170, s[16:19], s28 offen
    buffer_load_dwordx4 v[28:31], v170, s[16:19], s28 offen offset:1024
    buffer_load_dwordx4 v[32:35], v170, s[16:19], s28 offen offset:2048
    buffer_load_dwordx4 v[36:39], v170, s[16:19], s28 offen offset:3072
    buffer_load_dwordx4 v[40:43], v170, s[16:19], s29 offen
    buffer_load_dwordx4 v[44:47], v170, s[16:19], s29 offen offset:1024
    s_add_u32 s28, s28, 147456
    s_add_u32 s29, s29, 147456
    buffer_load_dwordx4 a[224:227], v160, s[12:15], s31 offen
    s_add_u32 s35, s31, 5120
    buffer_load_dwordx4 a[228:231], v161, s[12:15], s35 offen
    s_add_u32 s35, s31, 10240
    buffer_load_dwordx4 a[232:235], v160, s[12:15], s35 offen
    s_add_u32 s35, s31, 15360
    buffer_load_dwordx4 a[236:239], v161, s[12:15], s35 offen
    s_add_u32 s35, s31, 20480
    buffer_load_dwordx4 a[240:243], v160, s[12:15], s35 offen
    s_add_u32 s35, s31, 25600
    buffer_load_dwordx4 a[244:247], v161, s[12:15], s35 offen
    s_add_u32 s35, s31, 30720
    buffer_load_dwordx4 a[248:251], v160, s[12:15], s35 offen
    s_add_u32 s35, s31, 35840
    buffer_load_dwordx4 a[252:255], v161, s[12:15], s35 offen
    s_add_u32 s31, s31, 40960
    buffer_load_dwordx4 v[48:51], v170, s[16:19], s28 offen
    buffer_load_dwordx4 v[52:55], v170, s[16:19], s28 offen offset:1024
    buffer_load_dwordx4 v[56:59], v170, s[16:19], s28 offen offset:2048
    buffer_load_dwordx4 v[60:63], v170, s[16:19], s28 offen offset:3072
    buffer_load_dwordx4 v[64:67], v170, s[16:19], s29 offen
    buffer_load_dwordx4 v[68:71], v170, s[16:19], s29 offen offset:1024
    s_add_u32 s28, s28, 147456
    s_add_u32 s29, s29, 147456
    v_accvgpr_write_b32 a0, 0
    v_accvgpr_write_b32 a1, 0
    v_accvgpr_write_b32 a2, 0
    v_accvgpr_write_b32 a3, 0
    v_accvgpr_write_b32 a4, 0
    v_accvgpr_write_b32 a5, 0
    v_accvgpr_write_b32 a6, 0
    v_accvgpr_write_b32 a7, 0
    v_accvgpr_write_b32 a8, 0
    v_accvgpr_write_b32 a9, 0
    v_accvgpr_write_b32 a10, 0
    v_accvgpr_write_b32 a11, 0
    v_accvgpr_write_b32 a12, 0
    v_accvgpr_write_b32 a13, 0
    v_accvgpr_write_b32 a14, 0
    v_accvgpr_write_b32 a15, 0
    v_accvgpr_write_b32 a16, 0
    v_accvgpr_write_b32 a17, 0
    v_accvgpr_write_b32 a18, 0
    v_accvgpr_write_b32 a19, 0
    v_accvgpr_write_b32 a20, 0
    v_accvgpr_write_b32 a21, 0
    v_accvgpr_write_b32 a22, 0
    v_accvgpr_write_b32 a23, 0
    v_accvgpr_write_b32 a24, 0
    v_accvgpr_write_b32 a25, 0
    v_accvgpr_write_b32 a26, 0
    v_accvgpr_write_b32 a27, 0
    v_accvgpr_write_b32 a28, 0
    v_accvgpr_write_b32 a29, 0
    v_accvgpr_write_b32 a30, 0
    v_accvgpr_write_b32 a31, 0
    v_accvgpr_write_b32 a32, 0
    v_accvgpr_write_b32 a33, 0
    v_accvgpr_write_b32 a34, 0
    v_accvgpr_write_b32 a35, 0
    v_accvgpr_write_b32 a36, 0
    v_accvgpr_write_b32 a37, 0
    v_accvgpr_write_b32 a38, 0
    v_accvgpr_write_b32 a39, 0
    v_accvgpr_write_b32 a40, 0
    v_accvgpr_write_b32 a41, 0
    v_accvgpr_write_b32 a42, 0
    v_accvgpr_write_b32 a43, 0
    v_accvgpr_write_b32 a44, 0
    v_accvgpr_write_b32 a45, 0
    v_accvgpr_write_b32 a46, 0
    v_accvgpr_write_b32 a47, 0
    v_accvgpr_write_b32 a48, 0
    v_accvgpr_write_b32 a49, 0
    v_accvgpr_write_b32 a50, 0
    v_accvgpr_write_b32 a51, 0
    v_accvgpr_write_b32 a52, 0
    v_accvgpr_write_b32 a53, 0
    v_accvgpr_write_b32 a54, 0
    v_accvgpr_write_b32 a55, 0
    v_accvgpr_write_b32 a56, 0
    v_accvgpr_write_b32 a57, 0
    v_accvgpr_write_b32 a58, 0
    v_accvgpr_write_b32 a59, 0
    v_accvgpr_write_b32 a60, 0
    v_accvgpr_write_b32 a61, 0
    v_accvgpr_write_b32 a62, 0
    v_accvgpr_write_b32 a63, 0
    v_accvgpr_write_b32 a64, 0
    v_accvgpr_write_b32 a65, 0
    v_accvgpr_write_b32 a66, 0
    v_accvgpr_write_b32 a67, 0
    v_accvgpr_write_b32 a68, 0
    v_accvgpr_write_b32 a69, 0
    v_accvgpr_write_b32 a70, 0
    v_accvgpr_write_b32 a71, 0
    v_accvgpr_write_b32 a72, 0
    v_accvgpr_write_b32 a73, 0
    v_accvgpr_write_b32 a74, 0
    v_accvgpr_write_b32 a75, 0
    v_accvgpr_write_b32 a76, 0
    v_accvgpr_write_b32 a77, 0
    v_accvgpr_write_b32 a78, 0
    v_accvgpr_write_b32 a79, 0
    v_accvgpr_write_b32 a80, 0
    v_accvgpr_write_b32 a81, 0
    v_accvgpr_write_b32 a82, 0
    v_accvgpr_write_b32 a83, 0
    v_accvgpr_write_b32 a84, 0
    v_accvgpr_write_b32 a85, 0
    v_accvgpr_write_b32 a86, 0
    v_accvgpr_write_b32 a87, 0
    v_accvgpr_write_b32 a88, 0
    v_accvgpr_write_b32 a89, 0
    v_accvgpr_write_b32 a90, 0
    v_accvgpr_write_b32 a91, 0
    v_accvgpr_write_b32 a92, 0
    v_accvgpr_write_b32 a93, 0
    v_accvgpr_write_b32 a94, 0
    v_accvgpr_write_b32 a95, 0
    v_accvgpr_write_b32 a96, 0
    v_accvgpr_write_b32 a97, 0
    v_accvgpr_write_b32 a98, 0
    v_accvgpr_write_b32 a99, 0
    v_accvgpr_write_b32 a100, 0
    v_accvgpr_write_b32 a101, 0
    v_accvgpr_write_b32 a102, 0
    v_accvgpr_write_b32 a103, 0
    v_accvgpr_write_b32 a104, 0
    v_accvgpr_write_b32 a105, 0
    v_accvgpr_write_b32 a106, 0
    v_accvgpr_write_b32 a107, 0
    v_accvgpr_write_b32 a108, 0
    v_accvgpr_write_b32 a109, 0
    v_accvgpr_write_b32 a110, 0
    v_accvgpr_write_b32 a111, 0
    v_accvgpr_write_b32 a112, 0
    v_accvgpr_write_b32 a113, 0
    v_accvgpr_write_b32 a114, 0
    v_accvgpr_write_b32 a115, 0
    v_accvgpr_write_b32 a116, 0
    v_accvgpr_write_b32 a117, 0
    v_accvgpr_write_b32 a118, 0
    v_accvgpr_write_b32 a119, 0
    v_accvgpr_write_b32 a120, 0
    v_accvgpr_write_b32 a121, 0
    v_accvgpr_write_b32 a122, 0
    v_accvgpr_write_b32 a123, 0
    v_accvgpr_write_b32 a124, 0
    v_accvgpr_write_b32 a125, 0
    v_accvgpr_write_b32 a126, 0
    v_accvgpr_write_b32 a127, 0
    v_accvgpr_write_b32 a128, 0
    v_accvgpr_write_b32 a129, 0
    v_accvgpr_write_b32 a130, 0
    v_accvgpr_write_b32 a131, 0
    v_accvgpr_write_b32 a132, 0
    v_accvgpr_write_b32 a133, 0
    v_accvgpr_write_b32 a134, 0
    v_accvgpr_write_b32 a135, 0
    v_accvgpr_write_b32 a136, 0
    v_accvgpr_write_b32 a137, 0
    v_accvgpr_write_b32 a138, 0
    v_accvgpr_write_b32 a139, 0
    v_accvgpr_write_b32 a140, 0
    v_accvgpr_write_b32 a141, 0
    v_accvgpr_write_b32 a142, 0
    v_accvgpr_write_b32 a143, 0
    v_accvgpr_write_b32 a144, 0
    v_accvgpr_write_b32 a145, 0
    v_accvgpr_write_b32 a146, 0
    v_accvgpr_write_b32 a147, 0
    v_accvgpr_write_b32 a148, 0
    v_accvgpr_write_b32 a149, 0
    v_accvgpr_write_b32 a150, 0
    v_accvgpr_write_b32 a151, 0
    v_accvgpr_write_b32 a152, 0
    v_accvgpr_write_b32 a153, 0
    v_accvgpr_write_b32 a154, 0
    v_accvgpr_write_b32 a155, 0
    v_accvgpr_write_b32 a156, 0
    v_accvgpr_write_b32 a157, 0
    v_accvgpr_write_b32 a158, 0
    v_accvgpr_write_b32 a159, 0
    v_accvgpr_write_b32 a160, 0
    v_accvgpr_write_b32 a161, 0
    v_accvgpr_write_b32 a162, 0
    v_accvgpr_write_b32 a163, 0
    v_accvgpr_write_b32 a164, 0
    v_accvgpr_write_b32 a165, 0
    v_accvgpr_write_b32 a166, 0
    v_accvgpr_write_b32 a167, 0
    v_accvgpr_write_b32 a168, 0
    v_accvgpr_write_b32 a169, 0
    v_accvgpr_write_b32 a170, 0
    v_accvgpr_write_b32 a171, 0
    v_accvgpr_write_b32 a172, 0
    v_accvgpr_write_b32 a173, 0
    v_accvgpr_write_b32 a174, 0
    v_accvgpr_write_b32 a175, 0
    v_accvgpr_write_b32 a176, 0
    v_accvgpr_write_b32 a177, 0
    v_accvgpr_write_b32 a178, 0
    v_accvgpr_write_b32 a179, 0
    v_accvgpr_write_b32 a180, 0
    v_accvgpr_write_b32 a181, 0
    v_accvgpr_write_b32 a182, 0
    v_accvgpr_write_b32 a183, 0
    v_accvgpr_write_b32 a184, 0
    v_accvgpr_write_b32 a185, 0
    v_accvgpr_write_b32 a186, 0
    v_accvgpr_write_b32 a187, 0
    v_accvgpr_write_b32 a188, 0
    v_accvgpr_write_b32 a189, 0
    v_accvgpr_write_b32 a190, 0
    v_accvgpr_write_b32 a191, 0
    s_waitcnt vmcnt(27)
    ds_write_b128 v179, a[192:195]
    s_waitcnt vmcnt(26)
    ds_write_b128 v179, a[196:199] offset:1024
    s_waitcnt vmcnt(25)
    ds_write_b128 v179, a[200:203] offset:2048
    s_waitcnt vmcnt(24)
    ds_write_b128 v179, a[204:207] offset:3072
    s_waitcnt vmcnt(23)
    ds_write_b128 v179, a[208:211] offset:4096
    s_waitcnt vmcnt(22)
    ds_write_b128 v179, a[212:215] offset:5120
    s_waitcnt vmcnt(21)
    ds_write_b128 v179, a[216:219] offset:6144
    s_waitcnt vmcnt(20)
    ds_write_b128 v179, a[220:223] offset:7168
    ds_read_b64_tr_b16 v[96:97], v162
    ds_read_b64_tr_b16 v[98:99], v162 offset:4096
    ds_read_b64_tr_b16 v[100:101], v163
    ds_read_b64_tr_b16 v[102:103], v163 offset:4096
    ds_read_b64_tr_b16 v[104:105], v164
    ds_read_b64_tr_b16 v[106:107], v164 offset:4096
    ds_read_b64_tr_b16 v[108:109], v165
    ds_read_b64_tr_b16 v[110:111], v165 offset:4096
    ds_read_b64_tr_b16 v[112:113], v166
    ds_read_b64_tr_b16 v[114:115], v166 offset:4096
    ds_read_b64_tr_b16 v[116:117], v167
    ds_read_b64_tr_b16 v[118:119], v167 offset:4096
    ds_read_b64_tr_b16 v[120:121], v168
    ds_read_b64_tr_b16 v[122:123], v168 offset:4096
    ds_read_b64_tr_b16 v[124:125], v169
    ds_read_b64_tr_b16 v[126:127], v169 offset:4096
    s_nop 9
L_k2_loop:
    s_waitcnt vmcnt(13)
    buffer_load_dwordx4 a[192:195], v160, s[12:15], s31 offen
    s_add_u32 s35, s31, 5120
    s_waitcnt vmcnt(13)
    buffer_load_dwordx4 a[196:199], v161, s[12:15], s35 offen
    s_add_u32 s35, s31, 10240
    s_waitcnt vmcnt(13)
    buffer_load_dwordx4 a[200:203], v160, s[12:15], s35 offen
    s_add_u32 s35, s31, 15360
    s_waitcnt vmcnt(13)
    buffer_load_dwordx4 a[204:207], v161, s[12:15], s35 offen
    s_add_u32 s35, s31, 20480
    s_waitcnt vmcnt(13)
    buffer_load_dwordx4 a[208:211], v160, s[12:15], s35 offen
    s_add_u32 s35, s31, 25600
    s_waitcnt vmcnt(13)
    buffer_load_dwordx4 a[212:215], v161, s[12:15], s35 offen
    s_add_u32 s35, s31, 30720
    s_waitcnt vmcnt(13)
    buffer_load_dwordx4 a[216:219], v160, s[12:15], s35 offen
    s_add_u32 s35, s31, 35840
    s_waitcnt vmcnt(13)
    buffer_load_dwordx4 a[220:223], v161, s[12:15], s35 offen
    s_add_u32 s31, s31, 40960
    s_waitcnt vmcnt(13)
    buffer_load_dwordx4 v[72:75], v170, s[16:19], s28 offen
    s_waitcnt vmcnt(13)
    buffer_load_dwordx4 v[76:79], v170, s[16:19], s28 offen offset:1024
    s_waitcnt vmcnt(13)
    buffer_load_dwordx4 v[80:83], v170, s[16:19], s28 offen offset:2048
    s_waitcnt vmcnt(13)
    buffer_load_dwordx4 v[84:87], v170, s[16:19], s28 offen offset:3072
    s_waitcnt vmcnt(13)
    buffer_load_dwordx4 v[88:91], v170, s[16:19], s29 offen
    s_waitcnt vmcnt(13)
    buffer_load_dwordx4 v[92:95], v170, s[16:19], s29 offen offset:1024
    s_add_u32 s28, s28, 147456
    s_add_u32 s29, s29, 147456
    s_waitcnt lgkmcnt(14)
    v_mfma_f32_16x16x32_bf16 a[0:3], v[96:99], v[0:3], a[0:3]
    s_waitcnt lgkmcnt(12)
    v_mfma_f32_16x16x32_bf16 a[24:27], v[100:103], v[0:3], a[24:27]
    s_waitcnt lgkmcnt(10)
    v_mfma_f32_16x16x32_bf16 a[48:51], v[104:107], v[0:3], a[48:51]
    s_waitcnt lgkmcnt(8)
    v_mfma_f32_16x16x32_bf16 a[72:75], v[108:111], v[0:3], a[72:75]
    s_waitcnt lgkmcnt(6)
    v_mfma_f32_16x16x32_bf16 a[96:99], v[112:115], v[0:3], a[96:99]
    s_waitcnt lgkmcnt(4)
    v_mfma_f32_16x16x32_bf16 a[120:123], v[116:119], v[0:3], a[120:123]
    s_waitcnt lgkmcnt(2)
    v_mfma_f32_16x16x32_bf16 a[144:147], v[120:123], v[0:3], a[144:147]
    s_waitcnt lgkmcnt(0)
    v_mfma_f32_16x16x32_bf16 a[168:171], v[124:127], v[0:3], a[168:171]
    v_mfma_f32_16x16x32_bf16 a[4:7], v[96:99], v[4:7], a[4:7]
    v_mfma_f32_16x16x32_bf16 a[28:31], v[100:103], v[4:7], a[28:31]
    v_mfma_f32_16x16x32_bf16 a[52:55], v[104:107], v[4:7], a[52:55]
    v_mfma_f32_16x16x32_bf16 a[76:79], v[108:111], v[4:7], a[76:79]
    v_mfma_f32_16x16x32_bf16 a[100:103], v[112:115], v[4:7], a[100:103]
    v_mfma_f32_16x16x32_bf16 a[124:127], v[116:119], v[4:7], a[124:127]
    v_mfma_f32_16x16x32_bf16 a[148:151], v[120:123], v[4:7], a[148:151]
    v_mfma_f32_16x16x32_bf16 a[172:175], v[124:127], v[4:7], a[172:175]
    ds_write_b128 v179, a[224:227] offset:8192
    ds_write_b128 v179, a[228:231] offset:9216
    ds_write_b128 v179, a[232:235] offset:10240
    ds_write_b128 v179, a[236:239] offset:11264
    ds_write_b128 v179, a[240:243] offset:12288
    ds_write_b128 v179, a[244:247] offset:13312
    ds_write_b128 v179, a[248:251] offset:14336
    ds_write_b128 v179, a[252:255] offset:15360
    v_mfma_f32_16x16x32_bf16 a[8:11], v[96:99], v[8:11], a[8:11]
    v_mfma_f32_16x16x32_bf16 a[32:35], v[100:103], v[8:11], a[32:35]
    v_mfma_f32_16x16x32_bf16 a[56:59], v[104:107], v[8:11], a[56:59]
    v_mfma_f32_16x16x32_bf16 a[80:83], v[108:111], v[8:11], a[80:83]
    v_mfma_f32_16x16x32_bf16 a[104:107], v[112:115], v[8:11], a[104:107]
    v_mfma_f32_16x16x32_bf16 a[128:131], v[116:119], v[8:11], a[128:131]
    v_mfma_f32_16x16x32_bf16 a[152:155], v[120:123], v[8:11], a[152:155]
    v_mfma_f32_16x16x32_bf16 a[176:179], v[124:127], v[8:11], a[176:179]
    v_mfma_f32_16x16x32_bf16 a[12:15], v[96:99], v[12:15], a[12:15]
    v_mfma_f32_16x16x32_bf16 a[36:39], v[100:103], v[12:15], a[36:39]
    v_mfma_f32_16x16x32_bf16 a[60:63], v[104:107], v[12:15], a[60:63]
    v_mfma_f32_16x16x32_bf16 a[84:87], v[108:111], v[12:15], a[84:87]
    ds_read_b64_tr_b16 v[128:129], v162 offset:8192
    ds_read_b64_tr_b16 v[130:131], v162 offset:12288
    ds_read_b64_tr_b16 v[132:133], v163 offset:8192
    ds_read_b64_tr_b16 v[134:135], v163 offset:12288
    ds_read_b64_tr_b16 v[136:137], v164 offset:8192
    ds_read_b64_tr_b16 v[138:139], v164 offset:12288
    ds_read_b64_tr_b16 v[140:141], v165 offset:8192
    ds_read_b64_tr_b16 v[142:143], v165 offset:12288
    ds_read_b64_tr_b16 v[144:145], v166 offset:8192
    ds_read_b64_tr_b16 v[146:147], v166 offset:12288
    ds_read_b64_tr_b16 v[148:149], v167 offset:8192
    ds_read_b64_tr_b16 v[150:151], v167 offset:12288
    ds_read_b64_tr_b16 v[152:153], v168 offset:8192
    ds_read_b64_tr_b16 v[154:155], v168 offset:12288
    ds_read_b64_tr_b16 v[156:157], v169 offset:8192
    ds_read_b64_tr_b16 v[158:159], v169 offset:12288
    v_mfma_f32_16x16x32_bf16 a[108:111], v[112:115], v[12:15], a[108:111]
    v_mfma_f32_16x16x32_bf16 a[132:135], v[116:119], v[12:15], a[132:135]
    v_mfma_f32_16x16x32_bf16 a[156:159], v[120:123], v[12:15], a[156:159]
    v_mfma_f32_16x16x32_bf16 a[180:183], v[124:127], v[12:15], a[180:183]
    v_mfma_f32_16x16x32_bf16 a[16:19], v[96:99], v[16:19], a[16:19]
    v_mfma_f32_16x16x32_bf16 a[40:43], v[100:103], v[16:19], a[40:43]
    v_mfma_f32_16x16x32_bf16 a[64:67], v[104:107], v[16:19], a[64:67]
    v_mfma_f32_16x16x32_bf16 a[88:91], v[108:111], v[16:19], a[88:91]
    v_mfma_f32_16x16x32_bf16 a[112:115], v[112:115], v[16:19], a[112:115]
    v_mfma_f32_16x16x32_bf16 a[136:139], v[116:119], v[16:19], a[136:139]
    v_mfma_f32_16x16x32_bf16 a[160:163], v[120:123], v[16:19], a[160:163]
    v_mfma_f32_16x16x32_bf16 a[184:187], v[124:127], v[16:19], a[184:187]
    v_mfma_f32_16x16x32_bf16 a[20:23], v[96:99], v[20:23], a[20:23]
    v_mfma_f32_16x16x32_bf16 a[44:47], v[100:103], v[20:23], a[44:47]
    v_mfma_f32_16x16x32_bf16 a[68:71], v[104:107], v[20:23], a[68:71]
    v_mfma_f32_16x16x32_bf16 a[92:95], v[108:111], v[20:23], a[92:95]
    v_mfma_f32_16x16x32_bf16 a[116:119], v[112:115], v[20:23], a[116:119]
    v_mfma_f32_16x16x32_bf16 a[140:143], v[116:119], v[20:23], a[140:143]
    v_mfma_f32_16x16x32_bf16 a[164:167], v[120:123], v[20:23], a[164:167]
    v_mfma_f32_16x16x32_bf16 a[188:191], v[124:127], v[20:23], a[188:191]
    buffer_load_dwordx4 a[224:227], v160, s[12:15], s31 offen
    s_add_u32 s35, s31, 5120
    buffer_load_dwordx4 a[228:231], v161, s[12:15], s35 offen
    s_add_u32 s35, s31, 10240
    buffer_load_dwordx4 a[232:235], v160, s[12:15], s35 offen
    s_add_u32 s35, s31, 15360
    buffer_load_dwordx4 a[236:239], v161, s[12:15], s35 offen
    s_add_u32 s35, s31, 20480
    buffer_load_dwordx4 a[240:243], v160, s[12:15], s35 offen
    s_add_u32 s35, s31, 25600
    buffer_load_dwordx4 a[244:247], v161, s[12:15], s35 offen
    s_add_u32 s35, s31, 30720
    buffer_load_dwordx4 a[248:251], v160, s[12:15], s35 offen
    s_add_u32 s35, s31, 35840
    buffer_load_dwordx4 a[252:255], v161, s[12:15], s35 offen
    s_add_u32 s31, s31, 40960
    buffer_load_dwordx4 v[0:3], v170, s[16:19], s28 offen
    buffer_load_dwordx4 v[4:7], v170, s[16:19], s28 offen offset:1024
    buffer_load_dwordx4 v[8:11], v170, s[16:19], s28 offen offset:2048
    buffer_load_dwordx4 v[12:15], v170, s[16:19], s28 offen offset:3072
    buffer_load_dwordx4 v[16:19], v170, s[16:19], s29 offen
    buffer_load_dwordx4 v[20:23], v170, s[16:19], s29 offen offset:1024
    s_add_u32 s28, s28, 147456
    s_add_u32 s29, s29, 147456
    s_waitcnt lgkmcnt(14)
    v_mfma_f32_16x16x32_bf16 a[0:3], v[128:131], v[24:27], a[0:3]
    s_waitcnt lgkmcnt(12)
    v_mfma_f32_16x16x32_bf16 a[24:27], v[132:135], v[24:27], a[24:27]
    s_waitcnt lgkmcnt(10)
    v_mfma_f32_16x16x32_bf16 a[48:51], v[136:139], v[24:27], a[48:51]
    s_waitcnt lgkmcnt(8)
    v_mfma_f32_16x16x32_bf16 a[72:75], v[140:143], v[24:27], a[72:75]
    s_waitcnt lgkmcnt(6)
    v_mfma_f32_16x16x32_bf16 a[96:99], v[144:147], v[24:27], a[96:99]
    s_waitcnt lgkmcnt(4)
    v_mfma_f32_16x16x32_bf16 a[120:123], v[148:151], v[24:27], a[120:123]
    s_waitcnt lgkmcnt(2)
    v_mfma_f32_16x16x32_bf16 a[144:147], v[152:155], v[24:27], a[144:147]
    s_waitcnt lgkmcnt(0)
    v_mfma_f32_16x16x32_bf16 a[168:171], v[156:159], v[24:27], a[168:171]
    v_mfma_f32_16x16x32_bf16 a[4:7], v[128:131], v[28:31], a[4:7]
    v_mfma_f32_16x16x32_bf16 a[28:31], v[132:135], v[28:31], a[28:31]
    v_mfma_f32_16x16x32_bf16 a[52:55], v[136:139], v[28:31], a[52:55]
    v_mfma_f32_16x16x32_bf16 a[76:79], v[140:143], v[28:31], a[76:79]
    v_mfma_f32_16x16x32_bf16 a[100:103], v[144:147], v[28:31], a[100:103]
    v_mfma_f32_16x16x32_bf16 a[124:127], v[148:151], v[28:31], a[124:127]
    v_mfma_f32_16x16x32_bf16 a[148:151], v[152:155], v[28:31], a[148:151]
    v_mfma_f32_16x16x32_bf16 a[172:175], v[156:159], v[28:31], a[172:175]
    s_waitcnt vmcnt(27)
    ds_write_b128 v179, a[192:195]
    s_waitcnt vmcnt(26)
    ds_write_b128 v179, a[196:199] offset:1024
    s_waitcnt vmcnt(25)
    ds_write_b128 v179, a[200:203] offset:2048
    s_waitcnt vmcnt(24)
    ds_write_b128 v179, a[204:207] offset:3072
    s_waitcnt vmcnt(23)
    ds_write_b128 v179, a[208:211] offset:4096
    s_waitcnt vmcnt(22)
    ds_write_b128 v179, a[212:215] offset:5120
    s_waitcnt vmcnt(21)
    ds_write_b128 v179, a[216:219] offset:6144
    s_waitcnt vmcnt(20)
    ds_write_b128 v179, a[220:223] offset:7168
    v_mfma_f32_16x16x32_bf16 a[8:11], v[128:131], v[32:35], a[8:11]
    v_mfma_f32_16x16x32_bf16 a[32:35], v[132:135], v[32:35], a[32:35]
    v_mfma_f32_16x16x32_bf16 a[56:59], v[136:139], v[32:35], a[56:59]
    v_mfma_f32_16x16x32_bf16 a[80:83], v[140:143], v[32:35], a[80:83]
    v_mfma_f32_16x16x32_bf16 a[104:107], v[144:147], v[32:35], a[104:107]
    v_mfma_f32_16x16x32_bf16 a[128:131], v[148:151], v[32:35], a[128:131]
    v_mfma_f32_16x16x32_bf16 a[152:155], v[152:155], v[32:35], a[152:155]
    v_mfma_f32_16x16x32_bf16 a[176:179], v[156:159], v[32:35], a[176:179]
    v_mfma_f32_16x16x32_bf16 a[12:15], v[128:131], v[36:39], a[12:15]
    v_mfma_f32_16x16x32_bf16 a[36:39], v[132:135], v[36:39], a[36:39]
    v_mfma_f32_16x16x32_bf16 a[60:63], v[136:139], v[36:39], a[60:63]
    v_mfma_f32_16x16x32_bf16 a[84:87], v[140:143], v[36:39], a[84:87]
    ds_read_b64_tr_b16 v[96:97], v162
    ds_read_b64_tr_b16 v[98:99], v162 offset:4096
    ds_read_b64_tr_b16 v[100:101], v163
    ds_read_b64_tr_b16 v[102:103], v163 offset:4096
    ds_read_b64_tr_b16 v[104:105], v164
    ds_read_b64_tr_b16 v[106:107], v164 offset:4096
    ds_read_b64_tr_b16 v[108:109], v165
    ds_read_b64_tr_b16 v[110:111], v165 offset:4096
    ds_read_b64_tr_b16 v[112:113], v166
    ds_read_b64_tr_b16 v[114:115], v166 offset:4096
    ds_read_b64_tr_b16 v[116:117], v167
    ds_read_b64_tr_b16 v[118:119], v167 offset:4096
    ds_read_b64_tr_b16 v[120:121], v168
    ds_read_b64_tr_b16 v[122:123], v168 offset:4096
    ds_read_b64_tr_b16 v[124:125], v169
    ds_read_b64_tr_b16 v[126:127], v169 offset:4096
    v_mfma_f32_16x16x32_bf16 a[108:111], v[144:147], v[36:39], a[108:111]
    v_mfma_f32_16x16x32_bf16 a[132:135], v[148:151], v[36:39], a[132:135]
    v_mfma_f32_16x16x32_bf16 a[156:159], v[152:155], v[36:39], a[156:159]
    v_mfma_f32_16x16x32_bf16 a[180:183], v[156:159], v[36:39], a[180:183]
    v_mfma_f32_16x16x32_bf16 a[16:19], v[128:131], v[40:43], a[16:19]
    v_mfma_f32_16x16x32_bf16 a[40:43], v[132:135], v[40:43], a[40:43]
    v_mfma_f32_16x16x32_bf16 a[64:67], v[136:139], v[40:43], a[64:67]
    v_mfma_f32_16x16x32_bf16 a[88:91], v[140:143], v[40:43], a[88:91]
    v_mfma_f32_16x16x32_bf16 a[112:115], v[144:147], v[40:43], a[112:115]
    v_mfma_f32_16x16x32_bf16 a[136:139], v[148:151], v[40:43], a[136:139]
    v_mfma_f32_16x16x32_bf16 a[160:163], v[152:155], v[40:43], a[160:163]
    v_mfma_f32_16x16x32_bf16 a[184:187], v[156:159], v[40:43], a[184:187]
    v_mfma_f32_16x16x32_bf16 a[20:23], v[128:131], v[44:47], a[20:23]
    v_mfma_f32_16x16x32_bf16 a[44:47], v[132:135], v[44:47], a[44:47]
    v_mfma_f32_16x16x32_bf16 a[68:71], v[136:139], v[44:47], a[68:71]
    v_mfma_f32_16x16x32_bf16 a[92:95], v[140:143], v[44:47], a[92:95]
    v_mfma_f32_16x16x32_bf16 a[116:119], v[144:147], v[44:47], a[116:119]
    v_mfma_f32_16x16x32_bf16 a[140:143], v[148:151], v[44:47], a[140:143]
    v_mfma_f32_16x16x32_bf16 a[164:167], v[152:155], v[44:47], a[164:167]
    v_mfma_f32_16x16x32_bf16 a[188:191], v[156:159], v[44:47], a[188:191]
    buffer_load_dwordx4 a[192:195], v160, s[12:15], s31 offen
    s_add_u32 s35, s31, 5120
    buffer_load_dwordx4 a[196:199], v161, s[12:15], s35 offen
    s_add_u32 s35, s31, 10240
    buffer_load_dwordx4 a[200:203], v160, s[12:15], s35 offen
    s_add_u32 s35, s31, 15360
    buffer_load_dwordx4 a[204:207], v161, s[12:15], s35 offen
    s_add_u32 s35, s31, 20480
    buffer_load_dwordx4 a[208:211], v160, s[12:15], s35 offen
    s_add_u32 s35, s31, 25600
    buffer_load_dwordx4 a[212:215], v161, s[12:15], s35 offen
    s_add_u32 s35, s31, 30720
    buffer_load_dwordx4 a[216:219], v160, s[12:15], s35 offen
    s_add_u32 s35, s31, 35840
    buffer_load_dwordx4 a[220:223], v161, s[12:15], s35 offen
    s_add_u32 s31, s31, 40960
    buffer_load_dwordx4 v[24:27], v170, s[16:19], s28 offen
    buffer_load_dwordx4 v[28:31], v170, s[16:19], s28 offen offset:1024
    buffer_load_dwordx4 v[32:35], v170, s[16:19], s28 offen offset:2048
    buffer_load_dwordx4 v[36:39], v170, s[16:19], s28 offen offset:3072
    buffer_load_dwordx4 v[40:43], v170, s[16:19], s29 offen
    buffer_load_dwordx4 v[44:47], v170, s[16:19], s29 offen offset:1024
    s_add_u32 s28, s28, 147456
    s_add_u32 s29, s29, 147456
    s_waitcnt lgkmcnt(14)
    v_mfma_f32_16x16x32_bf16 a[0:3], v[96:99], v[48:51], a[0:3]
    s_waitcnt lgkmcnt(12)
    v_mfma_f32_16x16x32_bf16 a[24:27], v[100:103], v[48:51], a[24:27]
    s_waitcnt lgkmcnt(10)
    v_mfma_f32_16x16x32_bf16 a[48:51], v[104:107], v[48:51], a[48:51]
    s_waitcnt lgkmcnt(8)
    v_mfma_f32_16x16x32_bf16 a[72:75], v[108:111], v[48:51], a[72:75]
    s_waitcnt lgkmcnt(6)
    v_mfma_f32_16x16x32_bf16 a[96:99], v[112:115], v[48:51], a[96:99]
    s_waitcnt lgkmcnt(4)
    v_mfma_f32_16x16x32_bf16 a[120:123], v[116:119], v[48:51], a[120:123]
    s_waitcnt lgkmcnt(2)
    v_mfma_f32_16x16x32_bf16 a[144:147], v[120:123], v[48:51], a[144:147]
    s_waitcnt lgkmcnt(0)
    v_mfma_f32_16x16x32_bf16 a[168:171], v[124:127], v[48:51], a[168:171]
    v_mfma_f32_16x16x32_bf16 a[4:7], v[96:99], v[52:55], a[4:7]
    v_mfma_f32_16x16x32_bf16 a[28:31], v[100:103], v[52:55], a[28:31]
    v_mfma_f32_16x16x32_bf16 a[52:55], v[104:107], v[52:55], a[52:55]
    v_mfma_f32_16x16x32_bf16 a[76:79], v[108:111], v[52:55], a[76:79]
    v_mfma_f32_16x16x32_bf16 a[100:103], v[112:115], v[52:55], a[100:103]
    v_mfma_f32_16x16x32_bf16 a[124:127], v[116:119], v[52:55], a[124:127]
    v_mfma_f32_16x16x32_bf16 a[148:151], v[120:123], v[52:55], a[148:151]
    v_mfma_f32_16x16x32_bf16 a[172:175], v[124:127], v[52:55], a[172:175]
    s_waitcnt vmcnt(27)
    ds_write_b128 v179, a[224:227] offset:8192
    s_waitcnt vmcnt(26)
    ds_write_b128 v179, a[228:231] offset:9216
    s_waitcnt vmcnt(25)
    ds_write_b128 v179, a[232:235] offset:10240
    s_waitcnt vmcnt(24)
    ds_write_b128 v179, a[236:239] offset:11264
    s_waitcnt vmcnt(23)
    ds_write_b128 v179, a[240:243] offset:12288
    s_waitcnt vmcnt(22)
    ds_write_b128 v179, a[244:247] offset:13312
    s_waitcnt vmcnt(21)
    ds_write_b128 v179, a[248:251] offset:14336
    s_waitcnt vmcnt(20)
    ds_write_b128 v179, a[252:255] offset:15360
    v_mfma_f32_16x16x32_bf16 a[8:11], v[96:99], v[56:59], a[8:11]
    v_mfma_f32_16x16x32_bf16 a[32:35], v[100:103], v[56:59], a[32:35]
    v_mfma_f32_16x16x32_bf16 a[56:59], v[104:107], v[56:59], a[56:59]
    v_mfma_f32_16x16x32_bf16 a[80:83], v[108:111], v[56:59], a[80:83]
    v_mfma_f32_16x16x32_bf16 a[104:107], v[112:115], v[56:59], a[104:107]
    v_mfma_f32_16x16x32_bf16 a[128:131], v[116:119], v[56:59], a[128:131]
    v_mfma_f32_16x16x32_bf16 a[152:155], v[120:123], v[56:59], a[152:155]
    v_mfma_f32_16x16x32_bf16 a[176:179], v[124:127], v[56:59], a[176:179]
    v_mfma_f32_16x16x32_bf16 a[12:15], v[96:99], v[60:63], a[12:15]
    v_mfma_f32_16x16x32_bf16 a[36:39], v[100:103], v[60:63], a[36:39]
    v_mfma_f32_16x16x32_bf16 a[60:63], v[104:107], v[60:63], a[60:63]
    v_mfma_f32_16x16x32_bf16 a[84:87], v[108:111], v[60:63], a[84:87]
    ds_read_b64_tr_b16 v[128:129], v162 offset:8192
    ds_read_b64_tr_b16 v[130:131], v162 offset:12288
    ds_read_b64_tr_b16 v[132:133], v163 offset:8192
    ds_read_b64_tr_b16 v[134:135], v163 offset:12288
    ds_read_b64_tr_b16 v[136:137], v164 offset:8192
    ds_read_b64_tr_b16 v[138:139], v164 offset:12288
    ds_read_b64_tr_b16 v[140:141], v165 offset:8192
    ds_read_b64_tr_b16 v[142:143], v165 offset:12288
    ds_read_b64_tr_b16 v[144:145], v166 offset:8192
    ds_read_b64_tr_b16 v[146:147], v166 offset:12288
    ds_read_b64_tr_b16 v[148:149], v167 offset:8192
    ds_read_b64_tr_b16 v[150:151], v167 offset:12288
    ds_read_b64_tr_b16 v[152:153], v168 offset:8192
    ds_read_b64_tr_b16 v[154:155], v168 offset:12288
    ds_read_b64_tr_b16 v[156:157], v169 offset:8192
    ds_read_b64_tr_b16 v[158:159], v169 offset:12288
    v_mfma_f32_16x16x32_bf16 a[108:111], v[112:115], v[60:63], a[108:111]
    v_mfma_f32_16x16x32_bf16 a[132:135], v[116:119], v[60:63], a[132:135]
    v_mfma_f32_16x16x32_bf16 a[156:159], v[120:123], v[60:63], a[156:159]
    v_mfma_f32_16x16x32_bf16 a[180:183], v[124:127], v[60:63], a[180:183]
    v_mfma_f32_16x16x32_bf16 a[16:19], v[96:99], v[64:67], a[16:19]
    v_mfma_f32_16x16x32_bf16 a[40:43], v[100:103], v[64:67], a[40:43]
    v_mfma_f32_16x16x32_bf16 a[64:67], v[104:107], v[64:67], a[64:67]
    v_mfma_f32_16x16x32_bf16 a[88:91], v[108:111], v[64:67], a[88:91]
    v_mfma_f32_16x16x32_bf16 a[112:115], v[112:115], v[64:67], a[112:115]
    v_mfma_f32_16x16x32_bf16 a[136:139], v[116:119], v[64:67], a[136:139]
    v_mfma_f32_16x16x32_bf16 a[160:163], v[120:123], v[64:67], a[160:163]
    v_mfma_f32_16x16x32_bf16 a[184:187], v[124:127], v[64:67], a[184:187]
    v_mfma_f32_16x16x32_bf16 a[20:23], v[96:99], v[68:71], a[20:23]
    v_mfma_f32_16x16x32_bf16 a[44:47], v[100:103], v[68:71], a[44:47]
    v_mfma_f32_16x16x32_bf16 a[68:71], v[104:107], v[68:71], a[68:71]
    v_mfma_f32_16x16x32_bf16 a[92:95], v[108:111], v[68:71], a[92:95]
    v_mfma_f32_16x16x32_bf16 a[116:119], v[112:115], v[68:71], a[116:119]
    v_mfma_f32_16x16x32_bf16 a[140:143], v[116:119], v[68:71], a[140:143]
    v_mfma_f32_16x16x32_bf16 a[164:167], v[120:123], v[68:71], a[164:167]
    v_mfma_f32_16x16x32_bf16 a[188:191], v[124:127], v[68:71], a[188:191]
    buffer_load_dwordx4 a[224:227], v160, s[12:15], s31 offen
    s_add_u32 s35, s31, 5120
    buffer_load_dwordx4 a[228:231], v161, s[12:15], s35 offen
    s_add_u32 s35, s31, 10240
    buffer_load_dwordx4 a[232:235], v160, s[12:15], s35 offen
    s_add_u32 s35, s31, 15360
    buffer_load_dwordx4 a[236:239], v161, s[12:15], s35 offen
    s_add_u32 s35, s31, 20480
    buffer_load_dwordx4 a[240:243], v160, s[12:15], s35 offen
    s_add_u32 s35, s31, 25600
    buffer_load_dwordx4 a[244:247], v161, s[12:15], s35 offen
    s_add_u32 s35, s31, 30720
    buffer_load_dwordx4 a[248:251], v160, s[12:15], s35 offen
    s_add_u32 s35, s31, 35840
    buffer_load_dwordx4 a[252:255], v161, s[12:15], s35 offen
    s_add_u32 s31, s31, 40960
    buffer_load_dwordx4 v[48:51], v170, s[16:19], s28 offen
    buffer_load_dwordx4 v[52:55], v170, s[16:19], s28 offen offset:1024
    buffer_load_dwordx4 v[56:59], v170, s[16:19], s28 offen offset:2048
    buffer_load_dwordx4 v[60:63], v170, s[16:19], s28 offen offset:3072
    buffer_load_dwordx4 v[64:67], v170, s[16:19], s29 offen
    buffer_load_dwordx4 v[68:71], v170, s[16:19], s29 offen offset:1024
    s_add_u32 s28, s28, 147456
    s_add_u32 s29, s29, 147456
    s_waitcnt lgkmcnt(14)
    v_mfma_f32_16x16x32_bf16 a[0:3], v[128:131], v[72:75], a[0:3]
    s_waitcnt lgkmcnt(12)
    v_mfma_f32_16x16x32_bf16 a[24:27], v[132:135], v[72:75], a[24:27]
    s_waitcnt lgkmcnt(10)
    v_mfma_f32_16x16x32_bf16 a[48:51], v[136:139], v[72:75], a[48:51]
    s_waitcnt lgkmcnt(8)
    v_mfma_f32_16x16x32_bf16 a[72:75], v[140:143], v[72:75], a[72:75]
    s_waitcnt lgkmcnt(6)
    v_mfma_f32_16x16x32_bf16 a[96:99], v[144:147], v[72:75], a[96:99]
    s_waitcnt lgkmcnt(4)
    v_mfma_f32_16x16x32_bf16 a[120:123], v[148:151], v[72:75], a[120:123]
    s_waitcnt lgkmcnt(2)
    v_mfma_f32_16x16x32_bf16 a[144:147], v[152:155], v[72:75], a[144:147]
    s_waitcnt lgkmcnt(0)
    v_mfma_f32_16x16x32_bf16 a[168:171], v[156:159], v[72:75], a[168:171]
    v_mfma_f32_16x16x32_bf16 a[4:7], v[128:131], v[76:79], a[4:7]
    v_mfma_f32_16x16x32_bf16 a[28:31], v[132:135], v[76:79], a[28:31]
    v_mfma_f32_16x16x32_bf16 a[52:55], v[136:139], v[76:79], a[52:55]
    v_mfma_f32_16x16x32_bf16 a[76:79], v[140:143], v[76:79], a[76:79]
    v_mfma_f32_16x16x32_bf16 a[100:103], v[144:147], v[76:79], a[100:103]
    v_mfma_f32_16x16x32_bf16 a[124:127], v[148:151], v[76:79], a[124:127]
    v_mfma_f32_16x16x32_bf16 a[148:151], v[152:155], v[76:79], a[148:151]
    v_mfma_f32_16x16x32_bf16 a[172:175], v[156:159], v[76:79], a[172:175]
    s_waitcnt vmcnt(27)
    ds_write_b128 v179, a[192:195]
    s_waitcnt vmcnt(26)
    ds_write_b128 v179, a[196:199] offset:1024
    s_waitcnt vmcnt(25)
    ds_write_b128 v179, a[200:203] offset:2048
    s_waitcnt vmcnt(24)
    ds_write_b128 v179, a[204:207] offset:3072
    s_waitcnt vmcnt(23)
    ds_write_b128 v179, a[208:211] offset:4096
    s_waitcnt vmcnt(22)
    ds_write_b128 v179, a[212:215] offset:5120
    s_waitcnt vmcnt(21)
    ds_write_b128 v179, a[216:219] offset:6144
    s_waitcnt vmcnt(20)
    ds_write_b128 v179, a[220:223] offset:7168
    v_mfma_f32_16x16x32_bf16 a[8:11], v[128:131], v[80:83], a[8:11]
    v_mfma_f32_16x16x32_bf16 a[32:35], v[132:135], v[80:83], a[32:35]
    v_mfma_f32_16x16x32_bf16 a[56:59], v[136:139], v[80:83], a[56:59]
    v_mfma_f32_16x16x32_bf16 a[80:83], v[140:143], v[80:83], a[80:83]
    v_mfma_f32_16x16x32_bf16 a[104:107], v[144:147], v[80:83], a[104:107]
    v_mfma_f32_16x16x32_bf16 a[128:131], v[148:151], v[80:83], a[128:131]
    v_mfma_f32_16x16x32_bf16 a[152:155], v[152:155], v[80:83], a[152:155]
    v_mfma_f32_16x16x32_bf16 a[176:179], v[156:159], v[80:83], a[176:179]
    v_mfma_f32_16x16x32_bf16 a[12:15], v[128:131], v[84:87], a[12:15]
    v_mfma_f32_16x16x32_bf16 a[36:39], v[132:135], v[84:87], a[36:39]
    v_mfma_f32_16x16x32_bf16 a[60:63], v[136:139], v[84:87], a[60:63]
    v_mfma_f32_16x16x32_bf16 a[84:87], v[140:143], v[84:87], a[84:87]
    ds_read_b64_tr_b16 v[96:97], v162
    ds_read_b64_tr_b16 v[98:99], v162 offset:4096
    ds_read_b64_tr_b16 v[100:101], v163
    ds_read_b64_tr_b16 v[102:103], v163 offset:4096
    ds_read_b64_tr_b16 v[104:105], v164
    ds_read_b64_tr_b16 v[106:107], v164 offset:4096
    ds_read_b64_tr_b16 v[108:109], v165
    ds_read_b64_tr_b16 v[110:111], v165 offset:4096
    ds_read_b64_tr_b16 v[112:113], v166
    ds_read_b64_tr_b16 v[114:115], v166 offset:4096
    ds_read_b64_tr_b16 v[116:117], v167
    ds_read_b64_tr_b16 v[118:119], v167 offset:4096
    ds_read_b64_tr_b16 v[120:121], v168
    ds_read_b64_tr_b16 v[122:123], v168 offset:4096
    ds_read_b64_tr_b16 v[124:125], v169
    ds_read_b64_tr_b16 v[126:127], v169 offset:4096
    v_mfma_f32_16x16x32_bf16 a[108:111], v[144:147], v[84:87], a[108:111]
    v_mfma_f32_16x16x32_bf16 a[132:135], v[148:151], v[84:87], a[132:135]
    v_mfma_f32_16x16x32_bf16 a[156:159], v[152:155], v[84:87], a[156:159]
    v_mfma_f32_16x16x32_bf16 a[180:183], v[156:159], v[84:87], a[180:183]
    v_mfma_f32_16x16x32_bf16 a[16:19], v[128:131], v[88:91], a[16:19]
    v_mfma_f32_16x16x32_bf16 a[40:43], v[132:135], v[88:91], a[40:43]
    v_mfma_f32_16x16x32_bf16 a[64:67], v[136:139], v[88:91], a[64:67]
    v_mfma_f32_16x16x32_bf16 a[88:91], v[140:143], v[88:91], a[88:91]
    v_mfma_f32_16x16x32_bf16 a[112:115], v[144:147], v[88:91], a[112:115]
    v_mfma_f32_16x16x32_bf16 a[136:139], v[148:151], v[88:91], a[136:139]
    v_mfma_f32_16x16x32_bf16 a[160:163], v[152:155], v[88:91], a[160:163]
    v_mfma_f32_16x16x32_bf16 a[184:187], v[156:159], v[88:91], a[184:187]
    v_mfma_f32_16x16x32_bf16 a[20:23], v[128:131], v[92:95], a[20:23]
    v_mfma_f32_16x16x32_bf16 a[44:47], v[132:135], v[92:95], a[44:47]
    v_mfma_f32_16x16x32_bf16 a[68:71], v[136:139], v[92:95], a[68:71]
    v_mfma_f32_16x16x32_bf16 a[92:95], v[140:143], v[92:95], a[92:95]
    v_mfma_f32_16x16x32_bf16 a[116:119], v[144:147], v[92:95], a[116:119]
    v_mfma_f32_16x16x32_bf16 a[140:143], v[148:151], v[92:95], a[140:143]
    v_mfma_f32_16x16x32_bf16 a[164:167], v[152:155], v[92:95], a[164:167]
    v_mfma_f32_16x16x32_bf16 a[188:191], v[156:159], v[92:95], a[188:191]
    s_add_u32 s32, s32, 1
    s_cmp_lt_u32 s32, 12
    s_cbranch_scc1 L_k2_loop
    s_nop 9
    s_waitcnt vmcnt(0)
    s_waitcnt lgkmcnt(0)
    s_barrier
    v_lshlrev_b32 v176, 4, v171
    s_mul_i32 s35, s24, 24576
    v_add_u32 v177, s35, v176
    v_add_u32 v174, 49152, v176
    v_and_b32 v172, 15, v171
    v_mul_u32_u24 v172, 2560, v172
    v_lshrrev_b32 v173, 4, v171
    v_lshl_add_u32 v178, v173, 3, v172
    ds_write_b128 v177, a[0:3]
    ds_write_b128 v177, a[4:7] offset:1024
    ds_write_b128 v177, a[8:11] offset:2048
    ds_write_b128 v177, a[12:15] offset:3072
    ds_write_b128 v177, a[16:19] offset:4096
    ds_write_b128 v177, a[20:23] offset:5120
    ds_write_b128 v177, a[24:27] offset:6144
    ds_write_b128 v177, a[28:31] offset:7168
    ds_write_b128 v177, a[32:35] offset:8192
    ds_write_b128 v177, a[36:39] offset:9216
    ds_write_b128 v177, a[40:43] offset:10240
    ds_write_b128 v177, a[44:47] offset:11264
    ds_write_b128 v177, a[48:51] offset:12288
    ds_write_b128 v177, a[52:55] offset:13312
    ds_write_b128 v177, a[56:59] offset:14336
    ds_write_b128 v177, a[60:63] offset:15360
    ds_write_b128 v177, a[64:67] offset:16384
    ds_write_b128 v177, a[68:71] offset:17408
    ds_write_b128 v177, a[72:75] offset:18432
    ds_write_b128 v177, a[76:79] offset:19456
    ds_write_b128 v177, a[80:83] offset:20480
    ds_write_b128 v177, a[84:87] offset:21504
    ds_write_b128 v177, a[88:91] offset:22528
    ds_write_b128 v177, a[92:95] offset:23552
    s_waitcnt lgkmcnt(0)
    s_barrier
    s_cmp_lg_u32 s24, 0
    s_cbranch_scc1 L_k2_r0_w0
    ds_read_b128 v[0:3], v176
    ds_read_b128 v[4:7], v176 offset:24576
    ds_read_b128 v[8:11], v174
    ds_read_b128 v[12:15], v174 offset:24576
    ds_read_b128 v[16:19], v176 offset:4096
    ds_read_b128 v[20:23], v176 offset:28672
    ds_read_b128 v[24:27], v174 offset:4096
    ds_read_b128 v[28:31], v174 offset:28672
    ds_read_b128 v[32:35], v176 offset:8192
    ds_read_b128 v[36:39], v176 offset:32768
    ds_read_b128 v[40:43], v174 offset:8192
    ds_read_b128 v[44:47], v174 offset:32768
    ds_read_b128 v[48:51], v176 offset:12288
    ds_read_b128 v[52:55], v176 offset:36864
    ds_read_b128 v[56:59], v174 offset:12288
    ds_read_b128 v[60:63], v174 offset:36864
    ds_read_b128 v[64:67], v176 offset:16384
    ds_read_b128 v[68:71], v176 offset:40960
    ds_read_b128 v[72:75], v174 offset:16384
    ds_read_b128 v[76:79], v174 offset:40960
    ds_read_b128 v[80:83], v176 offset:20480
    ds_read_b128 v[84:87], v176 offset:45056
    ds_read_b128 v[88:91], v174 offset:20480
    ds_read_b128 v[92:95], v174 offset:45056
    s_waitcnt lgkmcnt(15)
    v_add_f32 v0, v0, v4
    v_add_f32 v8, v8, v12
    v_add_f32 v1, v1, v5
    v_add_f32 v9, v9, v13
    v_add_f32 v2, v2, v6
    v_add_f32 v10, v10, v14
    v_add_f32 v3, v3, v7
    v_add_f32 v11, v11, v15
    v_add_f32 v0, v0, v8
    v_add_f32 v1, v1, v9
    v_add_f32 v2, v2, v10
    v_add_f32 v3, v3, v11
    v_cvt_pk_bf16_f32 v0, v0, v1
    v_cvt_pk_bf16_f32 v1, v2, v3
    s_add_u32 s35, s34, 0
    buffer_store_dwordx2 v[0:1], v178, s[20:23], s35 offen
    v_add_f32 v16, v16, v20
    v_add_f32 v24, v24, v28
    v_add_f32 v17, v17, v21
    v_add_f32 v25, v25, v29
    v_add_f32 v18, v18, v22
    v_add_f32 v26, v26, v30
    v_add_f32 v19, v19, v23
    v_add_f32 v27, v27, v31
    v_add_f32 v16, v16, v24
    v_add_f32 v17, v17, v25
    v_add_f32 v18, v18, v26
    v_add_f32 v19, v19, v27
    v_cvt_pk_bf16_f32 v16, v16, v17
    v_cvt_pk_bf16_f32 v17, v18, v19
    s_add_u32 s35, s34, 163840
    buffer_store_dwordx2 v[16:17], v178, s[20:23], s35 offen
    s_waitcnt lgkmcnt(14)
    v_add_f32 v32, v32, v36
    s_waitcnt lgkmcnt(12)
    v_add_f32 v40, v40, v44
    v_add_f32 v33, v33, v37
    v_add_f32 v41, v41, v45
    v_add_f32 v34, v34, v38
    v_add_f32 v42, v42, v46
    v_add_f32 v35, v35, v39
    v_add_f32 v43, v43, v47
    v_add_f32 v32, v32, v40
    v_add_f32 v33, v33, v41
    v_add_f32 v34, v34, v42
    v_add_f32 v35, v35, v43
    v_cvt_pk_bf16_f32 v32, v32, v33
    v_cvt_pk_bf16_f32 v33, v34, v35
    s_add_u32 s35, s34, 81952
    buffer_store_dwordx2 v[32:33], v178, s[20:23], s35 offen
    s_waitcnt lgkmcnt(10)
    v_add_f32 v48, v48, v52
    s_waitcnt lgkmcnt(8)
    v_add_f32 v56, v56, v60
    v_add_f32 v49, v49, v53
    v_add_f32 v57, v57, v61
    v_add_f32 v50, v50, v54
    v_add_f32 v58, v58, v62
    v_add_f32 v51, v51, v55
    v_add_f32 v59, v59, v63
    v_add_f32 v48, v48, v56
    v_add_f32 v49, v49, v57
    v_add_f32 v50, v50, v58
    v_add_f32 v51, v51, v59
    v_cvt_pk_bf16_f32 v48, v48, v49
    v_cvt_pk_bf16_f32 v49, v50, v51
    s_add_u32 s35, s34, 64
    buffer_store_dwordx2 v[48:49], v178, s[20:23], s35 offen
    s_waitcnt lgkmcnt(6)
    v_add_f32 v64, v64, v68
    s_waitcnt lgkmcnt(4)
    v_add_f32 v72, v72, v76
    v_add_f32 v65, v65, v69
    v_add_f32 v73, v73, v77
    v_add_f32 v66, v66, v70
    v_add_f32 v74, v74, v78
    v_add_f32 v67, v67, v71
    v_add_f32 v75, v75, v79
    v_add_f32 v64, v64, v72
    v_add_f32 v65, v65, v73
    v_add_f32 v66, v66, v74
    v_add_f32 v67, v67, v75
    v_cvt_pk_bf16_f32 v64, v64, v65
    v_cvt_pk_bf16_f32 v65, v66, v67
    s_add_u32 s35, s34, 163904
    buffer_store_dwordx2 v[64:65], v178, s[20:23], s35 offen
    s_waitcnt lgkmcnt(2)
    v_add_f32 v80, v80, v84
    s_waitcnt lgkmcnt(0)
    v_add_f32 v88, v88, v92
    v_add_f32 v81, v81, v85
    v_add_f32 v89, v89, v93
    v_add_f32 v82, v82, v86
    v_add_f32 v90, v90, v94
    v_add_f32 v83, v83, v87
    v_add_f32 v91, v91, v95
    v_add_f32 v80, v80, v88
    v_add_f32 v81, v81, v89
    v_add_f32 v82, v82, v90
    v_add_f32 v83, v83, v91
    v_cvt_pk_bf16_f32 v80, v80, v81
    v_cvt_pk_bf16_f32 v81, v82, v83
    s_add_u32 s35, s34, 82016
    buffer_store_dwordx2 v[80:81], v178, s[20:23], s35 offen
L_k2_r0_w0:
    s_nop 9
    s_cmp_lg_u32 s24, 1
    s_cbranch_scc1 L_k2_r0_w1
    ds_read_b128 v[0:3], v176 offset:1024
    ds_read_b128 v[4:7], v176 offset:25600
    ds_read_b128 v[8:11], v174 offset:1024
    ds_read_b128 v[12:15], v174 offset:25600
    ds_read_b128 v[16:19], v176 offset:5120
    ds_read_b128 v[20:23], v176 offset:29696
    ds_read_b128 v[24:27], v174 offset:5120
    ds_read_b128 v[28:31], v174 offset:29696
    ds_read_b128 v[32:35], v176 offset:9216
    ds_read_b128 v[36:39], v176 offset:33792
    ds_read_b128 v[40:43], v174 offset:9216
    ds_read_b128 v[44:47], v174 offset:33792
    ds_read_b128 v[48:51], v176 offset:13312
    ds_read_b128 v[52:55], v176 offset:37888
    ds_read_b128 v[56:59], v174 offset:13312
    ds_read_b128 v[60:63], v174 offset:37888
    ds_read_b128 v[64:67], v176 offset:17408
    ds_read_b128 v[68:71], v176 offset:41984
    ds_read_b128 v[72:75], v174 offset:17408
    ds_read_b128 v[76:79], v174 offset:41984
    ds_read_b128 v[80:83], v176 offset:21504
    ds_read_b128 v[84:87], v176 offset:46080
    ds_read_b128 v[88:91], v174 offset:21504
    ds_read_b128 v[92:95], v174 offset:46080
    s_waitcnt lgkmcnt(15)
    v_add_f32 v0, v0, v4
    v_add_f32 v8, v8, v12
    v_add_f32 v1, v1, v5
    v_add_f32 v9, v9, v13
    v_add_f32 v2, v2, v6
    v_add_f32 v10, v10, v14
    v_add_f32 v3, v3, v7
    v_add_f32 v11, v11, v15
    v_add_f32 v0, v0, v8
    v_add_f32 v1, v1, v9
    v_add_f32 v2, v2, v10
    v_add_f32 v3, v3, v11
    v_cvt_pk_bf16_f32 v0, v0, v1
    v_cvt_pk_bf16_f32 v1, v2, v3
    s_add_u32 s35, s34, 40960
    buffer_store_dwordx2 v[0:1], v178, s[20:23], s35 offen
    v_add_f32 v16, v16, v20
    v_add_f32 v24, v24, v28
    v_add_f32 v17, v17, v21
    v_add_f32 v25, v25, v29
    v_add_f32 v18, v18, v22
    v_add_f32 v26, v26, v30
    v_add_f32 v19, v19, v23
    v_add_f32 v27, v27, v31
    v_add_f32 v16, v16, v24
    v_add_f32 v17, v17, v25
    v_add_f32 v18, v18, v26
    v_add_f32 v19, v19, v27
    v_cvt_pk_bf16_f32 v16, v16, v17
    v_cvt_pk_bf16_f32 v17, v18, v19
    s_add_u32 s35, s34, 204800
    buffer_store_dwordx2 v[16:17], v178, s[20:23], s35 offen
    s_waitcnt lgkmcnt(14)
    v_add_f32 v32, v32, v36
    s_waitcnt lgkmcnt(12)
    v_add_f32 v40, v40, v44
    v_add_f32 v33, v33, v37
    v_add_f32 v41, v41, v45
    v_add_f32 v34, v34, v38
    v_add_f32 v42, v42, v46
    v_add_f32 v35, v35, v39
    v_add_f32 v43, v43, v47
    v_add_f32 v32, v32, v40
    v_add_f32 v33, v33, v41
    v_add_f32 v34, v34, v42
    v_add_f32 v35, v35, v43
    v_cvt_pk_bf16_f32 v32, v32, v33
    v_cvt_pk_bf16_f32 v33, v34, v35
    s_add_u32 s35, s34, 122912
    buffer_store_dwordx2 v[32:33], v178, s[20:23], s35 offen
    s_waitcnt lgkmcnt(10)
    v_add_f32 v48, v48, v52
    s_waitcnt lgkmcnt(8)
    v_add_f32 v56, v56, v60
    v_add_f32 v49, v49, v53
    v_add_f32 v57, v57, v61
    v_add_f32 v50, v50, v54
    v_add_f32 v58, v58, v62
    v_add_f32 v51, v51, v55
    v_add_f32 v59, v59, v63
    v_add_f32 v48, v48, v56
    v_add_f32 v49, v49, v57
    v_add_f32 v50, v50, v58
    v_add_f32 v51, v51, v59
    v_cvt_pk_bf16_f32 v48, v48, v49
    v_cvt_pk_bf16_f32 v49, v50, v51
    s_add_u32 s35, s34, 41024
    buffer_store_dwordx2 v[48:49], v178, s[20:23], s35 offen
    s_waitcnt lgkmcnt(6)
    v_add_f32 v64, v64, v68
    s_waitcnt lgkmcnt(4)
    v_add_f32 v72, v72, v76
    v_add_f32 v65, v65, v69
    v_add_f32 v73, v73, v77
    v_add_f32 v66, v66, v70
    v_add_f32 v74, v74, v78
    v_add_f32 v67, v67, v71
    v_add_f32 v75, v75, v79
    v_add_f32 v64, v64, v72
    v_add_f32 v65, v65, v73
    v_add_f32 v66, v66, v74
    v_add_f32 v67, v67, v75
    v_cvt_pk_bf16_f32 v64, v64, v65
    v_cvt_pk_bf16_f32 v65, v66, v67
    s_add_u32 s35, s34, 204864
    buffer_store_dwordx2 v[64:65], v178, s[20:23], s35 offen
    s_waitcnt lgkmcnt(2)
    v_add_f32 v80, v80, v84
    s_waitcnt lgkmcnt(0)
    v_add_f32 v88, v88, v92
    v_add_f32 v81, v81, v85
    v_add_f32 v89, v89, v93
    v_add_f32 v82, v82, v86
    v_add_f32 v90, v90, v94
    v_add_f32 v83, v83, v87
    v_add_f32 v91, v91, v95
    v_add_f32 v80, v80, v88
    v_add_f32 v81, v81, v89
    v_add_f32 v82, v82, v90
    v_add_f32 v83, v83, v91
    v_cvt_pk_bf16_f32 v80, v80, v81
    v_cvt_pk_bf16_f32 v81, v82, v83
    s_add_u32 s35, s34, 122976
    buffer_store_dwordx2 v[80:81], v178, s[20:23], s35 offen
L_k2_r0_w1:
    s_nop 9
    s_cmp_lg_u32 s24, 2
    s_cbranch_scc1 L_k2_r0_w2
    ds_read_b128 v[0:3], v176 offset:2048
    ds_read_b128 v[4:7], v176 offset:26624
    ds_read_b128 v[8:11], v174 offset:2048
    ds_read_b128 v[12:15], v174 offset:26624
    ds_read_b128 v[16:19], v176 offset:6144
    ds_read_b128 v[20:23], v176 offset:30720
    ds_read_b128 v[24:27], v174 offset:6144
    ds_read_b128 v[28:31], v174 offset:30720
    ds_read_b128 v[32:35], v176 offset:10240
    ds_read_b128 v[36:39], v176 offset:34816
    ds_read_b128 v[40:43], v174 offset:10240
    ds_read_b128 v[44:47], v174 offset:34816
    ds_read_b128 v[48:51], v176 offset:14336
    ds_read_b128 v[52:55], v176 offset:38912
    ds_read_b128 v[56:59], v174 offset:14336
    ds_read_b128 v[60:63], v174 offset:38912
    ds_read_b128 v[64:67], v176 offset:18432
    ds_read_b128 v[68:71], v176 offset:43008
    ds_read_b128 v[72:75], v174 offset:18432
    ds_read_b128 v[76:79], v174 offset:43008
    ds_read_b128 v[80:83], v176 offset:22528
    ds_read_b128 v[84:87], v176 offset:47104
    ds_read_b128 v[88:91], v174 offset:22528
    ds_read_b128 v[92:95], v174 offset:47104
    s_waitcnt lgkmcnt(15)
    v_add_f32 v0, v0, v4
    v_add_f32 v8, v8, v12
    v_add_f32 v1, v1, v5
    v_add_f32 v9, v9, v13
    v_add_f32 v2, v2, v6
    v_add_f32 v10, v10, v14
    v_add_f32 v3, v3, v7
    v_add_f32 v11, v11, v15
    v_add_f32 v0, v0, v8
    v_add_f32 v1, v1, v9
    v_add_f32 v2, v2, v10
    v_add_f32 v3, v3, v11
    v_cvt_pk_bf16_f32 v0, v0, v1
    v_cvt_pk_bf16_f32 v1, v2, v3
    s_add_u32 s35, s34, 81920
    buffer_store_dwordx2 v[0:1], v178, s[20:23], s35 offen
    v_add_f32 v16, v16, v20
    v_add_f32 v24, v24, v28
    v_add_f32 v17, v17, v21
    v_add_f32 v25, v25, v29
    v_add_f32 v18, v18, v22
    v_add_f32 v26, v26, v30
    v_add_f32 v19, v19, v23
    v_add_f32 v27, v27, v31
    v_add_f32 v16, v16, v24
    v_add_f32 v17, v17, v25
    v_add_f32 v18, v18, v26
    v_add_f32 v19, v19, v27
    v_cvt_pk_bf16_f32 v16, v16, v17
    v_cvt_pk_bf16_f32 v17, v18, v19
    s_add_u32 s35, s34, 32
    buffer_store_dwordx2 v[16:17], v178, s[20:23], s35 offen
    s_waitcnt lgkmcnt(14)
    v_add_f32 v32, v32, v36
    s_waitcnt lgkmcnt(12)
    v_add_f32 v40, v40, v44
    v_add_f32 v33, v33, v37
    v_add_f32 v41, v41, v45
    v_add_f32 v34, v34, v38
    v_add_f32 v42, v42, v46
    v_add_f32 v35, v35, v39
    v_add_f32 v43, v43, v47
    v_add_f32 v32, v32, v40
    v_add_f32 v33, v33, v41
    v_add_f32 v34, v34, v42
    v_add_f32 v35, v35, v43
    v_cvt_pk_bf16_f32 v32, v32, v33
    v_cvt_pk_bf16_f32 v33, v34, v35
    s_add_u32 s35, s34, 163872
    buffer_store_dwordx2 v[32:33], v178, s[20:23], s35 offen
    s_waitcnt lgkmcnt(10)
    v_add_f32 v48, v48, v52
    s_waitcnt lgkmcnt(8)
    v_add_f32 v56, v56, v60
    v_add_f32 v49, v49, v53
    v_add_f32 v57, v57, v61
    v_add_f32 v50, v50, v54
    v_add_f32 v58, v58, v62
    v_add_f32 v51, v51, v55
    v_add_f32 v59, v59, v63
    v_add_f32 v48, v48, v56
    v_add_f32 v49, v49, v57
    v_add_f32 v50, v50, v58
    v_add_f32 v51, v51, v59
    v_cvt_pk_bf16_f32 v48, v48, v49
    v_cvt_pk_bf16_f32 v49, v50, v51
    s_add_u32 s35, s34, 81984
    buffer_store_dwordx2 v[48:49], v178, s[20:23], s35 offen
    s_waitcnt lgkmcnt(6)
    v_add_f32 v64, v64, v68
    s_waitcnt lgkmcnt(4)
    v_add_f32 v72, v72, v76
    v_add_f32 v65, v65, v69
    v_add_f32 v73, v73, v77
    v_add_f32 v66, v66, v70
    v_add_f32 v74, v74, v78
    v_add_f32 v67, v67, v71
    v_add_f32 v75, v75, v79
    v_add_f32 v64, v64, v72
    v_add_f32 v65, v65, v73
    v_add_f32 v66, v66, v74
    v_add_f32 v67, v67, v75
    v_cvt_pk_bf16_f32 v64, v64, v65
    v_cvt_pk_bf16_f32 v65, v66, v67
    s_add_u32 s35, s34, 96
    buffer_store_dwordx2 v[64:65], v178, s[20:23], s35 offen
    s_waitcnt lgkmcnt(2)
    v_add_f32 v80, v80, v84
    s_waitcnt lgkmcnt(0)
    v_add_f32 v88, v88, v92
    v_add_f32 v81, v81, v85
    v_add_f32 v89, v89, v93
    v_add_f32 v82, v82, v86
    v_add_f32 v90, v90, v94
    v_add_f32 v83, v83, v87
    v_add_f32 v91, v91, v95
    v_add_f32 v80, v80, v88
    v_add_f32 v81, v81, v89
    v_add_f32 v82, v82, v90
    v_add_f32 v83, v83, v91
    v_cvt_pk_bf16_f32 v80, v80, v81
    v_cvt_pk_bf16_f32 v81, v82, v83
    s_add_u32 s35, s34, 163936
    buffer_store_dwordx2 v[80:81], v178, s[20:23], s35 offen
L_k2_r0_w2:
    s_nop 9
    s_cmp_lg_u32 s24, 3
    s_cbranch_scc1 L_k2_r0_w3
    ds_read_b128 v[0:3], v176 offset:3072
    ds_read_b128 v[4:7], v176 offset:27648
    ds_read_b128 v[8:11], v174 offset:3072
    ds_read_b128 v[12:15], v174 offset:27648
    ds_read_b128 v[16:19], v176 offset:7168
    ds_read_b128 v[20:23], v176 offset:31744
    ds_read_b128 v[24:27], v174 offset:7168
    ds_read_b128 v[28:31], v174 offset:31744
    ds_read_b128 v[32:35], v176 offset:11264
    ds_read_b128 v[36:39], v176 offset:35840
    ds_read_b128 v[40:43], v174 offset:11264
    ds_read_b128 v[44:47], v174 offset:35840
    ds_read_b128 v[48:51], v176 offset:15360
    ds_read_b128 v[52:55], v176 offset:39936
    ds_read_b128 v[56:59], v174 offset:15360
    ds_read_b128 v[60:63], v174 offset:39936
    ds_read_b128 v[64:67], v176 offset:19456
    ds_read_b128 v[68:71], v176 offset:44032
    ds_read_b128 v[72:75], v174 offset:19456
    ds_read_b128 v[76:79], v174 offset:44032
    ds_read_b128 v[80:83], v176 offset:23552
    ds_read_b128 v[84:87], v176 offset:48128
    ds_read_b128 v[88:91], v174 offset:23552
    ds_read_b128 v[92:95], v174 offset:48128
    s_waitcnt lgkmcnt(15)
    v_add_f32 v0, v0, v4
    v_add_f32 v8, v8, v12
    v_add_f32 v1, v1, v5
    v_add_f32 v9, v9, v13
    v_add_f32 v2, v2, v6
    v_add_f32 v10, v10, v14
    v_add_f32 v3, v3, v7
    v_add_f32 v11, v11, v15
    v_add_f32 v0, v0, v8
    v_add_f32 v1, v1, v9
    v_add_f32 v2, v2, v10
    v_add_f32 v3, v3, v11
    v_cvt_pk_bf16_f32 v0, v0, v1
    v_cvt_pk_bf16_f32 v1, v2, v3
    s_add_u32 s35, s34, 122880
    buffer_store_dwordx2 v[0:1], v178, s[20:23], s35 offen
    v_add_f32 v16, v16, v20
    v_add_f32 v24, v24, v28
    v_add_f32 v17, v17, v21
    v_add_f32 v25, v25, v29
    v_add_f32 v18, v18, v22
    v_add_f32 v26, v26, v30
    v_add_f32 v19, v19, v23
    v_add_f32 v27, v27, v31
    v_add_f32 v16, v16, v24
    v_add_f32 v17, v17, v25
    v_add_f32 v18, v18, v26
    v_add_f32 v19, v19, v27
    v_cvt_pk_bf16_f32 v16, v16, v17
    v_cvt_pk_bf16_f32 v17, v18, v19
    s_add_u32 s35, s34, 40992
    buffer_store_dwordx2 v[16:17], v178, s[20:23], s35 offen
    s_waitcnt lgkmcnt(14)
    v_add_f32 v32, v32, v36
    s_waitcnt lgkmcnt(12)
    v_add_f32 v40, v40, v44
    v_add_f32 v33, v33, v37
    v_add_f32 v41, v41, v45
    v_add_f32 v34, v34, v38
    v_add_f32 v42, v42, v46
    v_add_f32 v35, v35, v39
    v_add_f32 v43, v43, v47
    v_add_f32 v32, v32, v40
    v_add_f32 v33, v33, v41
    v_add_f32 v34, v34, v42
    v_add_f32 v35, v35, v43
    v_cvt_pk_bf16_f32 v32, v32, v33
    v_cvt_pk_bf16_f32 v33, v34, v35
    s_add_u32 s35, s34, 204832
    buffer_store_dwordx2 v[32:33], v178, s[20:23], s35 offen
    s_waitcnt lgkmcnt(10)
    v_add_f32 v48, v48, v52
    s_waitcnt lgkmcnt(8)
    v_add_f32 v56, v56, v60
    v_add_f32 v49, v49, v53
    v_add_f32 v57, v57, v61
    v_add_f32 v50, v50, v54
    v_add_f32 v58, v58, v62
    v_add_f32 v51, v51, v55
    v_add_f32 v59, v59, v63
    v_add_f32 v48, v48, v56
    v_add_f32 v49, v49, v57
    v_add_f32 v50, v50, v58
    v_add_f32 v51, v51, v59
    v_cvt_pk_bf16_f32 v48, v48, v49
    v_cvt_pk_bf16_f32 v49, v50, v51
    s_add_u32 s35, s34, 122944
    buffer_store_dwordx2 v[48:49], v178, s[20:23], s35 offen
    s_waitcnt lgkmcnt(6)
    v_add_f32 v64, v64, v68
    s_waitcnt lgkmcnt(4)
    v_add_f32 v72, v72, v76
    v_add_f32 v65, v65, v69
    v_add_f32 v73, v73, v77
    v_add_f32 v66, v66, v70
    v_add_f32 v74, v74, v78
    v_add_f32 v67, v67, v71
    v_add_f32 v75, v75, v79
    v_add_f32 v64, v64, v72
    v_add_f32 v65, v65, v73
    v_add_f32 v66, v66, v74
    v_add_f32 v67, v67, v75
    v_cvt_pk_bf16_f32 v64, v64, v65
    v_cvt_pk_bf16_f32 v65, v66, v67
    s_add_u32 s35, s34, 41056
    buffer_store_dwordx2 v[64:65], v178, s[20:23], s35 offen
    s_waitcnt lgkmcnt(2)
    v_add_f32 v80, v80, v84
    s_waitcnt lgkmcnt(0)
    v_add_f32 v88, v88, v92
    v_add_f32 v81, v81, v85
    v_add_f32 v89, v89, v93
    v_add_f32 v82, v82, v86
    v_add_f32 v90, v90, v94
    v_add_f32 v83, v83, v87
    v_add_f32 v91, v91, v95
    v_add_f32 v80, v80, v88
    v_add_f32 v81, v81, v89
    v_add_f32 v82, v82, v90
    v_add_f32 v83, v83, v91
    v_cvt_pk_bf16_f32 v80, v80, v81
    v_cvt_pk_bf16_f32 v81, v82, v83
    s_add_u32 s35, s34, 204896
    buffer_store_dwordx2 v[80:81], v178, s[20:23], s35 offen
L_k2_r0_w3:
    s_nop 9
    s_barrier
    ds_write_b128 v177, a[96:99]
    ds_write_b128 v177, a[100:103] offset:1024
    ds_write_b128 v177, a[104:107] offset:2048
    ds_write_b128 v177, a[108:111] offset:3072
    ds_write_b128 v177, a[112:115] offset:4096
    ds_write_b128 v177, a[116:119] offset:5120
    ds_write_b128 v177, a[120:123] offset:6144
    ds_write_b128 v177, a[124:127] offset:7168
    ds_write_b128 v177, a[128:131] offset:8192
    ds_write_b128 v177, a[132:135] offset:9216
    ds_write_b128 v177, a[136:139] offset:10240
    ds_write_b128 v177, a[140:143] offset:11264
    ds_write_b128 v177, a[144:147] offset:12288
    ds_write_b128 v177, a[148:151] offset:13312
    ds_write_b128 v177, a[152:155] offset:14336
    ds_write_b128 v177, a[156:159] offset:15360
    ds_write_b128 v177, a[160:163] offset:16384
    ds_write_b128 v177, a[164:167] offset:17408
    ds_write_b128 v177, a[168:171] offset:18432
    ds_write_b128 v177, a[172:175] offset:19456
    ds_write_b128 v177, a[176:179] offset:20480
    ds_write_b128 v177, a[180:183] offset:21504
    ds_write_b128 v177, a[184:187] offset:22528
    ds_write_b128 v177, a[188:191] offset:23552
    s_waitcnt lgkmcnt(0)
    s_barrier
    s_cmp_lg_u32 s24, 0
    s_cbranch_scc1 L_k2_r1_w0
    ds_read_b128 v[0:3], v176
    ds_read_b128 v[4:7], v176 offset:24576
    ds_read_b128 v[8:11], v174
    ds_read_b128 v[12:15], v174 offset:24576
    ds_read_b128 v[16:19], v176 offset:4096
    ds_read_b128 v[20:23], v176 offset:28672
    ds_read_b128 v[24:27], v174 offset:4096
    ds_read_b128 v[28:31], v174 offset:28672
    ds_read_b128 v[32:35], v176 offset:8192
    ds_read_b128 v[36:39], v176 offset:32768
    ds_read_b128 v[40:43], v174 offset:8192
    ds_read_b128 v[44:47], v174 offset:32768
    ds_read_b128 v[48:51], v176 offset:12288
    ds_read_b128 v[52:55], v176 offset:36864
    ds_read_b128 v[56:59], v174 offset:12288
    ds_read_b128 v[60:63], v174 offset:36864
    ds_read_b128 v[64:67], v176 offset:16384
    ds_read_b128 v[68:71], v176 offset:40960
    ds_read_b128 v[72:75], v174 offset:16384
    ds_read_b128 v[76:79], v174 offset:40960
    ds_read_b128 v[80:83], v176 offset:20480
    ds_read_b128 v[84:87], v176 offset:45056
    ds_read_b128 v[88:91], v174 offset:20480
    ds_read_b128 v[92:95], v174 offset:45056
    s_waitcnt lgkmcnt(15)
    v_add_f32 v0, v0, v4
    v_add_f32 v8, v8, v12
    v_add_f32 v1, v1, v5
    v_add_f32 v9, v9, v13
    v_add_f32 v2, v2, v6
    v_add_f32 v10, v10, v14
    v_add_f32 v3, v3, v7
    v_add_f32 v11, v11, v15
    v_add_f32 v0, v0, v8
    v_add_f32 v1, v1, v9
    v_add_f32 v2, v2, v10
    v_add_f32 v3, v3, v11
    v_cvt_pk_bf16_f32 v0, v0, v1
    v_cvt_pk_bf16_f32 v1, v2, v3
    s_add_u32 s35, s34, 128
    buffer_store_dwordx2 v[0:1], v178, s[20:23], s35 offen
    v_add_f32 v16, v16, v20
    v_add_f32 v24, v24, v28
    v_add_f32 v17, v17, v21
    v_add_f32 v25, v25, v29
    v_add_f32 v18, v18, v22
    v_add_f32 v26, v26, v30
    v_add_f32 v19, v19, v23
    v_add_f32 v27, v27, v31
    v_add_f32 v16, v16, v24
    v_add_f32 v17, v17, v25
    v_add_f32 v18, v18, v26
    v_add_f32 v19, v19, v27
    v_cvt_pk_bf16_f32 v16, v16, v17
    v_cvt_pk_bf16_f32 v17, v18, v19
    s_add_u32 s35, s34, 163968
    buffer_store_dwordx2 v[16:17], v178, s[20:23], s35 offen
    s_waitcnt lgkmcnt(14)
    v_add_f32 v32, v32, v36
    s_waitcnt lgkmcnt(12)
    v_add_f32 v40, v40, v44
    v_add_f32 v33, v33, v37
    v_add_f32 v41, v41, v45
    v_add_f32 v34, v34, v38
    v_add_f32 v42, v42, v46
    v_add_f32 v35, v35, v39
    v_add_f32 v43, v43, v47
    v_add_f32 v32, v32, v40
    v_add_f32 v33, v33, v41
    v_add_f32 v34, v34, v42
    v_add_f32 v35, v35, v43
    v_cvt_pk_bf16_f32 v32, v32, v33
    v_cvt_pk_bf16_f32 v33, v34, v35
    s_add_u32 s35, s34, 82080
    buffer_store_dwordx2 v[32:33], v178, s[20:23], s35 offen
    s_waitcnt lgkmcnt(10)
    v_add_f32 v48, v48, v52
    s_waitcnt lgkmcnt(8)
    v_add_f32 v56, v56, v60
    v_add_f32 v49, v49, v53
    v_add_f32 v57, v57, v61
    v_add_f32 v50, v50, v54
    v_add_f32 v58, v58, v62
    v_add_f32 v51, v51, v55
    v_add_f32 v59, v59, v63
    v_add_f32 v48, v48, v56
    v_add_f32 v49, v49, v57
    v_add_f32 v50, v50, v58
    v_add_f32 v51, v51, v59
    v_cvt_pk_bf16_f32 v48, v48, v49
    v_cvt_pk_bf16_f32 v49, v50, v51
    s_add_u32 s35, s34, 192
    buffer_store_dwordx2 v[48:49], v178, s[20:23], s35 offen
    s_waitcnt lgkmcnt(6)
    v_add_f32 v64, v64, v68
    s_waitcnt lgkmcnt(4)
    v_add_f32 v72, v72, v76
    v_add_f32 v65, v65, v69
    v_add_f32 v73, v73, v77
    v_add_f32 v66, v66, v70
    v_add_f32 v74, v74, v78
    v_add_f32 v67, v67, v71
    v_add_f32 v75, v75, v79
    v_add_f32 v64, v64, v72
    v_add_f32 v65, v65, v73
    v_add_f32 v66, v66, v74
    v_add_f32 v67, v67, v75
    v_cvt_pk_bf16_f32 v64, v64, v65
    v_cvt_pk_bf16_f32 v65, v66, v67
    s_add_u32 s35, s34, 164032
    buffer_store_dwordx2 v[64:65], v178, s[20:23], s35 offen
    s_waitcnt lgkmcnt(2)
    v_add_f32 v80, v80, v84
    s_waitcnt lgkmcnt(0)
    v_add_f32 v88, v88, v92
    v_add_f32 v81, v81, v85
    v_add_f32 v89, v89, v93
    v_add_f32 v82, v82, v86
    v_add_f32 v90, v90, v94
    v_add_f32 v83, v83, v87
    v_add_f32 v91, v91, v95
    v_add_f32 v80, v80, v88
    v_add_f32 v81, v81, v89
    v_add_f32 v82, v82, v90
    v_add_f32 v83, v83, v91
    v_cvt_pk_bf16_f32 v80, v80, v81
    v_cvt_pk_bf16_f32 v81, v82, v83
    s_add_u32 s35, s34, 82144
    buffer_store_dwordx2 v[80:81], v178, s[20:23], s35 offen
L_k2_r1_w0:
    s_nop 9
    s_cmp_lg_u32 s24, 1
    s_cbranch_scc1 L_k2_r1_w1
    ds_read_b128 v[0:3], v176 offset:1024
    ds_read_b128 v[4:7], v176 offset:25600
    ds_read_b128 v[8:11], v174 offset:1024
    ds_read_b128 v[12:15], v174 offset:25600
    ds_read_b128 v[16:19], v176 offset:5120
    ds_read_b128 v[20:23], v176 offset:29696
    ds_read_b128 v[24:27], v174 offset:5120
    ds_read_b128 v[28:31], v174 offset:29696
    ds_read_b128 v[32:35], v176 offset:9216
    ds_read_b128 v[36:39], v176 offset:33792
    ds_read_b128 v[40:43], v174 offset:9216
    ds_read_b128 v[44:47], v174 offset:33792
    ds_read_b128 v[48:51], v176 offset:13312
    ds_read_b128 v[52:55], v176 offset:37888
    ds_read_b128 v[56:59], v174 offset:13312
    ds_read_b128 v[60:63], v174 offset:37888
    ds_read_b128 v[64:67], v176 offset:17408
    ds_read_b128 v[68:71], v176 offset:41984
    ds_read_b128 v[72:75], v174 offset:17408
    ds_read_b128 v[76:79], v174 offset:41984
    ds_read_b128 v[80:83], v176 offset:21504
    ds_read_b128 v[84:87], v176 offset:46080
    ds_read_b128 v[88:91], v174 offset:21504
    ds_read_b128 v[92:95], v174 offset:46080
    s_waitcnt lgkmcnt(15)
    v_add_f32 v0, v0, v4
    v_add_f32 v8, v8, v12
    v_add_f32 v1, v1, v5
    v_add_f32 v9, v9, v13
    v_add_f32 v2, v2, v6
    v_add_f32 v10, v10, v14
    v_add_f32 v3, v3, v7
    v_add_f32 v11, v11, v15
    v_add_f32 v0, v0, v8
    v_add_f32 v1, v1, v9
    v_add_f32 v2, v2, v10
    v_add_f32 v3, v3, v11
    v_cvt_pk_bf16_f32 v0, v0, v1
    v_cvt_pk_bf16_f32 v1, v2, v3
    s_add_u32 s35, s34, 41088
    buffer_store_dwordx2 v[0:1], v178, s[20:23], s35 offen
    v_add_f32 v16, v16, v20
    v_add_f32 v24, v24, v28
    v_add_f32 v17, v17, v21
    v_add_f32 v25, v25, v29
    v_add_f32 v18, v18, v22
    v_add_f32 v26, v26, v30
    v_add_f32 v19, v19, v23
    v_add_f32 v27, v27, v31
    v_add_f32 v16, v16, v24
    v_add_f32 v17, v17, v25
    v_add_f32 v18, v18, v26
    v_add_f32 v19, v19, v27
    v_cvt_pk_bf16_f32 v16, v16, v17
    v_cvt_pk_bf16_f32 v17, v18, v19
    s_add_u32 s35, s34, 204928
    buffer_store_dwordx2 v[16:17], v178, s[20:23], s35 offen
    s_waitcnt lgkmcnt(14)
    v_add_f32 v32, v32, v36
    s_waitcnt lgkmcnt(12)
    v_add_f32 v40, v40, v44
    v_add_f32 v33, v33, v37
    v_add_f32 v41, v41, v45
    v_add_f32 v34, v34, v38
    v_add_f32 v42, v42, v46
    v_add_f32 v35, v35, v39
    v_add_f32 v43, v43, v47
    v_add_f32 v32, v32, v40
    v_add_f32 v33, v33, v41
    v_add_f32 v34, v34, v42
    v_add_f32 v35, v35, v43
    v_cvt_pk_bf16_f32 v32, v32, v33
    v_cvt_pk_bf16_f32 v33, v34, v35
    s_add_u32 s35, s34, 123040
    buffer_store_dwordx2 v[32:33], v178, s[20:23], s35 offen
    s_waitcnt lgkmcnt(10)
    v_add_f32 v48, v48, v52
    s_waitcnt lgkmcnt(8)
    v_add_f32 v56, v56, v60
    v_add_f32 v49, v49, v53
    v_add_f32 v57, v57, v61
    v_add_f32 v50, v50, v54
    v_add_f32 v58, v58, v62
    v_add_f32 v51, v51, v55
    v_add_f32 v59, v59, v63
    v_add_f32 v48, v48, v56
    v_add_f32 v49, v49, v57
    v_add_f32 v50, v50, v58
    v_add_f32 v51, v51, v59
    v_cvt_pk_bf16_f32 v48, v48, v49
    v_cvt_pk_bf16_f32 v49, v50, v51
    s_add_u32 s35, s34, 41152
    buffer_store_dwordx2 v[48:49], v178, s[20:23], s35 offen
    s_waitcnt lgkmcnt(6)
    v_add_f32 v64, v64, v68
    s_waitcnt lgkmcnt(4)
    v_add_f32 v72, v72, v76
    v_add_f32 v65, v65, v69
    v_add_f32 v73, v73, v77
    v_add_f32 v66, v66, v70
    v_add_f32 v74, v74, v78
    v_add_f32 v67, v67, v71
    v_add_f32 v75, v75, v79
    v_add_f32 v64, v64, v72
    v_add_f32 v65, v65, v73
    v_add_f32 v66, v66, v74
    v_add_f32 v67, v67, v75
    v_cvt_pk_bf16_f32 v64, v64, v65
    v_cvt_pk_bf16_f32 v65, v66, v67
    s_add_u32 s35, s34, 204992
    buffer_store_dwordx2 v[64:65], v178, s[20:23], s35 offen
    s_waitcnt lgkmcnt(2)
    v_add_f32 v80, v80, v84
    s_waitcnt lgkmcnt(0)
    v_add_f32 v88, v88, v92
    v_add_f32 v81, v81, v85
    v_add_f32 v89, v89, v93
    v_add_f32 v82, v82, v86
    v_add_f32 v90, v90, v94
    v_add_f32 v83, v83, v87
    v_add_f32 v91, v91, v95
    v_add_f32 v80, v80, v88
    v_add_f32 v81, v81, v89
    v_add_f32 v82, v82, v90
    v_add_f32 v83, v83, v91
    v_cvt_pk_bf16_f32 v80, v80, v81
    v_cvt_pk_bf16_f32 v81, v82, v83
    s_add_u32 s35, s34, 123104
    buffer_store_dwordx2 v[80:81], v178, s[20:23], s35 offen
L_k2_r1_w1:
    s_nop 9
    s_cmp_lg_u32 s24, 2
    s_cbranch_scc1 L_k2_r1_w2
    ds_read_b128 v[0:3], v176 offset:2048
    ds_read_b128 v[4:7], v176 offset:26624
    ds_read_b128 v[8:11], v174 offset:2048
    ds_read_b128 v[12:15], v174 offset:26624
    ds_read_b128 v[16:19], v176 offset:6144
    ds_read_b128 v[20:23], v176 offset:30720
    ds_read_b128 v[24:27], v174 offset:6144
    ds_read_b128 v[28:31], v174 offset:30720
    ds_read_b128 v[32:35], v176 offset:10240
    ds_read_b128 v[36:39], v176 offset:34816
    ds_read_b128 v[40:43], v174 offset:10240
    ds_read_b128 v[44:47], v174 offset:34816
    ds_read_b128 v[48:51], v176 offset:14336
    ds_read_b128 v[52:55], v176 offset:38912
    ds_read_b128 v[56:59], v174 offset:14336
    ds_read_b128 v[60:63], v174 offset:38912
    ds_read_b128 v[64:67], v176 offset:18432
    ds_read_b128 v[68:71], v176 offset:43008
    ds_read_b128 v[72:75], v174 offset:18432
    ds_read_b128 v[76:79], v174 offset:43008
    ds_read_b128 v[80:83], v176 offset:22528
    ds_read_b128 v[84:87], v176 offset:47104
    ds_read_b128 v[88:91], v174 offset:22528
    ds_read_b128 v[92:95], v174 offset:47104
    s_waitcnt lgkmcnt(15)
    v_add_f32 v0, v0, v4
    v_add_f32 v8, v8, v12
    v_add_f32 v1, v1, v5
    v_add_f32 v9, v9, v13
    v_add_f32 v2, v2, v6
    v_add_f32 v10, v10, v14
    v_add_f32 v3, v3, v7
    v_add_f32 v11, v11, v15
    v_add_f32 v0, v0, v8
    v_add_f32 v1, v1, v9
    v_add_f32 v2, v2, v10
    v_add_f32 v3, v3, v11
    v_cvt_pk_bf16_f32 v0, v0, v1
    v_cvt_pk_bf16_f32 v1, v2, v3
    s_add_u32 s35, s34, 82048
    buffer_store_dwordx2 v[0:1], v178, s[20:23], s35 offen
    v_add_f32 v16, v16, v20
    v_add_f32 v24, v24, v28
    v_add_f32 v17, v17, v21
    v_add_f32 v25, v25, v29
    v_add_f32 v18, v18, v22
    v_add_f32 v26, v26, v30
    v_add_f32 v19, v19, v23
    v_add_f32 v27, v27, v31
    v_add_f32 v16, v16, v24
    v_add_f32 v17, v17, v25
    v_add_f32 v18, v18, v26
    v_add_f32 v19, v19, v27
    v_cvt_pk_bf16_f32 v16, v16, v17
    v_cvt_pk_bf16_f32 v17, v18, v19
    s_add_u32 s35, s34, 160
    buffer_store_dwordx2 v[16:17], v178, s[20:23], s35 offen
    s_waitcnt lgkmcnt(14)
    v_add_f32 v32, v32, v36
    s_waitcnt lgkmcnt(12)
    v_add_f32 v40, v40, v44
    v_add_f32 v33, v33, v37
    v_add_f32 v41, v41, v45
    v_add_f32 v34, v34, v38
    v_add_f32 v42, v42, v46
    v_add_f32 v35, v35, v39
    v_add_f32 v43, v43, v47
    v_add_f32 v32, v32, v40
    v_add_f32 v33, v33, v41
    v_add_f32 v34, v34, v42
    v_add_f32 v35, v35, v43
    v_cvt_pk_bf16_f32 v32, v32, v33
    v_cvt_pk_bf16_f32 v33, v34, v35
    s_add_u32 s35, s34, 164000
    buffer_store_dwordx2 v[32:33], v178, s[20:23], s35 offen
    s_waitcnt lgkmcnt(10)
    v_add_f32 v48, v48, v52
    s_waitcnt lgkmcnt(8)
    v_add_f32 v56, v56, v60
    v_add_f32 v49, v49, v53
    v_add_f32 v57, v57, v61
    v_add_f32 v50, v50, v54
    v_add_f32 v58, v58, v62
    v_add_f32 v51, v51, v55
    v_add_f32 v59, v59, v63
    v_add_f32 v48, v48, v56
    v_add_f32 v49, v49, v57
    v_add_f32 v50, v50, v58
    v_add_f32 v51, v51, v59
    v_cvt_pk_bf16_f32 v48, v48, v49
    v_cvt_pk_bf16_f32 v49, v50, v51
    s_add_u32 s35, s34, 82112
    buffer_store_dwordx2 v[48:49], v178, s[20:23], s35 offen
    s_waitcnt lgkmcnt(6)
    v_add_f32 v64, v64, v68
    s_waitcnt lgkmcnt(4)
    v_add_f32 v72, v72, v76
    v_add_f32 v65, v65, v69
    v_add_f32 v73, v73, v77
    v_add_f32 v66, v66, v70
    v_add_f32 v74, v74, v78
    v_add_f32 v67, v67, v71
    v_add_f32 v75, v75, v79
    v_add_f32 v64, v64, v72
    v_add_f32 v65, v65, v73
    v_add_f32 v66, v66, v74
    v_add_f32 v67, v67, v75
    v_cvt_pk_bf16_f32 v64, v64, v65
    v_cvt_pk_bf16_f32 v65, v66, v67
    s_add_u32 s35, s34, 224
    buffer_store_dwordx2 v[64:65], v178, s[20:23], s35 offen
    s_waitcnt lgkmcnt(2)
    v_add_f32 v80, v80, v84
    s_waitcnt lgkmcnt(0)
    v_add_f32 v88, v88, v92
    v_add_f32 v81, v81, v85
    v_add_f32 v89, v89, v93
    v_add_f32 v82, v82, v86
    v_add_f32 v90, v90, v94
    v_add_f32 v83, v83, v87
    v_add_f32 v91, v91, v95
    v_add_f32 v80, v80, v88
    v_add_f32 v81, v81, v89
    v_add_f32 v82, v82, v90
    v_add_f32 v83, v83, v91
    v_cvt_pk_bf16_f32 v80, v80, v81
    v_cvt_pk_bf16_f32 v81, v82, v83
    s_add_u32 s35, s34, 164064
    buffer_store_dwordx2 v[80:81], v178, s[20:23], s35 offen
L_k2_r1_w2:
    s_nop 9
    s_cmp_lg_u32 s24, 3
    s_cbranch_scc1 L_k2_r1_w3
    ds_read_b128 v[0:3], v176 offset:3072
    ds_read_b128 v[4:7], v176 offset:27648
    ds_read_b128 v[8:11], v174 offset:3072
    ds_read_b128 v[12:15], v174 offset:27648
    ds_read_b128 v[16:19], v176 offset:7168
    ds_read_b128 v[20:23], v176 offset:31744
    ds_read_b128 v[24:27], v174 offset:7168
    ds_read_b128 v[28:31], v174 offset:31744
    ds_read_b128 v[32:35], v176 offset:11264
    ds_read_b128 v[36:39], v176 offset:35840
    ds_read_b128 v[40:43], v174 offset:11264
    ds_read_b128 v[44:47], v174 offset:35840
    ds_read_b128 v[48:51], v176 offset:15360
    ds_read_b128 v[52:55], v176 offset:39936
    ds_read_b128 v[56:59], v174 offset:15360
    ds_read_b128 v[60:63], v174 offset:39936
    ds_read_b128 v[64:67], v176 offset:19456
    ds_read_b128 v[68:71], v176 offset:44032
    ds_read_b128 v[72:75], v174 offset:19456
    ds_read_b128 v[76:79], v174 offset:44032
    ds_read_b128 v[80:83], v176 offset:23552
    ds_read_b128 v[84:87], v176 offset:48128
    ds_read_b128 v[88:91], v174 offset:23552
    ds_read_b128 v[92:95], v174 offset:48128
    s_waitcnt lgkmcnt(15)
    v_add_f32 v0, v0, v4
    v_add_f32 v8, v8, v12
    v_add_f32 v1, v1, v5
    v_add_f32 v9, v9, v13
    v_add_f32 v2, v2, v6
    v_add_f32 v10, v10, v14
    v_add_f32 v3, v3, v7
    v_add_f32 v11, v11, v15
    v_add_f32 v0, v0, v8
    v_add_f32 v1, v1, v9
    v_add_f32 v2, v2, v10
    v_add_f32 v3, v3, v11
    v_cvt_pk_bf16_f32 v0, v0, v1
    v_cvt_pk_bf16_f32 v1, v2, v3
    s_add_u32 s35, s34, 123008
    buffer_store_dwordx2 v[0:1], v178, s[20:23], s35 offen
    v_add_f32 v16, v16, v20
    v_add_f32 v24, v24, v28
    v_add_f32 v17, v17, v21
    v_add_f32 v25, v25, v29
    v_add_f32 v18, v18, v22
    v_add_f32 v26, v26, v30
    v_add_f32 v19, v19, v23
    v_add_f32 v27, v27, v31
    v_add_f32 v16, v16, v24
    v_add_f32 v17, v17, v25
    v_add_f32 v18, v18, v26
    v_add_f32 v19, v19, v27
    v_cvt_pk_bf16_f32 v16, v16, v17
    v_cvt_pk_bf16_f32 v17, v18, v19
    s_add_u32 s35, s34, 41120
    buffer_store_dwordx2 v[16:17], v178, s[20:23], s35 offen
    s_waitcnt lgkmcnt(14)
    v_add_f32 v32, v32, v36
    s_waitcnt lgkmcnt(12)
    v_add_f32 v40, v40, v44
    v_add_f32 v33, v33, v37
    v_add_f32 v41, v41, v45
    v_add_f32 v34, v34, v38
    v_add_f32 v42, v42, v46
    v_add_f32 v35, v35, v39
    v_add_f32 v43, v43, v47
    v_add_f32 v32, v32, v40
    v_add_f32 v33, v33, v41
    v_add_f32 v34, v34, v42
    v_add_f32 v35, v35, v43
    v_cvt_pk_bf16_f32 v32, v32, v33
    v_cvt_pk_bf16_f32 v33, v34, v35
    s_add_u32 s35, s34, 204960
    buffer_store_dwordx2 v[32:33], v178, s[20:23], s35 offen
    s_waitcnt lgkmcnt(10)
    v_add_f32 v48, v48, v52
    s_waitcnt lgkmcnt(8)
    v_add_f32 v56, v56, v60
    v_add_f32 v49, v49, v53
    v_add_f32 v57, v57, v61
    v_add_f32 v50, v50, v54
    v_add_f32 v58, v58, v62
    v_add_f32 v51, v51, v55
    v_add_f32 v59, v59, v63
    v_add_f32 v48, v48, v56
    v_add_f32 v49, v49, v57
    v_add_f32 v50, v50, v58
    v_add_f32 v51, v51, v59
    v_cvt_pk_bf16_f32 v48, v48, v49
    v_cvt_pk_bf16_f32 v49, v50, v51
    s_add_u32 s35, s34, 123072
    buffer_store_dwordx2 v[48:49], v178, s[20:23], s35 offen
    s_waitcnt lgkmcnt(6)
    v_add_f32 v64, v64, v68
    s_waitcnt lgkmcnt(4)
    v_add_f32 v72, v72, v76
    v_add_f32 v65, v65, v69
    v_add_f32 v73, v73, v77
    v_add_f32 v66, v66, v70
    v_add_f32 v74, v74, v78
    v_add_f32 v67, v67, v71
    v_add_f32 v75, v75, v79
    v_add_f32 v64, v64, v72
    v_add_f32 v65, v65, v73
    v_add_f32 v66, v66, v74
    v_add_f32 v67, v67, v75
    v_cvt_pk_bf16_f32 v64, v64, v65
    v_cvt_pk_bf16_f32 v65, v66, v67
    s_add_u32 s35, s34, 41184
    buffer_store_dwordx2 v[64:65], v178, s[20:23], s35 offen
    s_waitcnt lgkmcnt(2)
    v_add_f32 v80, v80, v84
    s_waitcnt lgkmcnt(0)
    v_add_f32 v88, v88, v92
    v_add_f32 v81, v81, v85
    v_add_f32 v89, v89, v93
    v_add_f32 v82, v82, v86
    v_add_f32 v90, v90, v94
    v_add_f32 v83, v83, v87
    v_add_f32 v91, v91, v95
    v_add_f32 v80, v80, v88
    v_add_f32 v81, v81, v89
    v_add_f32 v82, v82, v90
    v_add_f32 v83, v83, v91
    v_cvt_pk_bf16_f32 v80, v80, v81
    v_cvt_pk_bf16_f32 v81, v82, v83
    s_add_u32 s35, s34, 205024
    buffer_store_dwordx2 v[80:81], v178, s[20:23], s35 offen
L_k2_r1_w3:
    s_nop 9
L_k2_exit:
    s_endpgm
.section .rodata,"a"
.p2align 6
.amdhsa_kernel attn_kernel
  .amdhsa_next_free_vgpr 256
  .amdhsa_next_free_sgpr 102
  .amdhsa_accum_offset 256
  .amdhsa_group_segment_fixed_size 0
  .amdhsa_kernarg_size 104
  .amdhsa_user_sgpr_count 2
  .amdhsa_user_sgpr_kernarg_segment_ptr 1
  .amdhsa_system_sgpr_workgroup_id_x 1
.end_amdhsa_kernel
.p2align 6
.amdhsa_kernel oproj_kernel
  .amdhsa_next_free_vgpr 512
  .amdhsa_next_free_sgpr 102
  .amdhsa_accum_offset 256
  .amdhsa_group_segment_fixed_size 0
  .amdhsa_kernarg_size 104
  .amdhsa_user_sgpr_count 2
  .amdhsa_user_sgpr_kernarg_segment_ptr 1
  .amdhsa_system_sgpr_workgroup_id_x 1
.end_amdhsa_kernel
```
